```python
import torch

def _softmax(x, axis=-1):
    return torch.softmax(x, dim=axis)
def _gelu(x):
    return torch.nn.functional.gelu(x, approximate="tanh")
def _silu(x):
    return torch.nn.functional.silu(x)
def _sigmoid(x):
    return torch.sigmoid(x)
def _layernorm(x, axis=-1, eps=1e-5):
    m = x.mean(dim=axis, keepdim=True)
    v = x.var(dim=axis, keepdim=True, unbiased=False)
    return (x - m) / torch.sqrt(v + eps)
def _scatter_add(tgt, idx, src, axis=0):
    return tgt.clone().index_add_(axis, idx, src)
def _segment_sum(src, seg, n):
    out = torch.zeros((n,) + src.shape[1:], dtype=src.dtype)
    return out.index_add_(0, seg, src)
def _pad(x, pw):
    flat = tuple(v for pair in reversed(pw) for v in pair)
    return torch.nn.functional.pad(x, flat)

kernel_name = 'parallel_sum__sliding_local_dilated__swiglu_ffn__prompt'

def setup_inputs():

    _w = (lambda a: (lambda t: t.to(torch.bfloat16) if t.is_floating_point() else t)(torch.as_tensor(a)))
    def _A_setup():
        B, S, D = 1, 2048, 576
        return {
            "x": _w((lambda *s: torch.randn(*s, dtype=torch.bfloat16) * 0.05)(B, S, D)),
            "wqkv": _w((lambda *s: torch.randn(*s, dtype=torch.bfloat16) * 0.1)(D, 3 * D)),
            "wo": _w((lambda *s: torch.randn(*s, dtype=torch.bfloat16) * 0.05)(D, D)),
        }
    _A_in = _A_setup()

    def _B_setup():
        B, S, D, F = 1, 2048, 576, 4608
        return {
            "x": _w((lambda *s: torch.randn(*s, dtype=torch.bfloat16) * 0.05)(B, S, D)),
            "w_gate": _w((lambda *s: torch.randn(*s, dtype=torch.bfloat16) * 0.05)(D, F)),
            "w_up": _w((lambda *s: torch.randn(*s, dtype=torch.bfloat16) * 0.05)(D, F)),
            "w_down": _w((lambda *s: torch.randn(*s, dtype=torch.bfloat16) * 0.05)(F, D)),
        }
    _B_in = _B_setup()

    return {
        "A_x": _A_in["x"],
        "A_wqkv": _A_in["wqkv"],
        "A_wo": _A_in["wo"],
        "B_x": _B_in["x"],
        "B_w_gate": _B_in["w_gate"],
        "B_w_up": _B_in["w_up"],
        "B_w_down": _B_in["w_down"],
    }

def reference(A_x, A_wqkv, A_wo, B_x, B_w_gate, B_w_up, B_w_down):
    def _A_ref(x, wqkv, wo):
        B, S, D = x.shape
        H = 32; Dh = D // H
        W, dil = 8, 2
        qkv = (lambda x, *d: x.permute(*d))((x @ wqkv).reshape(B, S, 3, H, Dh), 2, 0, 3, 1, 4)
        q, k, v = qkv[0], qkv[1], qkv[2]
        scale = Dh ** -0.5
        pos = torch.arange(S)
        off = torch.arange(W) * dil
        idx = pos[:, None] - off[None, :]
        mask = idx >= 0
        idx_c = torch.where(mask, idx, 0).reshape(-1)
        kg = k[:, :, idx_c, :].reshape(B, H, S, W, Dh)
        vg = v[:, :, idx_c, :].reshape(B, H, S, W, Dh)
        logits = torch.einsum("bhsd,bhswd->bhsw", q, kg) * scale
        logits = torch.where(mask[None, None, :, :], logits, -1e9)
        attn = _softmax(logits, axis=-1)
        o = torch.einsum("bhsw,bhswd->bhsd", attn, vg)
        return (lambda x, *d: x.permute(*d))(o, 0, 2, 1, 3).reshape(B, S, D) @ wo

    def _B_ref(x, w_gate, w_up, w_down):
        g = _silu(x @ w_gate)
        u = x @ w_up
        return (g * u) @ w_down

    x = A_x
    xn = _layernorm(x, axis=-1)
    return x + _A_ref(xn, A_wqkv, A_wo) + _B_ref(xn, B_w_gate, B_w_up, B_w_down)
```

```asm
; @launch grid=(256,1,1) block=(256,1,1) lds=163840
.amdgcn_target "amdgcn-amd-amdhsa--gfx950"
.text
.globl parallel_sum__sliding_local_dilated__swiglu_ffn__prompt_kernel
.p2align 8
.type parallel_sum__sliding_local_dilated__swiglu_ffn__prompt_kernel,@function
parallel_sum__sliding_local_dilated__swiglu_ffn__prompt_kernel:
s_cmp_ge_u32 s2, 256
s_cbranch_scc1 L_main_end
s_getpc_b64 s[96:97]
L_pc0:
v_lshlrev_b32 v223, 7, v0
global_load_dword v211, v223, s[96:97]
s_load_dwordx4 s[36:39], s[0:1], 0
s_load_dwordx2 s[40:41], s[0:1], 16
s_load_dwordx4 s[44:47], s[0:1], 32
s_load_dwordx2 s[42:43], s[0:1], 48
s_load_dwordx2 s[48:49], s[0:1], 72
s_load_dwordx2 s[58:59], s[0:1], 56
v_lshrrev_b32 v4, 6, v0
v_and_b32 v1, 63, v0
v_and_b32 v2, 15, v0
v_readfirstlane_b32 s50, v4
v_bfe_u32 v3, v0, 4, 2
s_and_b32 s54, s2, 7
s_lshl_b32 s54, s54, 1
s_lshr_b32 s3, s2, 3
s_and_b32 s3, s3, 1
s_add_u32 s54, s54, s3
s_lshr_b32 s53, s2, 4
s_lshl_b32 s55, s53, 7
v_lshrrev_b32 v5, 3, v1
v_and_b32 v6, 7, v1
s_lshr_b32 s51, s50, 1
s_and_b32 s52, s50, 1
s_lshl_b32 s3, s50, 5
s_add_u32 s3, s3, s55
v_add_u32 v4, s3, v5
v_mul_u32_u24 v4, 1152, v4
v_lshl_add_u32 v4, v6, 4, v4
s_movk_i32 s61, 9216
s_movk_i32 s62, 18432
s_movk_i32 s63, 27648
s_mov_b32 s56, 0x00003f80
s_mov_b32 s57, 0x3f800000
s_waitcnt lgkmcnt(0)
s_mov_b32 s8, s36
s_mov_b32 s9, s37
s_mov_b32 s10, 2359296
s_mov_b32 s11, 0x20000
buffer_load_dwordx4 v[48:51], v4, s[8:11], 0 offen offset:0
buffer_load_dwordx4 v[52:55], v4, s[8:11], 0 offen offset:128
buffer_load_dwordx4 v[56:59], v4, s[8:11], 0 offen offset:256
buffer_load_dwordx4 v[60:63], v4, s[8:11], 0 offen offset:384
buffer_load_dwordx4 v[64:67], v4, s[8:11], 0 offen offset:512
buffer_load_dwordx4 v[68:71], v4, s[8:11], 0 offen offset:640
buffer_load_dwordx4 v[72:75], v4, s[8:11], 0 offen offset:768
buffer_load_dwordx4 v[76:79], v4, s[8:11], 0 offen offset:896
buffer_load_dwordx4 v[80:83], v4, s[8:11], 0 offen offset:1024
buffer_load_dwordx4 v[84:87], v4, s[8:11], s61 offen offset:0
buffer_load_dwordx4 v[88:91], v4, s[8:11], s61 offen offset:128
buffer_load_dwordx4 v[92:95], v4, s[8:11], s61 offen offset:256
buffer_load_dwordx4 v[96:99], v4, s[8:11], s61 offen offset:384
buffer_load_dwordx4 v[100:103], v4, s[8:11], s61 offen offset:512
buffer_load_dwordx4 v[104:107], v4, s[8:11], s61 offen offset:640
buffer_load_dwordx4 v[108:111], v4, s[8:11], s61 offen offset:768
buffer_load_dwordx4 v[112:115], v4, s[8:11], s61 offen offset:896
buffer_load_dwordx4 v[116:119], v4, s[8:11], s61 offen offset:1024
s_lshl_b32 s3, s50, 2
s_add_u32 s3, s3, s55
s_sub_u32 s3, s3, 16
v_add_u32 v7, s3, v3
v_mul_i32_i24 v7, 1152, v7
v_lshl_add_u32 v7, v2, 4, v7
v_cmp_gt_u32 vcc, 8, v2
v_mov_b32 v9, 0x40000000
s_nop 0
v_cndmask_b32 v8, v9, v7, vcc
v_mov_b32 v223, v8
s_mov_b32 s12, s38
s_mov_b32 s13, s39
s_mov_b32 s14, 1990656
s_mov_b32 s15, 0x20000
buffer_load_dwordx4 v[192:195], v7, s[8:11], 0 offen offset:0
s_mov_b32 s16, s40
s_mov_b32 s17, s41
s_mov_b32 s18, 663552
s_mov_b32 s19, 0x20000
buffer_load_dwordx4 v[196:199], v7, s[8:11], 0 offen offset:256
s_mov_b32 s24, s42
s_mov_b32 s25, s43
s_mov_b32 s26, 5308416
s_mov_b32 s27, 0x20000
buffer_load_dwordx4 v[200:203], v7, s[8:11], 0 offen offset:512
s_mov_b32 s28, s48
s_mov_b32 s29, s49
s_mov_b32 s30, 268435456
s_mov_b32 s31, 0x20000
buffer_load_dwordx4 v[204:207], v7, s[8:11], 0 offen offset:768
s_cmp_ge_u32 s50, 2
s_cselect_b32 s20, s46, s44
s_cselect_b32 s21, s47, s45
s_mov_b32 s22, 5308416
buffer_load_dwordx4 v[208:211], v223, s[8:11], 0 offen offset:1024
s_mov_b32 s23, 0x20000
s_mov_b32 s44, s58
s_mov_b32 s45, s59
s_mov_b32 s46, 2359296
buffer_load_dwordx4 v[120:123], v4, s[8:11], s62 offen offset:0
s_mov_b32 s47, 0x20000
s_lshr_b32 s94, s50, 1
s_mul_i32 s73, s94, 12288
s_and_b32 s94, s50, 1
buffer_load_dwordx4 v[124:127], v4, s[8:11], s62 offen offset:128
s_mul_i32 s95, s94, 6144
s_add_u32 s73, s73, s95
s_mul_i32 s95, s94, 442368
v_lshrrev_b32 v8, 3, v1
buffer_load_dwordx4 v[128:131], v4, s[8:11], s62 offen offset:256
v_and_b32 v9, 7, v1
v_and_b32 v10, 2, v8
v_xor_b32 v9, v9, v10
v_mul_u32_u24 v8, 9216, v8
buffer_load_dwordx4 v[132:135], v4, s[8:11], s62 offen offset:384
v_add_u32 v8, s95, v8
v_xor_b32 v10, 4, v9
v_lshl_add_u32 v9, v9, 4, v8
v_lshl_add_u32 v10, v10, 4, v8
buffer_load_dwordx4 v[136:139], v4, s[8:11], s62 offen offset:512
v_add_u32 v224, 0, v9
v_add_u32 v225, 72704, v10
v_add_u32 v226, 145408, v9
v_add_u32 v227, 218112, v10
buffer_load_dwordx4 v[140:143], v4, s[8:11], s62 offen offset:640
v_add_u32 v228, 294912, v9
v_add_u32 v229, 367616, v10
s_mul_i32 s74, s54, 576
s_and_b32 s94, s54, 1
buffer_load_dwordx4 v[144:147], v4, s[8:11], s62 offen offset:768
s_lshl_b32 s95, s94, 6
s_add_u32 s75, s74, 512
s_cmp_eq_u32 s94, 1
s_cselect_b32 s75, s74, s75
buffer_load_dwordx4 v[148:151], v4, s[8:11], s62 offen offset:896
s_add_u32 s74, s74, s95
s_add_u32 s32, s20, s74
s_addc_u32 s33, s21, 0
s_add_u32 s34, s20, s75
buffer_load_dwordx4 v[152:155], v4, s[8:11], s62 offen offset:1024
s_addc_u32 s35, s21, 0
v_mov_b32 v8, 0
v_lshlrev_b32 v9, 2, v1
v_add_u32 v9, 159744, v9
buffer_load_dwordx4 v[156:159], v4, s[8:11], s63 offen offset:0
ds_write_b32 v9, v8 offset:1280
v_lshrrev_b32 v8, 2, v6
v_and_b32 v9, 3, v6
v_lshlrev_b32 v8, 10, v8
buffer_load_dwordx4 v[160:163], v4, s[8:11], s63 offen offset:128
v_lshl_add_u32 v8, v9, 8, v8
v_xor_b32 v9, v5, v6
v_lshl_add_u32 v10, v9, 4, v8
v_add_u32 v11, 128, v10
buffer_load_dwordx4 v[164:167], v4, s[8:11], s63 offen offset:256
s_mul_i32 s3, s50, 18432
s_add_u32 s3, s3, 49152
v_add_u32 v212, s3, v10
v_add_u32 v213, s3, v11
buffer_load_dwordx4 v[168:171], v4, s[8:11], s63 offen offset:384
s_cmp_eq_u32 s50, 1
s_cselect_b32 s3, 141312, s3
v_add_u32 v214, s3, v10
v_add_u32 v215, s3, v11
buffer_load_dwordx4 v[172:175], v4, s[8:11], s63 offen offset:512
s_lshl_b32 s3, s50, 5
s_add_u32 s3, s3, 16
v_add_u32 v216, s3, v5
v_lshlrev_b32 v216, 2, v216
buffer_load_dwordx4 v[176:179], v4, s[8:11], s63 offen offset:640
v_add_u32 v216, 159744, v216
s_lshl_b32 s3, s50, 2
v_add_u32 v8, s3, v3
v_and_b32 v9, 7, v2
buffer_load_dwordx4 v[180:183], v4, s[8:11], s63 offen offset:768
v_xor_b32 v9, v8, v9
v_lshrrev_b32 v10, 2, v2
v_and_b32 v11, 3, v2
v_lshlrev_b32 v10, 10, v10
buffer_load_dwordx4 v[184:187], v4, s[8:11], s63 offen offset:896
v_lshl_add_u32 v10, v11, 8, v10
v_lshl_add_u32 v10, v9, 4, v10
v_add_u32 v217, 122880, v10
v_add_u32 v9, 16384, v217
buffer_load_dwordx4 v[188:191], v4, s[8:11], s63 offen offset:1024
v_lshlrev_b32 v10, 4, v1
v_add_u32 v10, 161280, v10
v_cmp_gt_u32 vcc, 8, v2
s_nop 1
v_cndmask_b32 v218, v10, v9, vcc
v_lshlrev_b32 v219, 2, v8
v_add_u32 v219, 159744, v219
v_mov_b32 v220, 0x3f803f80
v_xor_b32 v8, v2, v3
v_lshlrev_b32 v9, 8, v3
v_lshl_add_u32 v221, v8, 4, v9
v_xor_b32 v222, 64, v221
s_waitcnt vmcnt(32)
v_dot2_f32_bf16 v244, v48, v220, 0
v_dot2_f32_bf16 v248, v48, v48, 0
v_dot2_f32_bf16 v245, v49, v220, 0
v_dot2_f32_bf16 v249, v49, v49, 0
v_dot2_f32_bf16 v246, v50, v220, 0
v_dot2_f32_bf16 v250, v50, v50, 0
v_dot2_f32_bf16 v247, v51, v220, 0
v_dot2_f32_bf16 v251, v51, v51, 0
v_dot2c_f32_bf16 v244, v52, v220
v_dot2c_f32_bf16 v248, v52, v52
v_dot2c_f32_bf16 v245, v53, v220
v_dot2c_f32_bf16 v249, v53, v53
v_dot2c_f32_bf16 v246, v54, v220
v_dot2c_f32_bf16 v250, v54, v54
v_dot2c_f32_bf16 v247, v55, v220
v_dot2c_f32_bf16 v251, v55, v55
s_add_u32 s4, s32, 0
s_addc_u32 s5, s33, 0
v_dot2c_f32_bf16 v244, v56, v220
v_dot2c_f32_bf16 v248, v56, v56
v_dot2c_f32_bf16 v245, v57, v220
v_dot2c_f32_bf16 v249, v57, v57
v_dot2c_f32_bf16 v246, v58, v220
v_dot2c_f32_bf16 v250, v58, v58
v_dot2c_f32_bf16 v247, v59, v220
v_dot2c_f32_bf16 v251, v59, v59
v_dot2c_f32_bf16 v244, v60, v220
v_dot2c_f32_bf16 v248, v60, v60
v_dot2c_f32_bf16 v245, v61, v220
v_dot2c_f32_bf16 v249, v61, v61
v_dot2c_f32_bf16 v246, v62, v220
v_dot2c_f32_bf16 v250, v62, v62
v_dot2c_f32_bf16 v247, v63, v220
v_dot2c_f32_bf16 v251, v63, v63
s_add_u32 m0, s73, 0
v_dot2c_f32_bf16 v244, v64, v220
v_dot2c_f32_bf16 v248, v64, v64
v_dot2c_f32_bf16 v245, v65, v220
v_dot2c_f32_bf16 v249, v65, v65
v_dot2c_f32_bf16 v246, v66, v220
v_dot2c_f32_bf16 v250, v66, v66
v_dot2c_f32_bf16 v247, v67, v220
v_dot2c_f32_bf16 v251, v67, v67
v_dot2c_f32_bf16 v244, v68, v220
v_dot2c_f32_bf16 v248, v68, v68
v_dot2c_f32_bf16 v245, v69, v220
v_dot2c_f32_bf16 v249, v69, v69
v_dot2c_f32_bf16 v246, v70, v220
v_dot2c_f32_bf16 v250, v70, v70
v_dot2c_f32_bf16 v247, v71, v220
v_dot2c_f32_bf16 v251, v71, v71
global_load_lds_dwordx4 v224, s[4:5] offset:0
v_dot2c_f32_bf16 v244, v72, v220
v_dot2c_f32_bf16 v248, v72, v72
v_dot2c_f32_bf16 v245, v73, v220
v_dot2c_f32_bf16 v249, v73, v73
v_dot2c_f32_bf16 v246, v74, v220
v_dot2c_f32_bf16 v250, v74, v74
v_dot2c_f32_bf16 v247, v75, v220
v_dot2c_f32_bf16 v251, v75, v75
v_dot2c_f32_bf16 v244, v76, v220
v_dot2c_f32_bf16 v248, v76, v76
v_dot2c_f32_bf16 v245, v77, v220
v_dot2c_f32_bf16 v249, v77, v77
v_dot2c_f32_bf16 v246, v78, v220
v_dot2c_f32_bf16 v250, v78, v78
v_dot2c_f32_bf16 v247, v79, v220
v_dot2c_f32_bf16 v251, v79, v79
global_load_lds_dwordx4 v225, s[4:5] offset:1024
v_dot2c_f32_bf16 v244, v80, v220
v_dot2c_f32_bf16 v248, v80, v80
v_dot2c_f32_bf16 v245, v81, v220
v_dot2c_f32_bf16 v249, v81, v81
v_dot2c_f32_bf16 v246, v82, v220
v_dot2c_f32_bf16 v250, v82, v82
v_dot2c_f32_bf16 v247, v83, v220
v_dot2c_f32_bf16 v251, v83, v83
v_add_f32 v244, v244, v245
v_add_f32 v248, v248, v249
v_add_f32 v246, v246, v247
v_add_f32 v250, v250, v251
v_add_f32 v11, v244, v246
v_add_f32 v13, v248, v250
s_nop 0
v_add_f32_dpp v11, v11, v11 quad_perm:[1,0,3,2] row_mask:0xf bank_mask:0xf
v_add_f32_dpp v13, v13, v13 quad_perm:[1,0,3,2] row_mask:0xf bank_mask:0xf
global_load_lds_dwordx4 v226, s[4:5] offset:2048
v_add_f32_dpp v11, v11, v11 quad_perm:[2,3,0,1] row_mask:0xf bank_mask:0xf
v_add_f32_dpp v13, v13, v13 quad_perm:[2,3,0,1] row_mask:0xf bank_mask:0xf
s_nop 0
v_add_f32_dpp v11, v11, v11 row_half_mirror row_mask:0xf bank_mask:0xf
v_add_f32_dpp v13, v13, v13 row_half_mirror row_mask:0xf bank_mask:0xf
v_mul_f32 v12, 0xbae38e39, v11
v_mul_f32 v14, 0x3ae38e39, v13
v_fma_f32 v14, -v12, v12, v14
v_max_f32 v14, 0, v14
v_add_f32 v14, 0x3727c5ac, v14
v_rsq_f32 v15, v14
s_nop 0
ds_write_b32 v216, v15 offset:0
ds_write_b32 v216, v14 offset:576
v_dot2_f32_bf16 v244, v48, s56, v12
v_dot2_f32_bf16 v245, v48, s57, v12
v_dot2_f32_bf16 v246, v49, s56, v12
v_dot2_f32_bf16 v247, v49, s57, v12
global_load_lds_dwordx4 v227, s[4:5] offset:3072
v_dot2_f32_bf16 v248, v50, s56, v12
v_dot2_f32_bf16 v249, v50, s57, v12
v_cvt_pk_bf16_f32 v48, v244, v245
v_dot2_f32_bf16 v250, v51, s56, v12
v_dot2_f32_bf16 v251, v51, s57, v12
v_cvt_pk_bf16_f32 v49, v246, v247
v_dot2_f32_bf16 v244, v52, s56, v12
v_dot2_f32_bf16 v245, v52, s57, v12
v_cvt_pk_bf16_f32 v50, v248, v249
v_dot2_f32_bf16 v246, v53, s56, v12
v_dot2_f32_bf16 v247, v53, s57, v12
v_cvt_pk_bf16_f32 v51, v250, v251
ds_write_b128 v212, v[48:51] offset:0
v_dot2_f32_bf16 v248, v54, s56, v12
v_dot2_f32_bf16 v249, v54, s57, v12
v_cvt_pk_bf16_f32 v52, v244, v245
s_add_u32 m0, s73, 4096
v_dot2_f32_bf16 v250, v55, s56, v12
v_dot2_f32_bf16 v251, v55, s57, v12
v_cvt_pk_bf16_f32 v53, v246, v247
v_dot2_f32_bf16 v244, v56, s56, v12
v_dot2_f32_bf16 v245, v56, s57, v12
v_cvt_pk_bf16_f32 v54, v248, v249
v_dot2_f32_bf16 v246, v57, s56, v12
v_dot2_f32_bf16 v247, v57, s57, v12
v_cvt_pk_bf16_f32 v55, v250, v251
ds_write_b128 v212, v[52:55] offset:2048
v_dot2_f32_bf16 v248, v58, s56, v12
v_dot2_f32_bf16 v249, v58, s57, v12
v_cvt_pk_bf16_f32 v56, v244, v245
v_dot2_f32_bf16 v250, v59, s56, v12
v_dot2_f32_bf16 v251, v59, s57, v12
v_cvt_pk_bf16_f32 v57, v246, v247
global_load_lds_dwordx4 v228, s[4:5] offset:0
v_dot2_f32_bf16 v244, v60, s56, v12
v_dot2_f32_bf16 v245, v60, s57, v12
v_cvt_pk_bf16_f32 v58, v248, v249
v_dot2_f32_bf16 v246, v61, s56, v12
v_dot2_f32_bf16 v247, v61, s57, v12
v_cvt_pk_bf16_f32 v59, v250, v251
ds_write_b128 v212, v[56:59] offset:4096
v_dot2_f32_bf16 v248, v62, s56, v12
v_dot2_f32_bf16 v249, v62, s57, v12
v_cvt_pk_bf16_f32 v60, v244, v245
v_dot2_f32_bf16 v250, v63, s56, v12
v_dot2_f32_bf16 v251, v63, s57, v12
v_cvt_pk_bf16_f32 v61, v246, v247
v_dot2_f32_bf16 v244, v64, s56, v12
v_dot2_f32_bf16 v245, v64, s57, v12
v_cvt_pk_bf16_f32 v62, v248, v249
global_load_lds_dwordx4 v229, s[4:5] offset:1024
v_dot2_f32_bf16 v246, v65, s56, v12
v_dot2_f32_bf16 v247, v65, s57, v12
v_cvt_pk_bf16_f32 v63, v250, v251
ds_write_b128 v212, v[60:63] offset:6144
v_dot2_f32_bf16 v248, v66, s56, v12
v_dot2_f32_bf16 v249, v66, s57, v12
v_cvt_pk_bf16_f32 v64, v244, v245
v_dot2_f32_bf16 v250, v67, s56, v12
v_dot2_f32_bf16 v251, v67, s57, v12
v_cvt_pk_bf16_f32 v65, v246, v247
v_dot2_f32_bf16 v244, v68, s56, v12
v_dot2_f32_bf16 v245, v68, s57, v12
v_cvt_pk_bf16_f32 v66, v248, v249
v_dot2_f32_bf16 v246, v69, s56, v12
v_dot2_f32_bf16 v247, v69, s57, v12
v_cvt_pk_bf16_f32 v67, v250, v251
s_add_u32 s4, s32, 884736
s_addc_u32 s5, s33, 0
ds_write_b128 v212, v[64:67] offset:8192
v_dot2_f32_bf16 v248, v70, s56, v12
v_dot2_f32_bf16 v249, v70, s57, v12
v_cvt_pk_bf16_f32 v68, v244, v245
v_dot2_f32_bf16 v250, v71, s56, v12
v_dot2_f32_bf16 v251, v71, s57, v12
v_cvt_pk_bf16_f32 v69, v246, v247
v_dot2_f32_bf16 v244, v72, s56, v12
v_dot2_f32_bf16 v245, v72, s57, v12
v_cvt_pk_bf16_f32 v70, v248, v249
v_dot2_f32_bf16 v246, v73, s56, v12
v_dot2_f32_bf16 v247, v73, s57, v12
v_cvt_pk_bf16_f32 v71, v250, v251
ds_write_b128 v212, v[68:71] offset:10240
v_dot2_f32_bf16 v248, v74, s56, v12
v_dot2_f32_bf16 v249, v74, s57, v12
s_add_u32 m0, s73, 24576
v_cvt_pk_bf16_f32 v72, v244, v245
v_dot2_f32_bf16 v250, v75, s56, v12
v_dot2_f32_bf16 v251, v75, s57, v12
v_cvt_pk_bf16_f32 v73, v246, v247
v_dot2_f32_bf16 v244, v76, s56, v12
v_dot2_f32_bf16 v245, v76, s57, v12
v_cvt_pk_bf16_f32 v74, v248, v249
v_dot2_f32_bf16 v246, v77, s56, v12
v_dot2_f32_bf16 v247, v77, s57, v12
v_cvt_pk_bf16_f32 v75, v250, v251
ds_write_b128 v212, v[72:75] offset:12288
v_dot2_f32_bf16 v248, v78, s56, v12
v_dot2_f32_bf16 v249, v78, s57, v12
v_cvt_pk_bf16_f32 v76, v244, v245
v_dot2_f32_bf16 v250, v79, s56, v12
v_dot2_f32_bf16 v251, v79, s57, v12
global_load_lds_dwordx4 v224, s[4:5] offset:0
v_cvt_pk_bf16_f32 v77, v246, v247
v_dot2_f32_bf16 v244, v80, s56, v12
v_dot2_f32_bf16 v245, v80, s57, v12
v_cvt_pk_bf16_f32 v78, v248, v249
v_dot2_f32_bf16 v246, v81, s56, v12
v_dot2_f32_bf16 v247, v81, s57, v12
v_cvt_pk_bf16_f32 v79, v250, v251
ds_write_b128 v212, v[76:79] offset:14336
v_dot2_f32_bf16 v248, v82, s56, v12
v_dot2_f32_bf16 v249, v82, s57, v12
v_cvt_pk_bf16_f32 v80, v244, v245
v_dot2_f32_bf16 v250, v83, s56, v12
v_dot2_f32_bf16 v251, v83, s57, v12
v_cvt_pk_bf16_f32 v81, v246, v247
v_cvt_pk_bf16_f32 v82, v248, v249
s_nop 0
v_cvt_pk_bf16_f32 v83, v250, v251
global_load_lds_dwordx4 v225, s[4:5] offset:1024
ds_write_b128 v212, v[80:83] offset:16384
s_waitcnt vmcnt(31)
v_dot2_f32_bf16 v244, v84, v220, 0
v_dot2_f32_bf16 v248, v84, v84, 0
v_dot2_f32_bf16 v245, v85, v220, 0
v_dot2_f32_bf16 v249, v85, v85, 0
v_dot2_f32_bf16 v246, v86, v220, 0
v_dot2_f32_bf16 v250, v86, v86, 0
v_dot2_f32_bf16 v247, v87, v220, 0
v_dot2_f32_bf16 v251, v87, v87, 0
v_dot2c_f32_bf16 v244, v88, v220
v_dot2c_f32_bf16 v248, v88, v88
v_dot2c_f32_bf16 v245, v89, v220
v_dot2c_f32_bf16 v249, v89, v89
v_dot2c_f32_bf16 v246, v90, v220
v_dot2c_f32_bf16 v250, v90, v90
v_dot2c_f32_bf16 v247, v91, v220
global_load_lds_dwordx4 v226, s[4:5] offset:2048
v_dot2c_f32_bf16 v251, v91, v91
v_dot2c_f32_bf16 v244, v92, v220
v_dot2c_f32_bf16 v248, v92, v92
v_dot2c_f32_bf16 v245, v93, v220
v_dot2c_f32_bf16 v249, v93, v93
v_dot2c_f32_bf16 v246, v94, v220
v_dot2c_f32_bf16 v250, v94, v94
v_dot2c_f32_bf16 v247, v95, v220
v_dot2c_f32_bf16 v251, v95, v95
v_dot2c_f32_bf16 v244, v96, v220
v_dot2c_f32_bf16 v248, v96, v96
v_dot2c_f32_bf16 v245, v97, v220
v_dot2c_f32_bf16 v249, v97, v97
v_dot2c_f32_bf16 v246, v98, v220
v_dot2c_f32_bf16 v250, v98, v98
v_dot2c_f32_bf16 v247, v99, v220
global_load_lds_dwordx4 v227, s[4:5] offset:3072
v_dot2c_f32_bf16 v251, v99, v99
v_dot2c_f32_bf16 v244, v100, v220
v_dot2c_f32_bf16 v248, v100, v100
v_dot2c_f32_bf16 v245, v101, v220
v_dot2c_f32_bf16 v249, v101, v101
v_dot2c_f32_bf16 v246, v102, v220
v_dot2c_f32_bf16 v250, v102, v102
v_dot2c_f32_bf16 v247, v103, v220
v_dot2c_f32_bf16 v251, v103, v103
v_dot2c_f32_bf16 v244, v104, v220
v_dot2c_f32_bf16 v248, v104, v104
v_dot2c_f32_bf16 v245, v105, v220
v_dot2c_f32_bf16 v249, v105, v105
v_dot2c_f32_bf16 v246, v106, v220
v_dot2c_f32_bf16 v250, v106, v106
v_dot2c_f32_bf16 v247, v107, v220
s_add_u32 m0, s73, 28672
v_dot2c_f32_bf16 v251, v107, v107
v_dot2c_f32_bf16 v244, v108, v220
v_dot2c_f32_bf16 v248, v108, v108
v_dot2c_f32_bf16 v245, v109, v220
v_dot2c_f32_bf16 v249, v109, v109
v_dot2c_f32_bf16 v246, v110, v220
v_dot2c_f32_bf16 v250, v110, v110
v_dot2c_f32_bf16 v247, v111, v220
v_dot2c_f32_bf16 v251, v111, v111
v_dot2c_f32_bf16 v244, v112, v220
v_dot2c_f32_bf16 v248, v112, v112
v_dot2c_f32_bf16 v245, v113, v220
v_dot2c_f32_bf16 v249, v113, v113
v_dot2c_f32_bf16 v246, v114, v220
v_dot2c_f32_bf16 v250, v114, v114
v_dot2c_f32_bf16 v247, v115, v220
global_load_lds_dwordx4 v228, s[4:5] offset:0
v_dot2c_f32_bf16 v251, v115, v115
v_dot2c_f32_bf16 v244, v116, v220
v_dot2c_f32_bf16 v248, v116, v116
v_dot2c_f32_bf16 v245, v117, v220
v_dot2c_f32_bf16 v249, v117, v117
v_dot2c_f32_bf16 v246, v118, v220
v_dot2c_f32_bf16 v250, v118, v118
v_dot2c_f32_bf16 v247, v119, v220
v_dot2c_f32_bf16 v251, v119, v119
v_add_f32 v244, v244, v245
v_add_f32 v248, v248, v249
v_add_f32 v246, v246, v247
v_add_f32 v250, v250, v251
v_add_f32 v11, v244, v246
v_add_f32 v13, v248, v250
s_nop 0
v_add_f32_dpp v11, v11, v11 quad_perm:[1,0,3,2] row_mask:0xf bank_mask:0xf
global_load_lds_dwordx4 v229, s[4:5] offset:1024
v_add_f32_dpp v13, v13, v13 quad_perm:[1,0,3,2] row_mask:0xf bank_mask:0xf
v_add_f32_dpp v11, v11, v11 quad_perm:[2,3,0,1] row_mask:0xf bank_mask:0xf
s_nop 0
v_add_f32_dpp v13, v13, v13 quad_perm:[2,3,0,1] row_mask:0xf bank_mask:0xf
v_add_f32_dpp v11, v11, v11 row_half_mirror row_mask:0xf bank_mask:0xf
s_nop 0
v_add_f32_dpp v13, v13, v13 row_half_mirror row_mask:0xf bank_mask:0xf
v_mul_f32 v12, 0xbae38e39, v11
v_mul_f32 v14, 0x3ae38e39, v13
v_fma_f32 v14, -v12, v12, v14
v_max_f32 v14, 0, v14
v_add_f32 v14, 0x3727c5ac, v14
v_rsq_f32 v15, v14
s_nop 0
ds_write_b32 v216, v15 offset:32
ds_write_b32 v216, v14 offset:608
v_dot2_f32_bf16 v244, v84, s56, v12
v_dot2_f32_bf16 v245, v84, s57, v12
v_dot2_f32_bf16 v246, v85, s56, v12
v_dot2_f32_bf16 v247, v85, s57, v12
v_dot2_f32_bf16 v248, v86, s56, v12
v_dot2_f32_bf16 v249, v86, s57, v12
v_cvt_pk_bf16_f32 v84, v244, v245
v_dot2_f32_bf16 v250, v87, s56, v12
v_dot2_f32_bf16 v251, v87, s57, v12
v_cvt_pk_bf16_f32 v85, v246, v247
v_dot2_f32_bf16 v244, v88, s56, v12
v_dot2_f32_bf16 v245, v88, s57, v12
v_cvt_pk_bf16_f32 v86, v248, v249
v_dot2_f32_bf16 v246, v89, s56, v12
v_dot2_f32_bf16 v247, v89, s57, v12
v_cvt_pk_bf16_f32 v87, v250, v251
ds_write_b128 v213, v[84:87] offset:0
v_dot2_f32_bf16 v248, v90, s56, v12
v_dot2_f32_bf16 v249, v90, s57, v12
v_cvt_pk_bf16_f32 v88, v244, v245
v_dot2_f32_bf16 v250, v91, s56, v12
v_dot2_f32_bf16 v251, v91, s57, v12
v_cvt_pk_bf16_f32 v89, v246, v247
v_dot2_f32_bf16 v244, v92, s56, v12
v_dot2_f32_bf16 v245, v92, s57, v12
v_cvt_pk_bf16_f32 v90, v248, v249
v_dot2_f32_bf16 v246, v93, s56, v12
v_dot2_f32_bf16 v247, v93, s57, v12
v_cvt_pk_bf16_f32 v91, v250, v251
ds_write_b128 v213, v[88:91] offset:2048
v_dot2_f32_bf16 v248, v94, s56, v12
v_dot2_f32_bf16 v249, v94, s57, v12
v_cvt_pk_bf16_f32 v92, v244, v245
v_dot2_f32_bf16 v250, v95, s56, v12
v_dot2_f32_bf16 v251, v95, s57, v12
v_cvt_pk_bf16_f32 v93, v246, v247
v_dot2_f32_bf16 v244, v96, s56, v12
v_dot2_f32_bf16 v245, v96, s57, v12
v_cvt_pk_bf16_f32 v94, v248, v249
v_dot2_f32_bf16 v246, v97, s56, v12
v_dot2_f32_bf16 v247, v97, s57, v12
v_cvt_pk_bf16_f32 v95, v250, v251
ds_write_b128 v213, v[92:95] offset:4096
v_dot2_f32_bf16 v248, v98, s56, v12
v_dot2_f32_bf16 v249, v98, s57, v12
v_cvt_pk_bf16_f32 v96, v244, v245
v_dot2_f32_bf16 v250, v99, s56, v12
v_dot2_f32_bf16 v251, v99, s57, v12
v_cvt_pk_bf16_f32 v97, v246, v247
v_dot2_f32_bf16 v244, v100, s56, v12
v_dot2_f32_bf16 v245, v100, s57, v12
v_cvt_pk_bf16_f32 v98, v248, v249
v_dot2_f32_bf16 v246, v101, s56, v12
v_dot2_f32_bf16 v247, v101, s57, v12
v_cvt_pk_bf16_f32 v99, v250, v251
ds_write_b128 v213, v[96:99] offset:6144
v_dot2_f32_bf16 v248, v102, s56, v12
v_dot2_f32_bf16 v249, v102, s57, v12
v_cvt_pk_bf16_f32 v100, v244, v245
v_dot2_f32_bf16 v250, v103, s56, v12
v_dot2_f32_bf16 v251, v103, s57, v12
v_cvt_pk_bf16_f32 v101, v246, v247
v_dot2_f32_bf16 v244, v104, s56, v12
v_dot2_f32_bf16 v245, v104, s57, v12
v_cvt_pk_bf16_f32 v102, v248, v249
v_dot2_f32_bf16 v246, v105, s56, v12
v_dot2_f32_bf16 v247, v105, s57, v12
v_cvt_pk_bf16_f32 v103, v250, v251
ds_write_b128 v213, v[100:103] offset:8192
v_dot2_f32_bf16 v248, v106, s56, v12
v_dot2_f32_bf16 v249, v106, s57, v12
v_cvt_pk_bf16_f32 v104, v244, v245
v_dot2_f32_bf16 v250, v107, s56, v12
v_dot2_f32_bf16 v251, v107, s57, v12
v_cvt_pk_bf16_f32 v105, v246, v247
v_dot2_f32_bf16 v244, v108, s56, v12
v_dot2_f32_bf16 v245, v108, s57, v12
v_cvt_pk_bf16_f32 v106, v248, v249
v_dot2_f32_bf16 v246, v109, s56, v12
v_dot2_f32_bf16 v247, v109, s57, v12
v_cvt_pk_bf16_f32 v107, v250, v251
ds_write_b128 v213, v[104:107] offset:10240
v_dot2_f32_bf16 v248, v110, s56, v12
v_dot2_f32_bf16 v249, v110, s57, v12
v_cvt_pk_bf16_f32 v108, v244, v245
v_dot2_f32_bf16 v250, v111, s56, v12
v_dot2_f32_bf16 v251, v111, s57, v12
v_cvt_pk_bf16_f32 v109, v246, v247
v_dot2_f32_bf16 v244, v112, s56, v12
v_dot2_f32_bf16 v245, v112, s57, v12
v_cvt_pk_bf16_f32 v110, v248, v249
v_dot2_f32_bf16 v246, v113, s56, v12
v_dot2_f32_bf16 v247, v113, s57, v12
v_cvt_pk_bf16_f32 v111, v250, v251
ds_write_b128 v213, v[108:111] offset:12288
v_dot2_f32_bf16 v248, v114, s56, v12
v_dot2_f32_bf16 v249, v114, s57, v12
v_cvt_pk_bf16_f32 v112, v244, v245
v_dot2_f32_bf16 v250, v115, s56, v12
v_dot2_f32_bf16 v251, v115, s57, v12
v_cvt_pk_bf16_f32 v113, v246, v247
v_dot2_f32_bf16 v244, v116, s56, v12
v_dot2_f32_bf16 v245, v116, s57, v12
v_cvt_pk_bf16_f32 v114, v248, v249
v_dot2_f32_bf16 v246, v117, s56, v12
v_dot2_f32_bf16 v247, v117, s57, v12
v_cvt_pk_bf16_f32 v115, v250, v251
ds_write_b128 v213, v[112:115] offset:14336
v_dot2_f32_bf16 v248, v118, s56, v12
v_dot2_f32_bf16 v249, v118, s57, v12
v_cvt_pk_bf16_f32 v116, v244, v245
v_dot2_f32_bf16 v250, v119, s56, v12
v_dot2_f32_bf16 v251, v119, s57, v12
v_cvt_pk_bf16_f32 v117, v246, v247
v_cvt_pk_bf16_f32 v118, v248, v249
s_nop 0
v_cvt_pk_bf16_f32 v119, v250, v251
ds_write_b128 v213, v[116:119] offset:16384
s_waitcnt vmcnt(30)
v_dot2_f32_bf16 v244, v192, v220, 0
v_dot2_f32_bf16 v248, v192, v192, 0
s_lshr_b32 s94, s2, 3
v_dot2_f32_bf16 v245, v193, v220, 0
v_dot2_f32_bf16 v249, v193, v193, 0
s_and_b32 s95, s2, 7
v_dot2_f32_bf16 v246, v194, v220, 0
v_dot2_f32_bf16 v250, v194, v194, 0
v_mul_u32_u24 v7, 57, v1
v_dot2_f32_bf16 v247, v195, v220, 0
v_dot2_f32_bf16 v251, v195, v195, 0
v_lshrrev_b32 v7, 9, v7
v_dot2c_f32_bf16 v244, v196, v220
v_dot2c_f32_bf16 v248, v196, v196
v_mul_u32_u24 v8, 9, v7
v_dot2c_f32_bf16 v245, v197, v220
v_dot2c_f32_bf16 v249, v197, v197
v_sub_u32 v8, v1, v8
v_dot2c_f32_bf16 v246, v198, v220
v_dot2c_f32_bf16 v250, v198, v198
v_mul_u32_u24 v7, 9216, v7
v_dot2c_f32_bf16 v247, v199, v220
v_dot2c_f32_bf16 v251, v199, v199
v_lshl_add_u32 v7, v8, 7, v7
v_dot2c_f32_bf16 v244, v200, v220
v_dot2c_f32_bf16 v248, v200, v200
s_mul_i32 s96, s94, 18
v_dot2c_f32_bf16 v245, v201, v220
v_dot2c_f32_bf16 v249, v201, v201
s_and_b32 s97, s50, 1
v_dot2c_f32_bf16 v246, v202, v220
v_dot2c_f32_bf16 v250, v202, v202
s_mul_i32 s97, s97, 9
v_dot2c_f32_bf16 v247, v203, v220
v_dot2c_f32_bf16 v251, v203, v203
s_add_u32 s96, s96, s97
v_dot2c_f32_bf16 v244, v204, v220
v_dot2c_f32_bf16 v248, v204, v204
s_mul_i32 s96, s96, 9216
v_dot2c_f32_bf16 v245, v205, v220
v_dot2c_f32_bf16 v249, v205, v205
s_mul_i32 s97, s95, 1152
v_dot2c_f32_bf16 v246, v206, v220
v_dot2c_f32_bf16 v250, v206, v206
s_add_u32 s96, s96, s97
v_dot2c_f32_bf16 v247, v207, v220
v_dot2c_f32_bf16 v251, v207, v207
buffer_load_dword v223, v7, s[20:23], s96 offen
v_dot2c_f32_bf16 v244, v208, v220
v_dot2c_f32_bf16 v248, v208, v208
v_add_u32 v8, 64, v1
v_dot2c_f32_bf16 v245, v209, v220
v_dot2c_f32_bf16 v249, v209, v209
v_min_u32 v8, 80, v8
v_dot2c_f32_bf16 v246, v210, v220
v_dot2c_f32_bf16 v250, v210, v210
v_mul_u32_u24 v7, 57, v8
v_dot2c_f32_bf16 v247, v211, v220
v_dot2c_f32_bf16 v251, v211, v211
v_lshrrev_b32 v7, 9, v7
v_add_f32 v244, v244, v245
v_add_f32 v248, v248, v249
v_mul_u32_u24 v10, 9, v7
v_add_f32 v246, v246, v247
v_add_f32 v250, v250, v251
v_sub_u32 v8, v8, v10
v_add_f32 v11, v244, v246
v_add_f32 v13, v248, v250
v_mul_u32_u24 v7, 9216, v7
v_add_f32_dpp v11, v11, v11 row_ror:1 row_mask:0xf bank_mask:0xf
v_add_f32_dpp v13, v13, v13 row_ror:1 row_mask:0xf bank_mask:0xf
v_lshl_add_u32 v7, v8, 7, v7
v_add_f32_dpp v11, v11, v11 row_ror:2 row_mask:0xf bank_mask:0xf
v_add_f32_dpp v13, v13, v13 row_ror:2 row_mask:0xf bank_mask:0xf
buffer_load_dword v223, v7, s[20:23], s96 offen
v_add_f32_dpp v11, v11, v11 row_ror:4 row_mask:0xf bank_mask:0xf
v_add_f32_dpp v13, v13, v13 row_ror:4 row_mask:0xf bank_mask:0xf
s_getpc_b64 s[96:97]
L_pc:
v_add_f32_dpp v11, v11, v11 row_ror:8 row_mask:0xf bank_mask:0xf
v_add_f32_dpp v13, v13, v13 row_ror:8 row_mask:0xf bank_mask:0xf
s_lshr_b32 s94, s2, 3
v_mul_f32 v12, 0xbae38e39, v11
v_mul_f32 v14, 0x3ae38e39, v13
s_lshl_b32 s94, s94, 2
v_fma_f32 v14, -v12, v12, v14
v_max_f32 v14, 0, v14
s_add_u32 s94, s94, s50
v_add_f32 v14, 0x3727c5ac, v14
v_rsq_f32 v15, v14
s_lshl_b32 s94, s94, 8
ds_write_b32 v219, v15 offset:0
ds_write_b32 v219, v14 offset:576
s_add_u32 s94, s94, 24576
v_dot2_f32_bf16 v244, v192, s56, v12
v_dot2_f32_bf16 v245, v192, s57, v12
v_min_u32 v7, 1, v1
v_dot2_f32_bf16 v246, v193, s56, v12
v_dot2_f32_bf16 v247, v193, s57, v12
v_lshlrev_b32 v7, 7, v7
v_dot2_f32_bf16 v248, v194, s56, v12
v_dot2_f32_bf16 v249, v194, s57, v12
v_add_u32 v7, s94, v7
v_cvt_pk_bf16_f32 v192, v244, v245
v_dot2_f32_bf16 v250, v195, s56, v12
v_min_u32 v7, L_main_end-L_pc, v7
v_dot2_f32_bf16 v251, v195, s57, v12
v_cvt_pk_bf16_f32 v193, v246, v247
global_load_dword v223, v7, s[96:97]
v_dot2_f32_bf16 v244, v196, s56, v12
v_dot2_f32_bf16 v245, v196, s57, v12
v_cvt_pk_bf16_f32 v194, v248, v249
v_dot2_f32_bf16 v246, v197, s56, v12
v_dot2_f32_bf16 v247, v197, s57, v12
v_cvt_pk_bf16_f32 v195, v250, v251
ds_write_b128 v217, v[192:195] offset:0
v_dot2_f32_bf16 v248, v198, s56, v12
v_dot2_f32_bf16 v249, v198, s57, v12
v_cvt_pk_bf16_f32 v196, v244, v245
v_dot2_f32_bf16 v250, v199, s56, v12
v_dot2_f32_bf16 v251, v199, s57, v12
v_cvt_pk_bf16_f32 v197, v246, v247
v_dot2_f32_bf16 v244, v200, s56, v12
v_dot2_f32_bf16 v245, v200, s57, v12
v_cvt_pk_bf16_f32 v198, v248, v249
v_dot2_f32_bf16 v246, v201, s56, v12
v_dot2_f32_bf16 v247, v201, s57, v12
v_cvt_pk_bf16_f32 v199, v250, v251
ds_write_b128 v217, v[196:199] offset:4096
v_dot2_f32_bf16 v248, v202, s56, v12
v_dot2_f32_bf16 v249, v202, s57, v12
v_cvt_pk_bf16_f32 v200, v244, v245
v_dot2_f32_bf16 v250, v203, s56, v12
v_dot2_f32_bf16 v251, v203, s57, v12
v_cvt_pk_bf16_f32 v201, v246, v247
v_dot2_f32_bf16 v244, v204, s56, v12
v_dot2_f32_bf16 v245, v204, s57, v12
v_cvt_pk_bf16_f32 v202, v248, v249
v_dot2_f32_bf16 v246, v205, s56, v12
v_dot2_f32_bf16 v247, v205, s57, v12
v_cvt_pk_bf16_f32 v203, v250, v251
ds_write_b128 v217, v[200:203] offset:8192
v_dot2_f32_bf16 v248, v206, s56, v12
v_dot2_f32_bf16 v249, v206, s57, v12
v_cvt_pk_bf16_f32 v204, v244, v245
v_dot2_f32_bf16 v250, v207, s56, v12
v_dot2_f32_bf16 v251, v207, s57, v12
v_cvt_pk_bf16_f32 v205, v246, v247
v_dot2_f32_bf16 v244, v208, s56, v12
v_dot2_f32_bf16 v245, v208, s57, v12
v_cvt_pk_bf16_f32 v206, v248, v249
v_dot2_f32_bf16 v246, v209, s56, v12
v_dot2_f32_bf16 v247, v209, s57, v12
v_cvt_pk_bf16_f32 v207, v250, v251
ds_write_b128 v217, v[204:207] offset:12288
v_dot2_f32_bf16 v248, v210, s56, v12
v_dot2_f32_bf16 v249, v210, s57, v12
v_cvt_pk_bf16_f32 v208, v244, v245
v_dot2_f32_bf16 v250, v211, s56, v12
v_dot2_f32_bf16 v251, v211, s57, v12
v_cvt_pk_bf16_f32 v209, v246, v247
v_cvt_pk_bf16_f32 v210, v248, v249
s_nop 0
v_cvt_pk_bf16_f32 v211, v250, v251
ds_write_b128 v218, v[208:211]
s_waitcnt lgkmcnt(0)
s_barrier
s_mul_i32 s3, s51, 36864
s_add_u32 s3, s3, 49152
v_add_u32 v7, s3, v221
v_add_u32 v8, s3, v222
s_waitcnt vmcnt(24)
v_dot2_f32_bf16 v244, v120, v220, 0
v_dot2_f32_bf16 v248, v120, v120, 0
v_dot2_f32_bf16 v245, v121, v220, 0
v_dot2_f32_bf16 v249, v121, v121, 0
v_dot2_f32_bf16 v246, v122, v220, 0
v_dot2_f32_bf16 v250, v122, v122, 0
v_dot2_f32_bf16 v247, v123, v220, 0
v_dot2_f32_bf16 v251, v123, v123, 0
ds_read_b128 a[0:3], v7 offset:0
ds_read_b128 a[8:11], v7 offset:18432
v_dot2c_f32_bf16 v244, v124, v220
v_dot2c_f32_bf16 v248, v124, v124
v_dot2c_f32_bf16 v245, v125, v220
v_dot2c_f32_bf16 v249, v125, v125
v_dot2c_f32_bf16 v246, v126, v220
v_dot2c_f32_bf16 v250, v126, v126
v_dot2c_f32_bf16 v247, v127, v220
v_dot2c_f32_bf16 v251, v127, v127
ds_read_b128 a[16:19], v8 offset:1024
ds_read_b128 a[24:27], v8 offset:19456
v_dot2c_f32_bf16 v244, v128, v220
v_dot2c_f32_bf16 v248, v128, v128
v_dot2c_f32_bf16 v245, v129, v220
v_dot2c_f32_bf16 v249, v129, v129
v_dot2c_f32_bf16 v246, v130, v220
v_dot2c_f32_bf16 v250, v130, v130
v_dot2c_f32_bf16 v247, v131, v220
v_dot2c_f32_bf16 v251, v131, v131
ds_read_b128 a[32:35], v7 offset:2048
ds_read_b128 a[40:43], v7 offset:20480
v_dot2c_f32_bf16 v244, v132, v220
v_dot2c_f32_bf16 v248, v132, v132
v_dot2c_f32_bf16 v245, v133, v220
v_dot2c_f32_bf16 v249, v133, v133
v_dot2c_f32_bf16 v246, v134, v220
v_dot2c_f32_bf16 v250, v134, v134
v_dot2c_f32_bf16 v247, v135, v220
v_dot2c_f32_bf16 v251, v135, v135
ds_read_b128 a[48:51], v8 offset:3072
ds_read_b128 a[56:59], v8 offset:21504
v_dot2c_f32_bf16 v244, v136, v220
v_dot2c_f32_bf16 v248, v136, v136
v_dot2c_f32_bf16 v245, v137, v220
v_dot2c_f32_bf16 v249, v137, v137
v_dot2c_f32_bf16 v246, v138, v220
v_dot2c_f32_bf16 v250, v138, v138
v_dot2c_f32_bf16 v247, v139, v220
v_dot2c_f32_bf16 v251, v139, v139
ds_read_b128 a[64:67], v7 offset:4096
ds_read_b128 a[72:75], v7 offset:22528
v_dot2c_f32_bf16 v244, v140, v220
v_dot2c_f32_bf16 v248, v140, v140
v_dot2c_f32_bf16 v245, v141, v220
v_dot2c_f32_bf16 v249, v141, v141
v_dot2c_f32_bf16 v246, v142, v220
v_dot2c_f32_bf16 v250, v142, v142
v_dot2c_f32_bf16 v247, v143, v220
v_dot2c_f32_bf16 v251, v143, v143
ds_read_b128 a[80:83], v8 offset:5120
ds_read_b128 a[88:91], v8 offset:23552
v_dot2c_f32_bf16 v244, v144, v220
v_dot2c_f32_bf16 v248, v144, v144
v_dot2c_f32_bf16 v245, v145, v220
v_dot2c_f32_bf16 v249, v145, v145
v_dot2c_f32_bf16 v246, v146, v220
v_dot2c_f32_bf16 v250, v146, v146
v_dot2c_f32_bf16 v247, v147, v220
v_dot2c_f32_bf16 v251, v147, v147
ds_read_b128 a[96:99], v7 offset:6144
ds_read_b128 a[104:107], v7 offset:24576
v_dot2c_f32_bf16 v244, v148, v220
v_dot2c_f32_bf16 v248, v148, v148
v_dot2c_f32_bf16 v245, v149, v220
v_dot2c_f32_bf16 v249, v149, v149
v_dot2c_f32_bf16 v246, v150, v220
v_dot2c_f32_bf16 v250, v150, v150
v_dot2c_f32_bf16 v247, v151, v220
v_dot2c_f32_bf16 v251, v151, v151
ds_read_b128 a[112:115], v8 offset:7168
ds_read_b128 a[120:123], v8 offset:25600
v_dot2c_f32_bf16 v244, v152, v220
v_dot2c_f32_bf16 v248, v152, v152
v_dot2c_f32_bf16 v245, v153, v220
v_dot2c_f32_bf16 v249, v153, v153
v_dot2c_f32_bf16 v246, v154, v220
v_dot2c_f32_bf16 v250, v154, v154
v_dot2c_f32_bf16 v247, v155, v220
v_dot2c_f32_bf16 v251, v155, v155
ds_read_b128 a[128:131], v7 offset:8192
ds_read_b128 a[136:139], v7 offset:26624
v_add_f32 v244, v244, v245
v_add_f32 v248, v248, v249
v_add_f32 v246, v246, v247
v_add_f32 v250, v250, v251
v_add_f32 v11, v244, v246
v_add_f32 v13, v248, v250
s_nop 0
v_add_f32_dpp v11, v11, v11 quad_perm:[1,0,3,2] row_mask:0xf bank_mask:0xf
v_add_f32_dpp v13, v13, v13 quad_perm:[1,0,3,2] row_mask:0xf bank_mask:0xf
ds_read_b128 a[144:147], v8 offset:9216
v_add_f32_dpp v11, v11, v11 quad_perm:[2,3,0,1] row_mask:0xf bank_mask:0xf
v_add_f32_dpp v13, v13, v13 quad_perm:[2,3,0,1] row_mask:0xf bank_mask:0xf
ds_read_b128 a[152:155], v8 offset:27648
v_add_f32_dpp v11, v11, v11 row_half_mirror row_mask:0xf bank_mask:0xf
v_add_f32_dpp v13, v13, v13 row_half_mirror row_mask:0xf bank_mask:0xf
ds_read_b128 a[160:163], v7 offset:10240
v_mul_f32 v12, 0xbae38e39, v11
v_mul_f32 v14, 0x3ae38e39, v13
v_fma_f32 v14, -v12, v12, v14
v_max_f32 v14, 0, v14
v_add_f32 v14, 0x3727c5ac, v14
v_rsq_f32 v15, v14
s_nop 0
ds_write_b32 v216, v15 offset:64
ds_write_b32 v216, v14 offset:640
v_dot2_f32_bf16 v244, v120, s56, v12
v_dot2_f32_bf16 v245, v120, s57, v12
ds_read_b128 a[168:171], v7 offset:28672
v_dot2_f32_bf16 v246, v121, s56, v12
v_dot2_f32_bf16 v247, v121, s57, v12
v_dot2_f32_bf16 v248, v122, s56, v12
v_dot2_f32_bf16 v249, v122, s57, v12
v_cvt_pk_bf16_f32 v120, v244, v245
ds_read_b128 a[176:179], v8 offset:11264
v_dot2_f32_bf16 v250, v123, s56, v12
v_dot2_f32_bf16 v251, v123, s57, v12
v_cvt_pk_bf16_f32 v121, v246, v247
v_dot2_f32_bf16 v244, v124, s56, v12
v_dot2_f32_bf16 v245, v124, s57, v12
v_cvt_pk_bf16_f32 v122, v248, v249
ds_read_b128 a[184:187], v8 offset:29696
v_dot2_f32_bf16 v246, v125, s56, v12
v_dot2_f32_bf16 v247, v125, s57, v12
v_cvt_pk_bf16_f32 v123, v250, v251
v_dot2_f32_bf16 v248, v126, s56, v12
v_dot2_f32_bf16 v249, v126, s57, v12
v_cvt_pk_bf16_f32 v124, v244, v245
ds_read_b128 a[192:195], v7 offset:12288
v_dot2_f32_bf16 v250, v127, s56, v12
v_dot2_f32_bf16 v251, v127, s57, v12
v_cvt_pk_bf16_f32 v125, v246, v247
v_dot2_f32_bf16 v244, v128, s56, v12
v_dot2_f32_bf16 v245, v128, s57, v12
v_cvt_pk_bf16_f32 v126, v248, v249
ds_read_b128 a[200:203], v7 offset:30720
v_dot2_f32_bf16 v246, v129, s56, v12
v_dot2_f32_bf16 v247, v129, s57, v12
v_cvt_pk_bf16_f32 v127, v250, v251
v_dot2_f32_bf16 v248, v130, s56, v12
v_dot2_f32_bf16 v249, v130, s57, v12
v_cvt_pk_bf16_f32 v128, v244, v245
ds_read_b128 a[208:211], v8 offset:13312
v_dot2_f32_bf16 v250, v131, s56, v12
v_dot2_f32_bf16 v251, v131, s57, v12
v_cvt_pk_bf16_f32 v129, v246, v247
v_dot2_f32_bf16 v244, v132, s56, v12
v_dot2_f32_bf16 v245, v132, s57, v12
v_cvt_pk_bf16_f32 v130, v248, v249
ds_read_b128 a[216:219], v8 offset:31744
v_dot2_f32_bf16 v246, v133, s56, v12
v_dot2_f32_bf16 v247, v133, s57, v12
v_cvt_pk_bf16_f32 v131, v250, v251
v_dot2_f32_bf16 v248, v134, s56, v12
v_dot2_f32_bf16 v249, v134, s57, v12
v_cvt_pk_bf16_f32 v132, v244, v245
ds_read_b128 a[224:227], v7 offset:14336
v_dot2_f32_bf16 v250, v135, s56, v12
v_dot2_f32_bf16 v251, v135, s57, v12
v_cvt_pk_bf16_f32 v133, v246, v247
v_dot2_f32_bf16 v244, v136, s56, v12
v_dot2_f32_bf16 v245, v136, s57, v12
v_cvt_pk_bf16_f32 v134, v248, v249
ds_read_b128 a[232:235], v7 offset:32768
v_dot2_f32_bf16 v246, v137, s56, v12
v_dot2_f32_bf16 v247, v137, s57, v12
v_cvt_pk_bf16_f32 v135, v250, v251
v_dot2_f32_bf16 v248, v138, s56, v12
v_dot2_f32_bf16 v249, v138, s57, v12
v_cvt_pk_bf16_f32 v136, v244, v245
ds_read_b128 a[240:243], v8 offset:15360
v_dot2_f32_bf16 v250, v139, s56, v12
v_dot2_f32_bf16 v251, v139, s57, v12
v_cvt_pk_bf16_f32 v137, v246, v247
v_dot2_f32_bf16 v244, v140, s56, v12
v_dot2_f32_bf16 v245, v140, s57, v12
v_cvt_pk_bf16_f32 v138, v248, v249
ds_read_b128 a[248:251], v8 offset:33792
v_dot2_f32_bf16 v246, v141, s56, v12
v_dot2_f32_bf16 v247, v141, s57, v12
v_cvt_pk_bf16_f32 v139, v250, v251
v_dot2_f32_bf16 v248, v142, s56, v12
v_dot2_f32_bf16 v249, v142, s57, v12
v_cvt_pk_bf16_f32 v140, v244, v245
ds_read_b128 v[16:19], v7 offset:16384
v_dot2_f32_bf16 v250, v143, s56, v12
v_dot2_f32_bf16 v251, v143, s57, v12
v_cvt_pk_bf16_f32 v141, v246, v247
v_dot2_f32_bf16 v244, v144, s56, v12
v_dot2_f32_bf16 v245, v144, s57, v12
v_cvt_pk_bf16_f32 v142, v248, v249
ds_read_b128 v[24:27], v7 offset:34816
v_dot2_f32_bf16 v246, v145, s56, v12
v_dot2_f32_bf16 v247, v145, s57, v12
v_cvt_pk_bf16_f32 v143, v250, v251
v_dot2_f32_bf16 v248, v146, s56, v12
v_dot2_f32_bf16 v249, v146, s57, v12
v_cvt_pk_bf16_f32 v144, v244, v245
ds_read_b128 v[32:35], v8 offset:17408
v_dot2_f32_bf16 v250, v147, s56, v12
v_dot2_f32_bf16 v251, v147, s57, v12
v_cvt_pk_bf16_f32 v145, v246, v247
v_dot2_f32_bf16 v244, v148, s56, v12
v_dot2_f32_bf16 v245, v148, s57, v12
v_cvt_pk_bf16_f32 v146, v248, v249
ds_read_b128 v[40:43], v8 offset:35840
v_dot2_f32_bf16 v246, v149, s56, v12
v_dot2_f32_bf16 v247, v149, s57, v12
v_cvt_pk_bf16_f32 v147, v250, v251
v_dot2_f32_bf16 v248, v150, s56, v12
v_dot2_f32_bf16 v249, v150, s57, v12
v_cvt_pk_bf16_f32 v148, v244, v245
v_dot2_f32_bf16 v250, v151, s56, v12
v_dot2_f32_bf16 v251, v151, s57, v12
v_cvt_pk_bf16_f32 v149, v246, v247
v_dot2_f32_bf16 v244, v152, s56, v12
v_dot2_f32_bf16 v245, v152, s57, v12
v_cvt_pk_bf16_f32 v150, v248, v249
v_dot2_f32_bf16 v246, v153, s56, v12
v_dot2_f32_bf16 v247, v153, s57, v12
v_cvt_pk_bf16_f32 v151, v250, v251
v_dot2_f32_bf16 v248, v154, s56, v12
v_dot2_f32_bf16 v249, v154, s57, v12
v_cvt_pk_bf16_f32 v152, v244, v245
v_dot2_f32_bf16 v250, v155, s56, v12
v_dot2_f32_bf16 v251, v155, s57, v12
v_cvt_pk_bf16_f32 v153, v246, v247
v_cvt_pk_bf16_f32 v154, v248, v249
s_nop 0
v_cvt_pk_bf16_f32 v155, v250, v251
s_waitcnt lgkmcnt(0)
s_barrier
s_waitcnt vmcnt(15)
v_dot2_f32_bf16 v244, v156, v220, 0
v_dot2_f32_bf16 v248, v156, v156, 0
v_dot2_f32_bf16 v245, v157, v220, 0
v_dot2_f32_bf16 v249, v157, v157, 0
v_dot2_f32_bf16 v246, v158, v220, 0
v_dot2_f32_bf16 v250, v158, v158, 0
v_dot2_f32_bf16 v247, v159, v220, 0
v_dot2_f32_bf16 v251, v159, v159, 0
ds_write_b128 v214, v[120:123] offset:0
ds_write_b128 v214, v[124:127] offset:2048
v_dot2c_f32_bf16 v244, v160, v220
v_dot2c_f32_bf16 v248, v160, v160
v_dot2c_f32_bf16 v245, v161, v220
v_dot2c_f32_bf16 v249, v161, v161
v_dot2c_f32_bf16 v246, v162, v220
v_dot2c_f32_bf16 v250, v162, v162
v_dot2c_f32_bf16 v247, v163, v220
v_dot2c_f32_bf16 v251, v163, v163
ds_write_b128 v214, v[128:131] offset:4096
ds_write_b128 v214, v[132:135] offset:6144
v_dot2c_f32_bf16 v244, v164, v220
v_dot2c_f32_bf16 v248, v164, v164
v_dot2c_f32_bf16 v245, v165, v220
v_dot2c_f32_bf16 v249, v165, v165
v_dot2c_f32_bf16 v246, v166, v220
v_dot2c_f32_bf16 v250, v166, v166
v_dot2c_f32_bf16 v247, v167, v220
v_dot2c_f32_bf16 v251, v167, v167
ds_write_b128 v214, v[136:139] offset:8192
ds_write_b128 v214, v[140:143] offset:10240
v_dot2c_f32_bf16 v244, v168, v220
v_dot2c_f32_bf16 v248, v168, v168
v_dot2c_f32_bf16 v245, v169, v220
v_dot2c_f32_bf16 v249, v169, v169
v_dot2c_f32_bf16 v246, v170, v220
v_dot2c_f32_bf16 v250, v170, v170
v_dot2c_f32_bf16 v247, v171, v220
v_dot2c_f32_bf16 v251, v171, v171
ds_write_b128 v214, v[144:147] offset:12288
ds_write_b128 v214, v[148:151] offset:14336
v_dot2c_f32_bf16 v244, v172, v220
v_dot2c_f32_bf16 v248, v172, v172
v_dot2c_f32_bf16 v245, v173, v220
v_dot2c_f32_bf16 v249, v173, v173
v_dot2c_f32_bf16 v246, v174, v220
v_dot2c_f32_bf16 v250, v174, v174
v_dot2c_f32_bf16 v247, v175, v220
v_dot2c_f32_bf16 v251, v175, v175
ds_write_b128 v214, v[152:155] offset:16384
v_dot2c_f32_bf16 v244, v176, v220
v_dot2c_f32_bf16 v248, v176, v176
v_dot2c_f32_bf16 v245, v177, v220
v_dot2c_f32_bf16 v249, v177, v177
v_dot2c_f32_bf16 v246, v178, v220
v_dot2c_f32_bf16 v250, v178, v178
v_dot2c_f32_bf16 v247, v179, v220
v_dot2c_f32_bf16 v251, v179, v179
v_dot2c_f32_bf16 v244, v180, v220
v_dot2c_f32_bf16 v248, v180, v180
v_dot2c_f32_bf16 v245, v181, v220
v_dot2c_f32_bf16 v249, v181, v181
v_dot2c_f32_bf16 v246, v182, v220
v_dot2c_f32_bf16 v250, v182, v182
v_dot2c_f32_bf16 v247, v183, v220
v_dot2c_f32_bf16 v251, v183, v183
v_dot2c_f32_bf16 v244, v184, v220
v_dot2c_f32_bf16 v248, v184, v184
v_dot2c_f32_bf16 v245, v185, v220
v_dot2c_f32_bf16 v249, v185, v185
v_dot2c_f32_bf16 v246, v186, v220
v_dot2c_f32_bf16 v250, v186, v186
v_dot2c_f32_bf16 v247, v187, v220
v_dot2c_f32_bf16 v251, v187, v187
v_dot2c_f32_bf16 v244, v188, v220
v_dot2c_f32_bf16 v248, v188, v188
v_dot2c_f32_bf16 v245, v189, v220
v_dot2c_f32_bf16 v249, v189, v189
v_dot2c_f32_bf16 v246, v190, v220
v_dot2c_f32_bf16 v250, v190, v190
v_dot2c_f32_bf16 v247, v191, v220
v_dot2c_f32_bf16 v251, v191, v191
v_add_f32 v244, v244, v245
v_add_f32 v248, v248, v249
v_add_f32 v246, v246, v247
v_add_f32 v250, v250, v251
v_add_f32 v11, v244, v246
v_add_f32 v13, v248, v250
s_nop 0
v_add_f32_dpp v11, v11, v11 quad_perm:[1,0,3,2] row_mask:0xf bank_mask:0xf
v_add_f32_dpp v13, v13, v13 quad_perm:[1,0,3,2] row_mask:0xf bank_mask:0xf
s_nop 0
v_add_f32_dpp v11, v11, v11 quad_perm:[2,3,0,1] row_mask:0xf bank_mask:0xf
v_add_f32_dpp v13, v13, v13 quad_perm:[2,3,0,1] row_mask:0xf bank_mask:0xf
s_nop 0
v_add_f32_dpp v11, v11, v11 row_half_mirror row_mask:0xf bank_mask:0xf
v_add_f32_dpp v13, v13, v13 row_half_mirror row_mask:0xf bank_mask:0xf
v_mul_f32 v12, 0xbae38e39, v11
v_mul_f32 v14, 0x3ae38e39, v13
v_fma_f32 v14, -v12, v12, v14
v_max_f32 v14, 0, v14
v_add_f32 v14, 0x3727c5ac, v14
v_rsq_f32 v15, v14
s_nop 0
ds_write_b32 v216, v15 offset:96
ds_write_b32 v216, v14 offset:672
v_dot2_f32_bf16 v244, v156, s56, v12
v_dot2_f32_bf16 v245, v156, s57, v12
v_dot2_f32_bf16 v246, v157, s56, v12
v_dot2_f32_bf16 v247, v157, s57, v12
v_dot2_f32_bf16 v248, v158, s56, v12
v_dot2_f32_bf16 v249, v158, s57, v12
v_cvt_pk_bf16_f32 v156, v244, v245
v_dot2_f32_bf16 v250, v159, s56, v12
v_dot2_f32_bf16 v251, v159, s57, v12
v_cvt_pk_bf16_f32 v157, v246, v247
v_dot2_f32_bf16 v244, v160, s56, v12
v_dot2_f32_bf16 v245, v160, s57, v12
v_cvt_pk_bf16_f32 v158, v248, v249
v_dot2_f32_bf16 v246, v161, s56, v12
v_dot2_f32_bf16 v247, v161, s57, v12
v_cvt_pk_bf16_f32 v159, v250, v251
ds_write_b128 v215, v[156:159] offset:0
v_dot2_f32_bf16 v248, v162, s56, v12
v_dot2_f32_bf16 v249, v162, s57, v12
v_cvt_pk_bf16_f32 v160, v244, v245
v_dot2_f32_bf16 v250, v163, s56, v12
v_dot2_f32_bf16 v251, v163, s57, v12
v_cvt_pk_bf16_f32 v161, v246, v247
v_dot2_f32_bf16 v244, v164, s56, v12
v_dot2_f32_bf16 v245, v164, s57, v12
v_cvt_pk_bf16_f32 v162, v248, v249
v_dot2_f32_bf16 v246, v165, s56, v12
v_dot2_f32_bf16 v247, v165, s57, v12
v_cvt_pk_bf16_f32 v163, v250, v251
ds_write_b128 v215, v[160:163] offset:2048
v_dot2_f32_bf16 v248, v166, s56, v12
v_dot2_f32_bf16 v249, v166, s57, v12
v_cvt_pk_bf16_f32 v164, v244, v245
v_dot2_f32_bf16 v250, v167, s56, v12
v_dot2_f32_bf16 v251, v167, s57, v12
v_cvt_pk_bf16_f32 v165, v246, v247
v_dot2_f32_bf16 v244, v168, s56, v12
v_dot2_f32_bf16 v245, v168, s57, v12
v_cvt_pk_bf16_f32 v166, v248, v249
v_dot2_f32_bf16 v246, v169, s56, v12
v_dot2_f32_bf16 v247, v169, s57, v12
v_cvt_pk_bf16_f32 v167, v250, v251
ds_write_b128 v215, v[164:167] offset:4096
v_dot2_f32_bf16 v248, v170, s56, v12
v_dot2_f32_bf16 v249, v170, s57, v12
v_cvt_pk_bf16_f32 v168, v244, v245
v_dot2_f32_bf16 v250, v171, s56, v12
v_dot2_f32_bf16 v251, v171, s57, v12
v_cvt_pk_bf16_f32 v169, v246, v247
v_dot2_f32_bf16 v244, v172, s56, v12
v_dot2_f32_bf16 v245, v172, s57, v12
v_cvt_pk_bf16_f32 v170, v248, v249
v_dot2_f32_bf16 v246, v173, s56, v12
v_dot2_f32_bf16 v247, v173, s57, v12
v_cvt_pk_bf16_f32 v171, v250, v251
ds_write_b128 v215, v[168:171] offset:6144
v_dot2_f32_bf16 v248, v174, s56, v12
v_dot2_f32_bf16 v249, v174, s57, v12
v_cvt_pk_bf16_f32 v172, v244, v245
v_dot2_f32_bf16 v250, v175, s56, v12
v_dot2_f32_bf16 v251, v175, s57, v12
v_cvt_pk_bf16_f32 v173, v246, v247
v_dot2_f32_bf16 v244, v176, s56, v12
v_dot2_f32_bf16 v245, v176, s57, v12
v_cvt_pk_bf16_f32 v174, v248, v249
v_dot2_f32_bf16 v246, v177, s56, v12
v_dot2_f32_bf16 v247, v177, s57, v12
v_cvt_pk_bf16_f32 v175, v250, v251
ds_write_b128 v215, v[172:175] offset:8192
v_dot2_f32_bf16 v248, v178, s56, v12
v_dot2_f32_bf16 v249, v178, s57, v12
v_cvt_pk_bf16_f32 v176, v244, v245
v_dot2_f32_bf16 v250, v179, s56, v12
v_dot2_f32_bf16 v251, v179, s57, v12
v_cvt_pk_bf16_f32 v177, v246, v247
v_dot2_f32_bf16 v244, v180, s56, v12
v_dot2_f32_bf16 v245, v180, s57, v12
v_cvt_pk_bf16_f32 v178, v248, v249
v_dot2_f32_bf16 v246, v181, s56, v12
v_dot2_f32_bf16 v247, v181, s57, v12
v_cvt_pk_bf16_f32 v179, v250, v251
ds_write_b128 v215, v[176:179] offset:10240
v_dot2_f32_bf16 v248, v182, s56, v12
v_dot2_f32_bf16 v249, v182, s57, v12
v_cvt_pk_bf16_f32 v180, v244, v245
v_dot2_f32_bf16 v250, v183, s56, v12
v_dot2_f32_bf16 v251, v183, s57, v12
v_cvt_pk_bf16_f32 v181, v246, v247
v_dot2_f32_bf16 v244, v184, s56, v12
v_dot2_f32_bf16 v245, v184, s57, v12
v_cvt_pk_bf16_f32 v182, v248, v249
v_dot2_f32_bf16 v246, v185, s56, v12
v_dot2_f32_bf16 v247, v185, s57, v12
v_cvt_pk_bf16_f32 v183, v250, v251
ds_write_b128 v215, v[180:183] offset:12288
v_dot2_f32_bf16 v248, v186, s56, v12
v_dot2_f32_bf16 v249, v186, s57, v12
v_cvt_pk_bf16_f32 v184, v244, v245
v_dot2_f32_bf16 v250, v187, s56, v12
v_dot2_f32_bf16 v251, v187, s57, v12
v_cvt_pk_bf16_f32 v185, v246, v247
v_dot2_f32_bf16 v244, v188, s56, v12
v_dot2_f32_bf16 v245, v188, s57, v12
v_cvt_pk_bf16_f32 v186, v248, v249
v_dot2_f32_bf16 v246, v189, s56, v12
v_dot2_f32_bf16 v247, v189, s57, v12
v_cvt_pk_bf16_f32 v187, v250, v251
ds_write_b128 v215, v[184:187] offset:14336
v_dot2_f32_bf16 v248, v190, s56, v12
v_dot2_f32_bf16 v249, v190, s57, v12
v_cvt_pk_bf16_f32 v188, v244, v245
v_dot2_f32_bf16 v250, v191, s56, v12
v_dot2_f32_bf16 v251, v191, s57, v12
v_cvt_pk_bf16_f32 v189, v246, v247
v_cvt_pk_bf16_f32 v190, v248, v249
s_nop 0
v_cvt_pk_bf16_f32 v191, v250, v251
ds_write_b128 v215, v[188:191] offset:16384
s_waitcnt lgkmcnt(0)
s_barrier
s_mov_b32 s3, 141312
s_cmp_eq_u32 s51, 0
s_cselect_b32 s3, s3, 104448
v_add_u32 v9, s3, v221
v_add_u32 v10, s3, v222
s_lshl_b32 s3, s51, 6
s_add_u32 s3, s3, 16
v_add_u32 v11, s3, v2
v_lshlrev_b32 v11, 2, v11
v_add_u32 v11, 159744, v11
ds_read_b32 v236, v11 offset:0
ds_read_b32 v240, v11 offset:576
ds_read_b32 v237, v11 offset:64
ds_read_b32 v241, v11 offset:640
ds_read_b32 v238, v11 offset:128
ds_read_b32 v242, v11 offset:704
ds_read_b32 v239, v11 offset:192
ds_read_b32 v243, v11 offset:768
ds_read_b128 a[4:7], v7 offset:0
ds_read_b128 a[12:15], v9 offset:0
ds_read_b128 a[20:23], v8 offset:1024
ds_read_b128 a[28:31], v10 offset:1024
ds_read_b128 a[36:39], v7 offset:2048
ds_read_b128 a[44:47], v9 offset:2048
ds_read_b128 a[52:55], v8 offset:3072
ds_read_b128 a[60:63], v10 offset:3072
ds_read_b128 a[68:71], v7 offset:4096
ds_read_b128 a[76:79], v9 offset:4096
ds_read_b128 a[84:87], v8 offset:5120
ds_read_b128 a[92:95], v10 offset:5120
ds_read_b128 a[100:103], v7 offset:6144
ds_read_b128 a[108:111], v9 offset:6144
ds_read_b128 a[116:119], v8 offset:7168
ds_read_b128 a[124:127], v10 offset:7168
ds_read_b128 a[132:135], v7 offset:8192
ds_read_b128 a[140:143], v9 offset:8192
ds_read_b128 a[148:151], v8 offset:9216
ds_read_b128 a[156:159], v10 offset:9216
ds_read_b128 a[164:167], v7 offset:10240
ds_read_b128 a[172:175], v9 offset:10240
ds_read_b128 a[180:183], v8 offset:11264
ds_read_b128 a[188:191], v10 offset:11264
ds_read_b128 a[196:199], v7 offset:12288
ds_read_b128 a[204:207], v9 offset:12288
ds_read_b128 a[212:215], v8 offset:13312
ds_read_b128 a[220:223], v10 offset:13312
ds_read_b128 a[228:231], v7 offset:14336
ds_read_b128 a[236:239], v9 offset:14336
ds_read_b128 a[244:247], v8 offset:15360
ds_read_b128 a[252:255], v10 offset:15360
ds_read_b128 v[20:23], v7 offset:16384
ds_read_b128 v[28:31], v9 offset:16384
ds_read_b128 v[36:39], v8 offset:17408
ds_read_b128 v[44:47], v10 offset:17408
v_bfe_u32 v252, v1, 2, 2
v_and_b32 v253, 3, v1
v_lshlrev_b32 v254, 3, v3
v_add_u32 v254, v254, v252
v_lshlrev_b32 v254, 7, v254
v_and_b32 v255, 1, v253
v_lshl_add_u32 v254, v255, 3, v254
v_lshrrev_b32 v253, 1, v253
v_lshl_add_u32 v254, v253, 4, v254
v_lshrrev_b32 v252, 1, v252
v_and_b32 v255, 1, v3
v_lshl_add_u32 v252, v255, 1, v252
s_lshl_b32 s3, s52, 1
v_xor_b32 v253, s3, v252
v_lshl_add_u32 v230, v253, 5, v254
v_add_u32 v231, 49152, v230
v_add_u32 v232, 98304, v230
s_add_u32 s3, s3, 1
v_xor_b32 v253, s3, v252
v_lshl_add_u32 v233, v253, 5, v254
v_add_u32 v234, 49152, v233
v_add_u32 v235, 98304, v233
s_mov_b32 s3, 122880
s_cmp_eq_u32 s51, 0
s_cselect_b32 s3, s3, 141312
v_add_u32 v254, s3, v221
v_add_u32 v255, s3, v222
s_waitcnt lgkmcnt(15)
v_mul_f32 v236, 0xbfb8aa3b, v236
v_mul_f32 v237, 0xbfb8aa3b, v237
v_mul_f32 v238, 0xbfb8aa3b, v238
v_mul_f32 v239, 0xbfb8aa3b, v239
s_waitcnt lgkmcnt(0)
s_barrier
s_add_u32 s4, s32, 1769472
s_addc_u32 s5, s33, 0
s_add_u32 m0, s73, 49152
s_nop 0
global_load_lds_dwordx4 v224, s[4:5] offset:0
global_load_lds_dwordx4 v225, s[4:5] offset:1024
global_load_lds_dwordx4 v226, s[4:5] offset:2048
global_load_lds_dwordx4 v227, s[4:5] offset:3072
s_add_u32 m0, s73, 53248
s_nop 0
global_load_lds_dwordx4 v228, s[4:5] offset:0
global_load_lds_dwordx4 v229, s[4:5] offset:1024
s_waitcnt vmcnt(15)
s_barrier
ds_read_b64_tr_b16 v[176:177], v230 offset:0
ds_read_b64_tr_b16 v[178:179], v230 offset:512
ds_read_b64_tr_b16 v[180:181], v230 offset:12288
ds_read_b64_tr_b16 v[182:183], v230 offset:12800
s_waitcnt lgkmcnt(0)
v_mfma_f32_16x16x32_bf16 v[48:51], v[176:179], a[0:3], 0
ds_read_b64_tr_b16 v[184:185], v233 offset:0
v_bfe_u32 v252, v1, 2, 2
v_mfma_f32_16x16x32_bf16 v[52:55], v[176:179], a[4:7], 0
ds_read_b64_tr_b16 v[186:187], v233 offset:512
v_and_b32 v253, 3, v1
v_mfma_f32_16x16x32_bf16 v[56:59], v[176:179], a[8:11], 0
ds_read_b64_tr_b16 v[188:189], v233 offset:12288
v_lshlrev_b32 v254, 3, v3
v_mfma_f32_16x16x32_bf16 v[60:63], v[176:179], a[12:15], 0
ds_read_b64_tr_b16 v[190:191], v233 offset:12800
v_add_u32 v254, v254, v252
v_mfma_f32_16x16x32_bf16 v[64:67], v[180:183], a[0:3], 0
s_add_u32 s4, s32, 2654208
s_addc_u32 s5, s33, 0
v_mfma_f32_16x16x32_bf16 v[68:71], v[180:183], a[4:7], 0
s_add_u32 m0, s73, 73728
s_nop 0
global_load_lds_dwordx4 v224, s[4:5] offset:0
v_mfma_f32_16x16x32_bf16 v[72:75], v[180:183], a[8:11], 0
v_lshlrev_b32 v254, 7, v254
v_lshrrev_b32 v252, 1, v252
v_mfma_f32_16x16x32_bf16 v[76:79], v[180:183], a[12:15], 0
v_and_b32 v255, 1, v3
v_lshl_add_u32 v252, v255, 1, v252
s_waitcnt lgkmcnt(0)
v_mfma_f32_16x16x32_bf16 v[80:83], v[184:187], a[0:3], 0
ds_read_b64_tr_b16 v[176:177], v230 offset:4096
v_lshlrev_b32 v252, 1, v252
v_mfma_f32_16x16x32_bf16 v[84:87], v[184:187], a[4:7], 0
ds_read_b64_tr_b16 v[178:179], v230 offset:4608
s_mul_i32 s3, s52, 3
v_mfma_f32_16x16x32_bf16 v[88:91], v[184:187], a[8:11], 0
ds_read_b64_tr_b16 v[180:181], v230 offset:16384
v_lshrrev_b32 v255, 1, v253
v_mfma_f32_16x16x32_bf16 v[92:95], v[184:187], a[12:15], 0
ds_read_b64_tr_b16 v[182:183], v230 offset:16896
v_add_u32 v255, s3, v255
v_mfma_f32_16x16x32_bf16 v[96:99], v[188:191], a[0:3], 0
global_load_lds_dwordx4 v225, s[4:5] offset:1024
v_mfma_f32_16x16x32_bf16 v[100:103], v[188:191], a[4:7], 0
global_load_lds_dwordx4 v226, s[4:5] offset:2048
v_mfma_f32_16x16x32_bf16 v[104:107], v[188:191], a[8:11], 0
global_load_lds_dwordx4 v227, s[4:5] offset:3072
v_mfma_f32_16x16x32_bf16 v[108:111], v[188:191], a[12:15], 0
v_xor_b32 v255, v255, v252
v_lshl_add_u32 v12, v255, 4, v254
s_waitcnt lgkmcnt(0)
v_mfma_f32_16x16x32_bf16 v[48:51], v[176:179], a[16:19], v[48:51]
ds_read_b64_tr_b16 v[184:185], v233 offset:4096
v_and_b32 v255, 1, v253
v_mfma_f32_16x16x32_bf16 v[52:55], v[176:179], a[20:23], v[52:55]
ds_read_b64_tr_b16 v[186:187], v233 offset:4608
v_lshl_add_u32 v12, v255, 3, v12
v_mfma_f32_16x16x32_bf16 v[56:59], v[176:179], a[24:27], v[56:59]
ds_read_b64_tr_b16 v[188:189], v233 offset:16384
s_add_u32 s3, s3, 2
v_mfma_f32_16x16x32_bf16 v[60:63], v[176:179], a[28:31], v[60:63]
ds_read_b64_tr_b16 v[190:191], v233 offset:16896
v_xor_b32 v255, s3, v252
v_mfma_f32_16x16x32_bf16 v[64:67], v[180:183], a[16:19], v[64:67]
s_add_u32 m0, s73, 77824
s_nop 0
global_load_lds_dwordx4 v228, s[4:5] offset:0
v_mfma_f32_16x16x32_bf16 v[68:71], v[180:183], a[20:23], v[68:71]
global_load_lds_dwordx4 v229, s[4:5] offset:1024
v_mfma_f32_16x16x32_bf16 v[72:75], v[180:183], a[24:27], v[72:75]
v_lshl_add_u32 v172, v255, 4, v254
v_min_u32 v253, 2, v253
v_mfma_f32_16x16x32_bf16 v[76:79], v[180:183], a[28:31], v[76:79]
v_lshl_add_u32 v172, v253, 12, v172
v_add_u32 v172, 8, v172
s_waitcnt lgkmcnt(0)
v_mfma_f32_16x16x32_bf16 v[80:83], v[184:187], a[16:19], v[80:83]
ds_read_b64_tr_b16 v[176:177], v230 offset:8192
v_add_u32 v13, 49152, v12
v_mfma_f32_16x16x32_bf16 v[84:87], v[184:187], a[20:23], v[84:87]
ds_read_b64_tr_b16 v[178:179], v230 offset:8704
v_add_u32 v14, 98304, v12
v_mfma_f32_16x16x32_bf16 v[88:91], v[184:187], a[24:27], v[88:91]
ds_read_b64_tr_b16 v[180:181], v230 offset:20480
v_add_u32 v173, 49152, v172
v_mfma_f32_16x16x32_bf16 v[92:95], v[184:187], a[28:31], v[92:95]
ds_read_b64_tr_b16 v[182:183], v230 offset:20992
v_add_u32 v174, 98304, v172
v_mfma_f32_16x16x32_bf16 v[96:99], v[188:191], a[16:19], v[96:99]
s_add_u32 s4, s32, 3538944
s_addc_u32 s5, s33, 0
v_mfma_f32_16x16x32_bf16 v[100:103], v[188:191], a[20:23], v[100:103]
s_add_u32 m0, s73, 98304
s_nop 0
global_load_lds_dwordx4 v224, s[4:5] offset:0
v_mfma_f32_16x16x32_bf16 v[104:107], v[188:191], a[24:27], v[104:107]
s_mov_b32 s3, 122880
v_mfma_f32_16x16x32_bf16 v[108:111], v[188:191], a[28:31], v[108:111]
s_cmp_eq_u32 s51, 0
s_cselect_b32 s3, s3, 141312
s_waitcnt lgkmcnt(0)
v_mfma_f32_16x16x32_bf16 v[48:51], v[176:179], a[32:35], v[48:51]
ds_read_b64_tr_b16 v[184:185], v233 offset:8192
v_add_u32 v254, s3, v221
v_mfma_f32_16x16x32_bf16 v[52:55], v[176:179], a[36:39], v[52:55]
ds_read_b64_tr_b16 v[186:187], v233 offset:8704
v_add_u32 v255, s3, v222
v_mfma_f32_16x16x32_bf16 v[56:59], v[176:179], a[40:43], v[56:59]
ds_read_b64_tr_b16 v[188:189], v233 offset:20480
s_lshr_b32 s98, s2, 3
v_mfma_f32_16x16x32_bf16 v[60:63], v[176:179], a[44:47], v[60:63]
ds_read_b64_tr_b16 v[190:191], v233 offset:20992
s_and_b32 s99, s2, 7
v_mfma_f32_16x16x32_bf16 v[64:67], v[180:183], a[32:35], v[64:67]
global_load_lds_dwordx4 v225, s[4:5] offset:1024
v_mfma_f32_16x16x32_bf16 v[68:71], v[180:183], a[36:39], v[68:71]
global_load_lds_dwordx4 v226, s[4:5] offset:2048
v_mfma_f32_16x16x32_bf16 v[72:75], v[180:183], a[40:43], v[72:75]
global_load_lds_dwordx4 v227, s[4:5] offset:3072
v_mfma_f32_16x16x32_bf16 v[76:79], v[180:183], a[44:47], v[76:79]
s_mul_i32 s100, s50, 27
v_min_u32 v8, 26, v1
s_waitcnt lgkmcnt(0)
s_waitcnt vmcnt(19)
s_barrier
v_mfma_f32_16x16x32_bf16 v[80:83], v[184:187], a[32:35], v[80:83]
ds_read_b64_tr_b16 v[176:177], v230 offset:24576
v_add_u32 v8, s100, v8
v_mfma_f32_16x16x32_bf16 v[84:87], v[184:187], a[36:39], v[84:87]
ds_read_b64_tr_b16 v[178:179], v230 offset:25088
v_mul_u32_u24 v9, 43, v8
v_mfma_f32_16x16x32_bf16 v[88:91], v[184:187], a[40:43], v[88:91]
ds_read_b64_tr_b16 v[180:181], v230 offset:36864
v_lshrrev_b32 v9, 8, v9
v_mfma_f32_16x16x32_bf16 v[92:95], v[184:187], a[44:47], v[92:95]
ds_read_b64_tr_b16 v[182:183], v230 offset:37376
v_mul_u32_u24 v10, 6, v9
v_mfma_f32_16x16x32_bf16 v[96:99], v[188:191], a[32:35], v[96:99]
s_add_u32 m0, s73, 102400
s_nop 0
global_load_lds_dwordx4 v228, s[4:5] offset:0
v_mfma_f32_16x16x32_bf16 v[100:103], v[188:191], a[36:39], v[100:103]
global_load_lds_dwordx4 v229, s[4:5] offset:1024
v_mfma_f32_16x16x32_bf16 v[104:107], v[188:191], a[40:43], v[104:107]
v_sub_u32 v10, v8, v10
v_lshrrev_b32 v8, 1, v10
v_mfma_f32_16x16x32_bf16 v[108:111], v[188:191], a[44:47], v[108:111]
v_and_b32 v10, 1, v10
v_mul_u32_u24 v9, 3456, v9
s_waitcnt lgkmcnt(0)
v_mfma_f32_16x16x32_bf16 v[48:51], v[176:179], a[48:51], v[48:51]
ds_read_b64_tr_b16 v[184:185], v233 offset:24576
v_mul_u32_u24 v8, 1152, v8
v_mfma_f32_16x16x32_bf16 v[52:55], v[176:179], a[52:55], v[52:55]
ds_read_b64_tr_b16 v[186:187], v233 offset:25088
v_add_u32 v9, v9, v8
v_mfma_f32_16x16x32_bf16 v[56:59], v[176:179], a[56:59], v[56:59]
ds_read_b64_tr_b16 v[188:189], v233 offset:36864
v_lshl_add_u32 v9, v10, 7, v9
v_mfma_f32_16x16x32_bf16 v[60:63], v[176:179], a[60:63], v[60:63]
ds_read_b64_tr_b16 v[190:191], v233 offset:37376
s_mul_i32 s100, s98, 62208
v_mfma_f32_16x16x32_bf16 v[64:67], v[180:183], a[48:51], v[64:67]
s_add_u32 s4, s32, 4423680
s_addc_u32 s5, s33, 0
v_mfma_f32_16x16x32_bf16 v[68:71], v[180:183], a[52:55], v[68:71]
s_mul_i32 s101, s99, 144
s_add_u32 s100, s100, s101
v_mfma_f32_16x16x32_bf16 v[72:75], v[180:183], a[56:59], v[72:75]
buffer_load_dword v15, v9, s[12:15], s100 offen
v_mfma_f32_16x16x32_bf16 v[76:79], v[180:183], a[60:63], v[76:79]
s_lshl_b32 s3, s53, 7
s_add_u32 s3, s3, 41943040
s_waitcnt lgkmcnt(0)
v_mfma_f32_16x16x32_bf16 v[80:83], v[184:187], a[48:51], v[80:83]
ds_read_b64_tr_b16 v[176:177], v230 offset:28672
v_mov_b32 v11, 0
v_mfma_f32_16x16x32_bf16 v[84:87], v[184:187], a[52:55], v[84:87]
ds_read_b64_tr_b16 v[178:179], v230 offset:29184
v_mfma_f32_16x16x32_bf16 v[88:91], v[184:187], a[56:59], v[88:91]
ds_read_b64_tr_b16 v[180:181], v230 offset:40960
v_mfma_f32_16x16x32_bf16 v[92:95], v[184:187], a[60:63], v[92:95]
ds_read_b64_tr_b16 v[182:183], v230 offset:41472
v_mfma_f32_16x16x32_bf16 v[96:99], v[188:191], a[48:51], v[96:99]
s_add_u32 m0, s73, 0
s_nop 0
global_load_lds_dwordx4 v224, s[4:5] offset:0
v_mfma_f32_16x16x32_bf16 v[100:103], v[188:191], a[52:55], v[100:103]
buffer_load_dword v11, v11, s[28:31], s3 offen sc1
v_mfma_f32_16x16x32_bf16 v[104:107], v[188:191], a[56:59], v[104:107]
s_mul_i32 s37, s53, 1152
s_add_u32 s37, s37, 41947136
v_mfma_f32_16x16x32_bf16 v[108:111], v[188:191], a[60:63], v[108:111]
s_waitcnt lgkmcnt(0)
v_mfma_f32_16x16x32_bf16 v[48:51], v[176:179], a[64:67], v[48:51]
ds_read_b64_tr_b16 v[184:185], v233 offset:28672
v_mfma_f32_16x16x32_bf16 v[52:55], v[176:179], a[68:71], v[52:55]
ds_read_b64_tr_b16 v[186:187], v233 offset:29184
v_mfma_f32_16x16x32_bf16 v[56:59], v[176:179], a[72:75], v[56:59]
ds_read_b64_tr_b16 v[188:189], v233 offset:40960
v_mfma_f32_16x16x32_bf16 v[60:63], v[176:179], a[76:79], v[60:63]
ds_read_b64_tr_b16 v[190:191], v233 offset:41472
v_mfma_f32_16x16x32_bf16 v[64:67], v[180:183], a[64:67], v[64:67]
global_load_lds_dwordx4 v225, s[4:5] offset:1024
v_mfma_f32_16x16x32_bf16 v[68:71], v[180:183], a[68:71], v[68:71]
v_mfma_f32_16x16x32_bf16 v[72:75], v[180:183], a[72:75], v[72:75]
v_mfma_f32_16x16x32_bf16 v[76:79], v[180:183], a[76:79], v[76:79]
s_waitcnt lgkmcnt(0)
v_mfma_f32_16x16x32_bf16 v[80:83], v[184:187], a[64:67], v[80:83]
ds_read_b64_tr_b16 v[176:177], v230 offset:32768
v_mfma_f32_16x16x32_bf16 v[84:87], v[184:187], a[68:71], v[84:87]
ds_read_b64_tr_b16 v[178:179], v230 offset:33280
v_mfma_f32_16x16x32_bf16 v[88:91], v[184:187], a[72:75], v[88:91]
ds_read_b64_tr_b16 v[180:181], v230 offset:45056
v_mfma_f32_16x16x32_bf16 v[92:95], v[184:187], a[76:79], v[92:95]
ds_read_b64_tr_b16 v[182:183], v230 offset:45568
v_mfma_f32_16x16x32_bf16 v[96:99], v[188:191], a[64:67], v[96:99]
global_load_lds_dwordx4 v226, s[4:5] offset:2048
v_mfma_f32_16x16x32_bf16 v[100:103], v[188:191], a[68:71], v[100:103]
global_load_lds_dwordx4 v227, s[4:5] offset:3072
v_mfma_f32_16x16x32_bf16 v[104:107], v[188:191], a[72:75], v[104:107]
v_mfma_f32_16x16x32_bf16 v[108:111], v[188:191], a[76:79], v[108:111]
s_waitcnt lgkmcnt(0)
v_mfma_f32_16x16x32_bf16 v[48:51], v[176:179], a[80:83], v[48:51]
ds_read_b64_tr_b16 v[184:185], v233 offset:32768
v_mfma_f32_16x16x32_bf16 v[52:55], v[176:179], a[84:87], v[52:55]
ds_read_b64_tr_b16 v[186:187], v233 offset:33280
v_mfma_f32_16x16x32_bf16 v[56:59], v[176:179], a[88:91], v[56:59]
ds_read_b64_tr_b16 v[188:189], v233 offset:45056
v_mfma_f32_16x16x32_bf16 v[60:63], v[176:179], a[92:95], v[60:63]
ds_read_b64_tr_b16 v[190:191], v233 offset:45568
v_mfma_f32_16x16x32_bf16 v[64:67], v[180:183], a[80:83], v[64:67]
s_add_u32 m0, s73, 4096
v_mfma_f32_16x16x32_bf16 v[68:71], v[180:183], a[84:87], v[68:71]
v_mfma_f32_16x16x32_bf16 v[72:75], v[180:183], a[88:91], v[72:75]
v_mfma_f32_16x16x32_bf16 v[76:79], v[180:183], a[92:95], v[76:79]
s_waitcnt lgkmcnt(0)
s_waitcnt vmcnt(18)
s_barrier
v_mfma_f32_16x16x32_bf16 v[80:83], v[184:187], a[80:83], v[80:83]
ds_read_b64_tr_b16 v[176:177], v231 offset:0
v_mfma_f32_16x16x32_bf16 v[84:87], v[184:187], a[84:87], v[84:87]
ds_read_b64_tr_b16 v[178:179], v231 offset:512
v_mfma_f32_16x16x32_bf16 v[88:91], v[184:187], a[88:91], v[88:91]
ds_read_b64_tr_b16 v[180:181], v231 offset:12288
v_mfma_f32_16x16x32_bf16 v[92:95], v[184:187], a[92:95], v[92:95]
ds_read_b64_tr_b16 v[182:183], v231 offset:12800
v_mfma_f32_16x16x32_bf16 v[96:99], v[188:191], a[80:83], v[96:99]
global_load_lds_dwordx4 v228, s[4:5] offset:0
v_mfma_f32_16x16x32_bf16 v[100:103], v[188:191], a[84:87], v[100:103]
global_load_lds_dwordx4 v229, s[4:5] offset:1024
v_mfma_f32_16x16x32_bf16 v[104:107], v[188:191], a[88:91], v[104:107]
v_mfma_f32_16x16x32_bf16 v[108:111], v[188:191], a[92:95], v[108:111]
s_waitcnt lgkmcnt(0)
v_mfma_f32_16x16x32_bf16 v[48:51], v[176:179], a[96:99], v[48:51]
ds_read_b64_tr_b16 v[184:185], v234 offset:0
v_mfma_f32_16x16x32_bf16 v[52:55], v[176:179], a[100:103], v[52:55]
ds_read_b64_tr_b16 v[186:187], v234 offset:512
v_mfma_f32_16x16x32_bf16 v[56:59], v[176:179], a[104:107], v[56:59]
ds_read_b64_tr_b16 v[188:189], v234 offset:12288
v_mfma_f32_16x16x32_bf16 v[60:63], v[176:179], a[108:111], v[60:63]
ds_read_b64_tr_b16 v[190:191], v234 offset:12800
v_mfma_f32_16x16x32_bf16 v[64:67], v[180:183], a[96:99], v[64:67]
s_lshl_b32 s71, s50, 10
s_sub_u32 s71, s71, 4096
v_mfma_f32_16x16x32_bf16 v[68:71], v[180:183], a[100:103], v[68:71]
v_lshrrev_b32 v4, 3, v1
v_and_b32 v5, 7, v1
v_mfma_f32_16x16x32_bf16 v[72:75], v[180:183], a[104:107], v[72:75]
v_and_b32 v6, 2, v4
v_xor_b32 v5, v5, v6
v_mfma_f32_16x16x32_bf16 v[76:79], v[180:183], a[108:111], v[76:79]
s_waitcnt lgkmcnt(0)
v_mfma_f32_16x16x32_bf16 v[80:83], v[184:187], a[96:99], v[80:83]
ds_read_b64_tr_b16 v[176:177], v231 offset:4096
v_mfma_f32_16x16x32_bf16 v[84:87], v[184:187], a[100:103], v[84:87]
ds_read_b64_tr_b16 v[178:179], v231 offset:4608
v_mfma_f32_16x16x32_bf16 v[88:91], v[184:187], a[104:107], v[88:91]
ds_read_b64_tr_b16 v[180:181], v231 offset:16384
v_mfma_f32_16x16x32_bf16 v[92:95], v[184:187], a[108:111], v[92:95]
ds_read_b64_tr_b16 v[182:183], v231 offset:16896
v_mfma_f32_16x16x32_bf16 v[96:99], v[188:191], a[96:99], v[96:99]
s_lshl_b32 s94, s52, 2
v_xor_b32 v5, s94, v5
v_mfma_f32_16x16x32_bf16 v[100:103], v[188:191], a[100:103], v[100:103]
v_min_u32 v5, 5, v5
v_subrev_u32 v7, 3, v5
v_mfma_f32_16x16x32_bf16 v[104:107], v[188:191], a[104:107], v[104:107]
v_min_u32 v7, v7, v5
v_sub_u32 v5, v5, v7
v_mfma_f32_16x16x32_bf16 v[108:111], v[188:191], a[108:111], v[108:111]
s_waitcnt lgkmcnt(0)
v_mfma_f32_16x16x32_bf16 v[48:51], v[176:179], a[112:115], v[48:51]
ds_read_b64_tr_b16 v[184:185], v234 offset:4096
v_mfma_f32_16x16x32_bf16 v[52:55], v[176:179], a[116:119], v[52:55]
ds_read_b64_tr_b16 v[186:187], v234 offset:4608
v_mfma_f32_16x16x32_bf16 v[56:59], v[176:179], a[120:123], v[56:59]
ds_read_b64_tr_b16 v[188:189], v234 offset:16384
v_mfma_f32_16x16x32_bf16 v[60:63], v[176:179], a[124:127], v[60:63]
ds_read_b64_tr_b16 v[190:191], v234 offset:16896
v_mfma_f32_16x16x32_bf16 v[64:67], v[180:183], a[112:115], v[64:67]
v_mul_u32_u24 v5, 12, v5
v_lshlrev_b32 v6, 4, v7
v_mfma_f32_16x16x32_bf16 v[68:71], v[180:183], a[116:119], v[68:71]
v_min_u32 v6, 20, v6
v_add_u32 v6, v6, v5
v_mfma_f32_16x16x32_bf16 v[72:75], v[180:183], a[120:123], v[72:75]
s_lshl_b32 s94, s50, 3
v_add_u32 v4, s94, v4
v_mfma_f32_16x16x32_bf16 v[76:79], v[180:183], a[124:127], v[76:79]
s_waitcnt lgkmcnt(0)
v_mfma_f32_16x16x32_bf16 v[80:83], v[184:187], a[112:115], v[80:83]
ds_read_b64_tr_b16 v[176:177], v231 offset:8192
v_mfma_f32_16x16x32_bf16 v[84:87], v[184:187], a[116:119], v[84:87]
ds_read_b64_tr_b16 v[178:179], v231 offset:8704
v_mfma_f32_16x16x32_bf16 v[88:91], v[184:187], a[120:123], v[88:91]
ds_read_b64_tr_b16 v[180:181], v231 offset:20480
v_mfma_f32_16x16x32_bf16 v[92:95], v[184:187], a[124:127], v[92:95]
ds_read_b64_tr_b16 v[182:183], v231 offset:20992
v_mfma_f32_16x16x32_bf16 v[96:99], v[188:191], a[112:115], v[96:99]
v_mul_u32_u24 v4, 3456, v4
v_add_u32 v4, v4, v6
v_mfma_f32_16x16x32_bf16 v[100:103], v[188:191], a[116:119], v[100:103]
s_mul_i32 s94, s54, 72
v_add_u32 v175, s94, v4
v_mfma_f32_16x16x32_bf16 v[104:107], v[188:191], a[120:123], v[104:107]
s_add_u32 s6, s38, 0
s_addc_u32 s7, s39, 0
v_mfma_f32_16x16x32_bf16 v[108:111], v[188:191], a[124:127], v[108:111]
s_add_u32 m0, s71, 28672
s_waitcnt lgkmcnt(0)
v_mfma_f32_16x16x32_bf16 v[48:51], v[176:179], a[128:131], v[48:51]
ds_read_b64_tr_b16 v[184:185], v234 offset:8192
v_mfma_f32_16x16x32_bf16 v[52:55], v[176:179], a[132:135], v[52:55]
ds_read_b64_tr_b16 v[186:187], v234 offset:8704
v_mfma_f32_16x16x32_bf16 v[56:59], v[176:179], a[136:139], v[56:59]
ds_read_b64_tr_b16 v[188:189], v234 offset:20480
v_mfma_f32_16x16x32_bf16 v[60:63], v[176:179], a[140:143], v[60:63]
ds_read_b64_tr_b16 v[190:191], v234 offset:20992
v_mfma_f32_16x16x32_bf16 v[64:67], v[180:183], a[128:131], v[64:67]
global_load_lds_dwordx4 v175, s[6:7] offset:0
v_mfma_f32_16x16x32_bf16 v[68:71], v[180:183], a[132:135], v[68:71]
s_add_u32 m0, s71, 31616
s_nop 0
global_load_lds_dwordx4 v175, s[6:7] offset:1152
v_mfma_f32_16x16x32_bf16 v[72:75], v[180:183], a[136:139], v[72:75]
s_add_u32 m0, s71, 34560
s_nop 0
global_load_lds_dwordx4 v175, s[6:7] offset:2304
v_mfma_f32_16x16x32_bf16 v[76:79], v[180:183], a[140:143], v[76:79]
s_add_u32 s6, s38, 110592
s_addc_u32 s7, s39, 0
s_waitcnt lgkmcnt(0)
s_waitcnt vmcnt(17)
s_barrier
v_mfma_f32_16x16x32_bf16 v[80:83], v[184:187], a[128:131], v[80:83]
ds_read_b64_tr_b16 v[176:177], v231 offset:24576
v_mfma_f32_16x16x32_bf16 v[84:87], v[184:187], a[132:135], v[84:87]
ds_read_b64_tr_b16 v[178:179], v231 offset:25088
v_mfma_f32_16x16x32_bf16 v[88:91], v[184:187], a[136:139], v[88:91]
ds_read_b64_tr_b16 v[180:181], v231 offset:36864
v_mfma_f32_16x16x32_bf16 v[92:95], v[184:187], a[140:143], v[92:95]
ds_read_b64_tr_b16 v[182:183], v231 offset:37376
v_mfma_f32_16x16x32_bf16 v[96:99], v[188:191], a[128:131], v[96:99]
s_add_u32 m0, s71, 40960
s_nop 0
global_load_lds_dwordx4 v175, s[6:7] offset:0
v_mfma_f32_16x16x32_bf16 v[100:103], v[188:191], a[132:135], v[100:103]
s_add_u32 m0, s71, 43904
s_nop 0
global_load_lds_dwordx4 v175, s[6:7] offset:1152
v_mfma_f32_16x16x32_bf16 v[104:107], v[188:191], a[136:139], v[104:107]
s_add_u32 m0, s71, 46848
s_nop 0
global_load_lds_dwordx4 v175, s[6:7] offset:2304
v_mfma_f32_16x16x32_bf16 v[108:111], v[188:191], a[140:143], v[108:111]
s_waitcnt lgkmcnt(0)
v_mfma_f32_16x16x32_bf16 v[48:51], v[176:179], a[144:147], v[48:51]
ds_read_b64_tr_b16 v[184:185], v234 offset:24576
v_mfma_f32_16x16x32_bf16 v[52:55], v[176:179], a[148:151], v[52:55]
ds_read_b64_tr_b16 v[186:187], v234 offset:25088
v_mfma_f32_16x16x32_bf16 v[56:59], v[176:179], a[152:155], v[56:59]
ds_read_b64_tr_b16 v[188:189], v234 offset:36864
v_mfma_f32_16x16x32_bf16 v[60:63], v[176:179], a[156:159], v[60:63]
ds_read_b64_tr_b16 v[190:191], v234 offset:37376
v_mfma_f32_16x16x32_bf16 v[64:67], v[180:183], a[144:147], v[64:67]
s_add_u32 s6, s38, 221184
s_addc_u32 s7, s39, 0
v_mfma_f32_16x16x32_bf16 v[68:71], v[180:183], a[148:151], v[68:71]
s_add_u32 m0, s71, 53248
v_mfma_f32_16x16x32_bf16 v[72:75], v[180:183], a[152:155], v[72:75]
v_mfma_f32_16x16x32_bf16 v[76:79], v[180:183], a[156:159], v[76:79]
s_waitcnt lgkmcnt(0)
v_mfma_f32_16x16x32_bf16 v[80:83], v[184:187], a[144:147], v[80:83]
ds_read_b64_tr_b16 v[176:177], v231 offset:28672
v_mfma_f32_16x16x32_bf16 v[84:87], v[184:187], a[148:151], v[84:87]
ds_read_b64_tr_b16 v[178:179], v231 offset:29184
v_mfma_f32_16x16x32_bf16 v[88:91], v[184:187], a[152:155], v[88:91]
ds_read_b64_tr_b16 v[180:181], v231 offset:40960
v_mfma_f32_16x16x32_bf16 v[92:95], v[184:187], a[156:159], v[92:95]
ds_read_b64_tr_b16 v[182:183], v231 offset:41472
v_mfma_f32_16x16x32_bf16 v[96:99], v[188:191], a[144:147], v[96:99]
global_load_lds_dwordx4 v175, s[6:7] offset:0
v_mfma_f32_16x16x32_bf16 v[100:103], v[188:191], a[148:151], v[100:103]
s_add_u32 m0, s71, 56192
v_mfma_f32_16x16x32_bf16 v[104:107], v[188:191], a[152:155], v[104:107]
v_mfma_f32_16x16x32_bf16 v[108:111], v[188:191], a[156:159], v[108:111]
s_waitcnt lgkmcnt(0)
v_mfma_f32_16x16x32_bf16 v[48:51], v[176:179], a[160:163], v[48:51]
ds_read_b64_tr_b16 v[184:185], v234 offset:28672
v_mfma_f32_16x16x32_bf16 v[52:55], v[176:179], a[164:167], v[52:55]
ds_read_b64_tr_b16 v[186:187], v234 offset:29184
v_mfma_f32_16x16x32_bf16 v[56:59], v[176:179], a[168:171], v[56:59]
ds_read_b64_tr_b16 v[188:189], v234 offset:40960
v_mfma_f32_16x16x32_bf16 v[60:63], v[176:179], a[172:175], v[60:63]
ds_read_b64_tr_b16 v[190:191], v234 offset:41472
v_mfma_f32_16x16x32_bf16 v[64:67], v[180:183], a[160:163], v[64:67]
global_load_lds_dwordx4 v175, s[6:7] offset:1152
v_mfma_f32_16x16x32_bf16 v[68:71], v[180:183], a[164:167], v[68:71]
s_add_u32 m0, s71, 59136
s_nop 0
global_load_lds_dwordx4 v175, s[6:7] offset:2304
v_mfma_f32_16x16x32_bf16 v[72:75], v[180:183], a[168:171], v[72:75]
v_mfma_f32_16x16x32_bf16 v[76:79], v[180:183], a[172:175], v[76:79]
s_waitcnt lgkmcnt(0)
v_mfma_f32_16x16x32_bf16 v[80:83], v[184:187], a[160:163], v[80:83]
ds_read_b64_tr_b16 v[176:177], v231 offset:32768
v_mfma_f32_16x16x32_bf16 v[84:87], v[184:187], a[164:167], v[84:87]
ds_read_b64_tr_b16 v[178:179], v231 offset:33280
v_mfma_f32_16x16x32_bf16 v[88:91], v[184:187], a[168:171], v[88:91]
ds_read_b64_tr_b16 v[180:181], v231 offset:45056
v_mfma_f32_16x16x32_bf16 v[92:95], v[184:187], a[172:175], v[92:95]
ds_read_b64_tr_b16 v[182:183], v231 offset:45568
v_mfma_f32_16x16x32_bf16 v[96:99], v[188:191], a[160:163], v[96:99]
s_add_u32 s6, s38, 331776
s_addc_u32 s7, s39, 0
v_mfma_f32_16x16x32_bf16 v[100:103], v[188:191], a[164:167], v[100:103]
s_add_u32 m0, s71, 65536
v_mfma_f32_16x16x32_bf16 v[104:107], v[188:191], a[168:171], v[104:107]
v_mfma_f32_16x16x32_bf16 v[108:111], v[188:191], a[172:175], v[108:111]
s_waitcnt lgkmcnt(0)
v_mfma_f32_16x16x32_bf16 v[48:51], v[176:179], a[176:179], v[48:51]
ds_read_b64_tr_b16 v[184:185], v234 offset:32768
v_mfma_f32_16x16x32_bf16 v[52:55], v[176:179], a[180:183], v[52:55]
ds_read_b64_tr_b16 v[186:187], v234 offset:33280
v_mfma_f32_16x16x32_bf16 v[56:59], v[176:179], a[184:187], v[56:59]
ds_read_b64_tr_b16 v[188:189], v234 offset:45056
v_mfma_f32_16x16x32_bf16 v[60:63], v[176:179], a[188:191], v[60:63]
ds_read_b64_tr_b16 v[190:191], v234 offset:45568
v_mfma_f32_16x16x32_bf16 v[64:67], v[180:183], a[176:179], v[64:67]
global_load_lds_dwordx4 v175, s[6:7] offset:0
v_mfma_f32_16x16x32_bf16 v[68:71], v[180:183], a[180:183], v[68:71]
s_add_u32 m0, s71, 68480
v_mfma_f32_16x16x32_bf16 v[72:75], v[180:183], a[184:187], v[72:75]
v_mfma_f32_16x16x32_bf16 v[76:79], v[180:183], a[188:191], v[76:79]
s_waitcnt lgkmcnt(0)
s_waitcnt vmcnt(18)
s_barrier
v_mfma_f32_16x16x32_bf16 v[80:83], v[184:187], a[176:179], v[80:83]
ds_read_b64_tr_b16 v[176:177], v232 offset:0
v_mfma_f32_16x16x32_bf16 v[84:87], v[184:187], a[180:183], v[84:87]
ds_read_b64_tr_b16 v[178:179], v232 offset:512
v_mfma_f32_16x16x32_bf16 v[88:91], v[184:187], a[184:187], v[88:91]
ds_read_b64_tr_b16 v[180:181], v232 offset:12288
v_mfma_f32_16x16x32_bf16 v[92:95], v[184:187], a[188:191], v[92:95]
ds_read_b64_tr_b16 v[182:183], v232 offset:12800
v_mfma_f32_16x16x32_bf16 v[96:99], v[188:191], a[176:179], v[96:99]
global_load_lds_dwordx4 v175, s[6:7] offset:1152
v_mfma_f32_16x16x32_bf16 v[100:103], v[188:191], a[180:183], v[100:103]
s_add_u32 m0, s71, 71424
s_nop 0
global_load_lds_dwordx4 v175, s[6:7] offset:2304
v_mfma_f32_16x16x32_bf16 v[104:107], v[188:191], a[184:187], v[104:107]
v_mfma_f32_16x16x32_bf16 v[108:111], v[188:191], a[188:191], v[108:111]
s_waitcnt lgkmcnt(0)
v_mfma_f32_16x16x32_bf16 v[48:51], v[176:179], a[192:195], v[48:51]
ds_read_b64_tr_b16 v[184:185], v235 offset:0
v_mfma_f32_16x16x32_bf16 v[52:55], v[176:179], a[196:199], v[52:55]
ds_read_b64_tr_b16 v[186:187], v235 offset:512
v_mfma_f32_16x16x32_bf16 v[56:59], v[176:179], a[200:203], v[56:59]
ds_read_b64_tr_b16 v[188:189], v235 offset:12288
v_mfma_f32_16x16x32_bf16 v[60:63], v[176:179], a[204:207], v[60:63]
ds_read_b64_tr_b16 v[190:191], v235 offset:12800
v_mfma_f32_16x16x32_bf16 v[64:67], v[180:183], a[192:195], v[64:67]
s_add_u32 s6, s38, 442368
s_addc_u32 s7, s39, 0
v_mfma_f32_16x16x32_bf16 v[68:71], v[180:183], a[196:199], v[68:71]
s_add_u32 m0, s71, 77824
v_mfma_f32_16x16x32_bf16 v[72:75], v[180:183], a[200:203], v[72:75]
v_mfma_f32_16x16x32_bf16 v[76:79], v[180:183], a[204:207], v[76:79]
s_waitcnt lgkmcnt(0)
v_mfma_f32_16x16x32_bf16 v[80:83], v[184:187], a[192:195], v[80:83]
ds_read_b64_tr_b16 v[176:177], v232 offset:4096
v_mfma_f32_16x16x32_bf16 v[84:87], v[184:187], a[196:199], v[84:87]
ds_read_b64_tr_b16 v[178:179], v232 offset:4608
v_mfma_f32_16x16x32_bf16 v[88:91], v[184:187], a[200:203], v[88:91]
ds_read_b64_tr_b16 v[180:181], v232 offset:16384
v_mfma_f32_16x16x32_bf16 v[92:95], v[184:187], a[204:207], v[92:95]
ds_read_b64_tr_b16 v[182:183], v232 offset:16896
v_mfma_f32_16x16x32_bf16 v[96:99], v[188:191], a[192:195], v[96:99]
global_load_lds_dwordx4 v175, s[6:7] offset:0
v_mfma_f32_16x16x32_bf16 v[100:103], v[188:191], a[196:199], v[100:103]
s_add_u32 m0, s71, 80768
v_mfma_f32_16x16x32_bf16 v[104:107], v[188:191], a[200:203], v[104:107]
v_mfma_f32_16x16x32_bf16 v[108:111], v[188:191], a[204:207], v[108:111]
s_waitcnt lgkmcnt(0)
v_mfma_f32_16x16x32_bf16 v[48:51], v[176:179], a[208:211], v[48:51]
ds_read_b64_tr_b16 v[184:185], v235 offset:4096
v_mfma_f32_16x16x32_bf16 v[52:55], v[176:179], a[212:215], v[52:55]
ds_read_b64_tr_b16 v[186:187], v235 offset:4608
v_mfma_f32_16x16x32_bf16 v[56:59], v[176:179], a[216:219], v[56:59]
ds_read_b64_tr_b16 v[188:189], v235 offset:16384
v_mfma_f32_16x16x32_bf16 v[60:63], v[176:179], a[220:223], v[60:63]
ds_read_b64_tr_b16 v[190:191], v235 offset:16896
v_mfma_f32_16x16x32_bf16 v[64:67], v[180:183], a[208:211], v[64:67]
global_load_lds_dwordx4 v175, s[6:7] offset:1152
v_mfma_f32_16x16x32_bf16 v[68:71], v[180:183], a[212:215], v[68:71]
s_add_u32 m0, s71, 83712
s_nop 0
global_load_lds_dwordx4 v175, s[6:7] offset:2304
v_mfma_f32_16x16x32_bf16 v[72:75], v[180:183], a[216:219], v[72:75]
v_mfma_f32_16x16x32_bf16 v[76:79], v[180:183], a[220:223], v[76:79]
s_waitcnt lgkmcnt(0)
v_mfma_f32_16x16x32_bf16 v[80:83], v[184:187], a[208:211], v[80:83]
ds_read_b64_tr_b16 v[176:177], v232 offset:8192
v_mfma_f32_16x16x32_bf16 v[84:87], v[184:187], a[212:215], v[84:87]
ds_read_b64_tr_b16 v[178:179], v232 offset:8704
v_mfma_f32_16x16x32_bf16 v[88:91], v[184:187], a[216:219], v[88:91]
ds_read_b64_tr_b16 v[180:181], v232 offset:20480
v_mfma_f32_16x16x32_bf16 v[92:95], v[184:187], a[220:223], v[92:95]
ds_read_b64_tr_b16 v[182:183], v232 offset:20992
v_mfma_f32_16x16x32_bf16 v[96:99], v[188:191], a[208:211], v[96:99]
s_add_u32 s6, s38, 552960
s_addc_u32 s7, s39, 0
v_mfma_f32_16x16x32_bf16 v[100:103], v[188:191], a[212:215], v[100:103]
s_add_u32 m0, s71, 90112
v_mfma_f32_16x16x32_bf16 v[104:107], v[188:191], a[216:219], v[104:107]
v_mfma_f32_16x16x32_bf16 v[108:111], v[188:191], a[220:223], v[108:111]
s_waitcnt lgkmcnt(0)
v_mfma_f32_16x16x32_bf16 v[48:51], v[176:179], a[224:227], v[48:51]
ds_read_b64_tr_b16 v[184:185], v235 offset:8192
v_mfma_f32_16x16x32_bf16 v[52:55], v[176:179], a[228:231], v[52:55]
ds_read_b64_tr_b16 v[186:187], v235 offset:8704
v_mfma_f32_16x16x32_bf16 v[56:59], v[176:179], a[232:235], v[56:59]
ds_read_b64_tr_b16 v[188:189], v235 offset:20480
v_mfma_f32_16x16x32_bf16 v[60:63], v[176:179], a[236:239], v[60:63]
ds_read_b64_tr_b16 v[190:191], v235 offset:20992
v_mfma_f32_16x16x32_bf16 v[64:67], v[180:183], a[224:227], v[64:67]
global_load_lds_dwordx4 v175, s[6:7] offset:0
v_mfma_f32_16x16x32_bf16 v[68:71], v[180:183], a[228:231], v[68:71]
s_add_u32 m0, s71, 93056
v_mfma_f32_16x16x32_bf16 v[72:75], v[180:183], a[232:235], v[72:75]
v_mfma_f32_16x16x32_bf16 v[76:79], v[180:183], a[236:239], v[76:79]
s_waitcnt lgkmcnt(0)
s_waitcnt vmcnt(16)
s_barrier
v_mfma_f32_16x16x32_bf16 v[80:83], v[184:187], a[224:227], v[80:83]
ds_read_b64_tr_b16 v[176:177], v230 offset:0
v_mfma_f32_16x16x32_bf16 v[84:87], v[184:187], a[228:231], v[84:87]
ds_read_b64_tr_b16 v[178:179], v230 offset:512
v_mfma_f32_16x16x32_bf16 v[88:91], v[184:187], a[232:235], v[88:91]
ds_read_b64_tr_b16 v[180:181], v230 offset:12288
v_mfma_f32_16x16x32_bf16 v[92:95], v[184:187], a[236:239], v[92:95]
ds_read_b64_tr_b16 v[182:183], v230 offset:12800
v_mfma_f32_16x16x32_bf16 v[96:99], v[188:191], a[224:227], v[96:99]
global_load_lds_dwordx4 v175, s[6:7] offset:1152
v_mfma_f32_16x16x32_bf16 v[100:103], v[188:191], a[228:231], v[100:103]
s_add_u32 m0, s71, 96000
s_nop 0
global_load_lds_dwordx4 v175, s[6:7] offset:2304
v_mfma_f32_16x16x32_bf16 v[104:107], v[188:191], a[232:235], v[104:107]
v_mfma_f32_16x16x32_bf16 v[108:111], v[188:191], a[236:239], v[108:111]
v_readfirstlane_b32 s36, v11
s_nop 3
s_add_u32 s36, s36, 1
s_waitcnt lgkmcnt(0)
v_mfma_f32_16x16x32_bf16 v[48:51], v[176:179], a[240:243], v[48:51]
ds_read_b64_tr_b16 v[184:185], v233 offset:0
v_mfma_f32_16x16x32_bf16 v[52:55], v[176:179], a[244:247], v[52:55]
ds_read_b64_tr_b16 v[186:187], v233 offset:512
v_mfma_f32_16x16x32_bf16 v[56:59], v[176:179], a[248:251], v[56:59]
ds_read_b64_tr_b16 v[188:189], v233 offset:12288
v_mfma_f32_16x16x32_bf16 v[60:63], v[176:179], a[252:255], v[60:63]
ds_read_b64_tr_b16 v[190:191], v233 offset:12800
v_mfma_f32_16x16x32_bf16 v[64:67], v[180:183], a[240:243], v[64:67]
s_add_u32 s6, s38, 663552
s_addc_u32 s7, s39, 0
v_mfma_f32_16x16x32_bf16 v[68:71], v[180:183], a[244:247], v[68:71]
s_add_u32 m0, s71, 102400
v_mfma_f32_16x16x32_bf16 v[72:75], v[180:183], a[248:251], v[72:75]
v_mfma_f32_16x16x32_bf16 v[76:79], v[180:183], a[252:255], v[76:79]
s_waitcnt lgkmcnt(0)
v_mfma_f32_16x16x32_bf16 v[80:83], v[184:187], a[240:243], v[80:83]
ds_read_b64_tr_b16 v[176:177], v230 offset:4096
v_mfma_f32_16x16x32_bf16 v[84:87], v[184:187], a[244:247], v[84:87]
ds_read_b64_tr_b16 v[178:179], v230 offset:4608
v_mfma_f32_16x16x32_bf16 v[88:91], v[184:187], a[248:251], v[88:91]
ds_read_b64_tr_b16 v[180:181], v230 offset:16384
v_mfma_f32_16x16x32_bf16 v[92:95], v[184:187], a[252:255], v[92:95]
ds_read_b64_tr_b16 v[182:183], v230 offset:16896
v_mfma_f32_16x16x32_bf16 v[96:99], v[188:191], a[240:243], v[96:99]
global_load_lds_dwordx4 v175, s[6:7] offset:0
v_mfma_f32_16x16x32_bf16 v[100:103], v[188:191], a[244:247], v[100:103]
s_add_u32 m0, s71, 105344
v_mfma_f32_16x16x32_bf16 v[104:107], v[188:191], a[248:251], v[104:107]
v_mfma_f32_16x16x32_bf16 v[108:111], v[188:191], a[252:255], v[108:111]
s_waitcnt lgkmcnt(0)
v_mfma_f32_16x16x32_bf16 v[48:51], v[176:179], v[16:19], v[48:51]
ds_read_b64_tr_b16 v[184:185], v233 offset:4096
v_mfma_f32_16x16x32_bf16 v[52:55], v[176:179], v[20:23], v[52:55]
ds_read_b64_tr_b16 v[186:187], v233 offset:4608
v_mfma_f32_16x16x32_bf16 v[56:59], v[176:179], v[24:27], v[56:59]
ds_read_b64_tr_b16 v[188:189], v233 offset:16384
v_mfma_f32_16x16x32_bf16 v[60:63], v[176:179], v[28:31], v[60:63]
ds_read_b64_tr_b16 v[190:191], v233 offset:16896
v_mfma_f32_16x16x32_bf16 v[64:67], v[180:183], v[16:19], v[64:67]
global_load_lds_dwordx4 v175, s[6:7] offset:1152
v_mfma_f32_16x16x32_bf16 v[68:71], v[180:183], v[20:23], v[68:71]
s_add_u32 m0, s71, 108288
s_nop 0
global_load_lds_dwordx4 v175, s[6:7] offset:2304
v_mfma_f32_16x16x32_bf16 v[72:75], v[180:183], v[24:27], v[72:75]
v_mfma_f32_16x16x32_bf16 v[76:79], v[180:183], v[28:31], v[76:79]
s_waitcnt lgkmcnt(0)
v_mfma_f32_16x16x32_bf16 v[80:83], v[184:187], v[16:19], v[80:83]
ds_read_b64_tr_b16 v[176:177], v230 offset:8192
v_mfma_f32_16x16x32_bf16 v[84:87], v[184:187], v[20:23], v[84:87]
ds_read_b64_tr_b16 v[178:179], v230 offset:8704
v_mfma_f32_16x16x32_bf16 v[88:91], v[184:187], v[24:27], v[88:91]
ds_read_b64_tr_b16 v[180:181], v230 offset:20480
v_mfma_f32_16x16x32_bf16 v[92:95], v[184:187], v[28:31], v[92:95]
ds_read_b64_tr_b16 v[182:183], v230 offset:20992
v_mfma_f32_16x16x32_bf16 v[96:99], v[188:191], v[16:19], v[96:99]
s_add_u32 s6, s38, 774144
s_addc_u32 s7, s39, 0
v_mfma_f32_16x16x32_bf16 v[100:103], v[188:191], v[20:23], v[100:103]
s_add_u32 m0, s71, 114688
v_mfma_f32_16x16x32_bf16 v[104:107], v[188:191], v[24:27], v[104:107]
v_mfma_f32_16x16x32_bf16 v[108:111], v[188:191], v[28:31], v[108:111]
s_waitcnt lgkmcnt(0)
v_mfma_f32_16x16x32_bf16 v[48:51], v[176:179], v[32:35], v[48:51]
ds_read_b64_tr_b16 v[184:185], v233 offset:8192
v_mfma_f32_16x16x32_bf16 v[52:55], v[176:179], v[36:39], v[52:55]
ds_read_b64_tr_b16 v[186:187], v233 offset:8704
v_mfma_f32_16x16x32_bf16 v[56:59], v[176:179], v[40:43], v[56:59]
ds_read_b64_tr_b16 v[188:189], v233 offset:20480
v_mfma_f32_16x16x32_bf16 v[60:63], v[176:179], v[44:47], v[60:63]
ds_read_b64_tr_b16 v[190:191], v233 offset:20992
v_mfma_f32_16x16x32_bf16 v[64:67], v[180:183], v[32:35], v[64:67]
global_load_lds_dwordx4 v175, s[6:7] offset:0
v_mfma_f32_16x16x32_bf16 v[68:71], v[180:183], v[36:39], v[68:71]
s_add_u32 m0, s71, 117632
v_mfma_f32_16x16x32_bf16 v[72:75], v[180:183], v[40:43], v[72:75]
v_mfma_f32_16x16x32_bf16 v[76:79], v[180:183], v[44:47], v[76:79]
s_waitcnt lgkmcnt(0)
s_waitcnt vmcnt(16)
s_barrier
v_mfma_f32_16x16x32_bf16 v[80:83], v[184:187], v[32:35], v[80:83]
ds_read_b64_tr_b16 v[212:213], v12 offset:24576
ds_read_b64_tr_b16 v[214:215], v12 offset:25088
v_mfma_f32_16x16x32_bf16 v[84:87], v[184:187], v[36:39], v[84:87]
ds_read_b64_tr_b16 v[216:217], v12 offset:28672
v_mfma_f32_16x16x32_bf16 v[88:91], v[184:187], v[40:43], v[88:91]
ds_read_b64_tr_b16 v[218:219], v12 offset:29184
v_mfma_f32_16x16x32_bf16 v[92:95], v[184:187], v[44:47], v[92:95]
ds_read_b64_tr_b16 v[168:169], v12 offset:32768
v_mfma_f32_16x16x32_bf16 v[96:99], v[188:191], v[32:35], v[96:99]
ds_read_b64_tr_b16 v[170:171], v12 offset:33280
v_mfma_f32_16x16x32_bf16 v[100:103], v[188:191], v[36:39], v[100:103]
ds_read_b64_tr_b16 v[220:221], v172 offset:24576
v_mfma_f32_16x16x32_bf16 v[104:107], v[188:191], v[40:43], v[104:107]
ds_read_b64_tr_b16 v[222:223], v172 offset:25088
v_mfma_f32_16x16x32_bf16 v[108:111], v[188:191], v[44:47], v[108:111]
ds_read_b128 v[4:7], v254 offset:0
global_load_lds_dwordx4 v175, s[6:7] offset:1152
s_add_u32 m0, s71, 120576
s_nop 0
global_load_lds_dwordx4 v175, s[6:7] offset:2304
s_waitcnt lgkmcnt(5)
v_mfma_f32_16x16x32_bf16 v[112:115], v[212:215], a[0:3], 0
ds_read_b64_tr_b16 v[176:177], v12 offset:36864
v_mul_f32 v244, v48, v236
v_mfma_f32_16x16x32_bf16 v[116:119], v[212:215], a[4:7], 0
ds_read_b64_tr_b16 v[178:179], v12 offset:37376
v_mul_f32 v245, v49, v236
v_mfma_f32_16x16x32_bf16 v[120:123], v[212:215], a[8:11], 0
ds_read_b64_tr_b16 v[180:181], v12 offset:40960
v_mul_f32 v246, v50, v236
v_mfma_f32_16x16x32_bf16 v[124:127], v[212:215], a[12:15], 0
ds_read_b64_tr_b16 v[182:183], v12 offset:41472
v_mul_f32 v247, v51, v236
v_mfma_f32_16x16x32_bf16 v[132:135], v[216:219], a[0:3], 0
ds_read_b64_tr_b16 v[188:189], v12 offset:45056
v_mul_f32 v64, v48, v64
v_mfma_f32_16x16x32_bf16 v[136:139], v[216:219], a[4:7], 0
ds_read_b64_tr_b16 v[190:191], v12 offset:45568
v_mul_f32 v65, v49, v65
v_mfma_f32_16x16x32_bf16 v[140:143], v[216:219], a[8:11], 0
ds_read_b64_tr_b16 v[184:185], v172 offset:36864
v_mul_f32 v66, v50, v66
v_mfma_f32_16x16x32_bf16 v[144:147], v[216:219], a[12:15], 0
ds_read_b64_tr_b16 v[186:187], v172 offset:37376
v_mul_f32 v67, v51, v67
s_waitcnt lgkmcnt(8)
v_mfma_f32_16x16x32_bf16 v[128:131], v[216:219], v[4:7], 0
ds_read_b128 v[8:11], v255 offset:1024
v_mfma_f32_16x16x32_bf16 v[196:199], a[0:3], v[168:171], 0
s_add_u32 s6, s38, 884736
s_addc_u32 s7, s39, 0
v_mfma_f32_16x16x32_bf16 v[200:203], a[4:7], v[168:171], 0
s_add_u32 m0, s71, 4096
s_nop 0
global_load_lds_dwordx4 v175, s[6:7] offset:0
v_mfma_f32_16x16x32_bf16 v[204:207], a[8:11], v[168:171], 0
s_add_u32 m0, s71, 7040
s_nop 0
global_load_lds_dwordx4 v175, s[6:7] offset:1152
v_mfma_f32_16x16x32_bf16 v[208:211], a[12:15], v[168:171], 0
s_add_u32 m0, s71, 9984
s_nop 0
global_load_lds_dwordx4 v175, s[6:7] offset:2304
v_mfma_f32_16x16x32_bf16 v[192:195], v[4:7], v[168:171], 0
v_exp_f32 v244, v244
v_mfma_f32_16x16x32_bf16 v[152:155], v[220:223], a[0:3], 0
v_exp_f32 v245, v245
v_mfma_f32_16x16x32_bf16 v[156:159], v[220:223], a[4:7], 0
v_exp_f32 v246, v246
v_mfma_f32_16x16x32_bf16 v[160:163], v[220:223], a[8:11], 0
v_exp_f32 v247, v247
v_mfma_f32_16x16x32_bf16 v[164:167], v[220:223], a[12:15], 0
v_fma_f32 v244, v244, v240, v240
v_fma_f32 v245, v245, v240, v240
v_mfma_f32_16x16x32_bf16 v[148:151], v[220:223], v[4:7], 0
v_fma_f32 v246, v246, v240, v240
v_fma_f32 v247, v247, v240, v240
s_waitcnt lgkmcnt(0)
s_waitcnt vmcnt(15)
s_barrier
v_mfma_f32_16x16x32_bf16 v[112:115], v[176:179], a[16:19], v[112:115]
ds_read_b64_tr_b16 v[212:213], v13 offset:0
v_mul_f32 v248, v52, v237
v_mfma_f32_16x16x32_bf16 v[116:119], v[176:179], a[20:23], v[116:119]
ds_read_b64_tr_b16 v[214:215], v13 offset:512
v_mul_f32 v249, v53, v237
v_mfma_f32_16x16x32_bf16 v[120:123], v[176:179], a[24:27], v[120:123]
ds_read_b64_tr_b16 v[216:217], v13 offset:4096
v_mul_f32 v250, v54, v237
v_mfma_f32_16x16x32_bf16 v[124:127], v[176:179], a[28:31], v[124:127]
ds_read_b64_tr_b16 v[218:219], v13 offset:4608
v_mul_f32 v251, v55, v237
v_mfma_f32_16x16x32_bf16 v[132:135], v[180:183], a[16:19], v[132:135]
ds_read_b64_tr_b16 v[168:169], v13 offset:8192
v_mul_f32 v68, v52, v68
v_mfma_f32_16x16x32_bf16 v[136:139], v[180:183], a[20:23], v[136:139]
ds_read_b64_tr_b16 v[170:171], v13 offset:8704
v_mul_f32 v69, v53, v69
v_mfma_f32_16x16x32_bf16 v[140:143], v[180:183], a[24:27], v[140:143]
ds_read_b64_tr_b16 v[220:221], v173 offset:0
v_mul_f32 v70, v54, v70
v_mfma_f32_16x16x32_bf16 v[144:147], v[180:183], a[28:31], v[144:147]
ds_read_b64_tr_b16 v[222:223], v173 offset:512
v_mfma_f32_16x16x32_bf16 v[128:131], v[180:183], v[8:11], v[128:131]
ds_read_b128 v[4:7], v254 offset:2048
v_mfma_f32_16x16x32_bf16 v[196:199], a[16:19], v[188:191], v[196:199]
s_add_u32 s6, s38, 995328
s_addc_u32 s7, s39, 0
v_mfma_f32_16x16x32_bf16 v[200:203], a[20:23], v[188:191], v[200:203]
s_add_u32 m0, s71, 16384
s_nop 0
global_load_lds_dwordx4 v175, s[6:7] offset:0
v_mfma_f32_16x16x32_bf16 v[204:207], a[24:27], v[188:191], v[204:207]
s_add_u32 m0, s71, 19328
s_nop 0
global_load_lds_dwordx4 v175, s[6:7] offset:1152
v_mfma_f32_16x16x32_bf16 v[208:211], a[28:31], v[188:191], v[208:211]
s_add_u32 m0, s71, 22272
s_nop 0
global_load_lds_dwordx4 v175, s[6:7] offset:2304
v_mfma_f32_16x16x32_bf16 v[192:195], v[8:11], v[188:191], v[192:195]
v_rcp_f32 v244, v244
v_mfma_f32_16x16x32_bf16 v[152:155], v[184:187], a[16:19], v[152:155]
v_rcp_f32 v245, v245
v_mfma_f32_16x16x32_bf16 v[156:159], v[184:187], a[20:23], v[156:159]
v_rcp_f32 v246, v246
v_mfma_f32_16x16x32_bf16 v[160:163], v[184:187], a[24:27], v[160:163]
v_rcp_f32 v247, v247
v_mfma_f32_16x16x32_bf16 v[164:167], v[184:187], a[28:31], v[164:167]
v_mul_f32 v64, v64, v244
v_mul_f32 v65, v65, v245
v_mfma_f32_16x16x32_bf16 v[148:151], v[184:187], v[8:11], v[148:151]
v_mul_f32 v66, v66, v246
v_mul_f32 v67, v67, v247
s_waitcnt lgkmcnt(5)
v_mfma_f32_16x16x32_bf16 v[112:115], v[212:215], a[32:35], v[112:115]
ds_read_b64_tr_b16 v[176:177], v13 offset:12288
v_cvt_pk_bf16_f32 v64, v64, v65
v_mfma_f32_16x16x32_bf16 v[116:119], v[212:215], a[36:39], v[116:119]
ds_read_b64_tr_b16 v[178:179], v13 offset:12800
v_cvt_pk_bf16_f32 v65, v66, v67
v_mfma_f32_16x16x32_bf16 v[120:123], v[212:215], a[40:43], v[120:123]
ds_read_b64_tr_b16 v[180:181], v13 offset:16384
v_mul_f32 v71, v55, v71
v_mfma_f32_16x16x32_bf16 v[124:127], v[212:215], a[44:47], v[124:127]
ds_read_b64_tr_b16 v[182:183], v13 offset:16896
v_mfma_f32_16x16x32_bf16 v[132:135], v[216:219], a[32:35], v[132:135]
ds_read_b64_tr_b16 v[188:189], v13 offset:20480
v_mfma_f32_16x16x32_bf16 v[136:139], v[216:219], a[36:39], v[136:139]
ds_read_b64_tr_b16 v[190:191], v13 offset:20992
v_mfma_f32_16x16x32_bf16 v[140:143], v[216:219], a[40:43], v[140:143]
ds_read_b64_tr_b16 v[184:185], v173 offset:12288
v_mfma_f32_16x16x32_bf16 v[144:147], v[216:219], a[44:47], v[144:147]
ds_read_b64_tr_b16 v[186:187], v173 offset:12800
s_waitcnt lgkmcnt(8)
v_mfma_f32_16x16x32_bf16 v[128:131], v[216:219], v[4:7], v[128:131]
ds_read_b128 v[8:11], v255 offset:3072
v_mfma_f32_16x16x32_bf16 v[196:199], a[32:35], v[168:171], v[196:199]
s_add_u32 s6, s38, 1105920
s_addc_u32 s7, s39, 0
v_mfma_f32_16x16x32_bf16 v[200:203], a[36:39], v[168:171], v[200:203]
s_add_u32 m0, s71, 28672
s_nop 0
global_load_lds_dwordx4 v175, s[6:7] offset:0
v_mfma_f32_16x16x32_bf16 v[204:207], a[40:43], v[168:171], v[204:207]
s_add_u32 m0, s71, 31616
s_nop 0
global_load_lds_dwordx4 v175, s[6:7] offset:1152
v_mfma_f32_16x16x32_bf16 v[208:211], a[44:47], v[168:171], v[208:211]
s_add_u32 m0, s71, 34560
s_nop 0
global_load_lds_dwordx4 v175, s[6:7] offset:2304
v_mfma_f32_16x16x32_bf16 v[192:195], v[4:7], v[168:171], v[192:195]
v_exp_f32 v248, v248
v_mfma_f32_16x16x32_bf16 v[152:155], v[220:223], a[32:35], v[152:155]
v_exp_f32 v249, v249
v_mfma_f32_16x16x32_bf16 v[156:159], v[220:223], a[36:39], v[156:159]
v_exp_f32 v250, v250
v_mfma_f32_16x16x32_bf16 v[160:163], v[220:223], a[40:43], v[160:163]
v_exp_f32 v251, v251
v_mfma_f32_16x16x32_bf16 v[164:167], v[220:223], a[44:47], v[164:167]
v_fma_f32 v248, v248, v241, v241
v_fma_f32 v249, v249, v241, v241
v_mfma_f32_16x16x32_bf16 v[148:151], v[220:223], v[4:7], v[148:151]
v_fma_f32 v250, v250, v241, v241
v_fma_f32 v251, v251, v241, v241
s_waitcnt lgkmcnt(0)
s_waitcnt vmcnt(15)
s_barrier
v_mfma_f32_16x16x32_bf16 v[112:115], v[176:179], a[48:51], v[112:115]
ds_read_b64_tr_b16 v[212:213], v13 offset:24576
v_mul_f32 v244, v56, v238
v_mfma_f32_16x16x32_bf16 v[116:119], v[176:179], a[52:55], v[116:119]
ds_read_b64_tr_b16 v[214:215], v13 offset:25088
v_mul_f32 v245, v57, v238
v_mfma_f32_16x16x32_bf16 v[120:123], v[176:179], a[56:59], v[120:123]
ds_read_b64_tr_b16 v[216:217], v13 offset:28672
v_mul_f32 v246, v58, v238
v_mfma_f32_16x16x32_bf16 v[124:127], v[176:179], a[60:63], v[124:127]
ds_read_b64_tr_b16 v[218:219], v13 offset:29184
v_mul_f32 v247, v59, v238
v_mfma_f32_16x16x32_bf16 v[132:135], v[180:183], a[48:51], v[132:135]
ds_read_b64_tr_b16 v[168:169], v13 offset:32768
v_mul_f32 v72, v56, v72
v_mfma_f32_16x16x32_bf16 v[136:139], v[180:183], a[52:55], v[136:139]
ds_read_b64_tr_b16 v[170:171], v13 offset:33280
v_mul_f32 v73, v57, v73
v_mfma_f32_16x16x32_bf16 v[140:143], v[180:183], a[56:59], v[140:143]
ds_read_b64_tr_b16 v[220:221], v173 offset:24576
v_mul_f32 v74, v58, v74
v_mfma_f32_16x16x32_bf16 v[144:147], v[180:183], a[60:63], v[144:147]
ds_read_b64_tr_b16 v[222:223], v173 offset:25088
v_mfma_f32_16x16x32_bf16 v[128:131], v[180:183], v[8:11], v[128:131]
ds_read_b128 v[4:7], v254 offset:4096
v_mfma_f32_16x16x32_bf16 v[196:199], a[48:51], v[188:191], v[196:199]
s_add_u32 s6, s38, 1216512
s_addc_u32 s7, s39, 0
v_mfma_f32_16x16x32_bf16 v[200:203], a[52:55], v[188:191], v[200:203]
s_add_u32 m0, s71, 40960
s_nop 0
global_load_lds_dwordx4 v175, s[6:7] offset:0
v_mfma_f32_16x16x32_bf16 v[204:207], a[56:59], v[188:191], v[204:207]
s_add_u32 m0, s71, 43904
s_nop 0
global_load_lds_dwordx4 v175, s[6:7] offset:1152
v_mfma_f32_16x16x32_bf16 v[208:211], a[60:63], v[188:191], v[208:211]
s_add_u32 m0, s71, 46848
s_nop 0
global_load_lds_dwordx4 v175, s[6:7] offset:2304
v_mfma_f32_16x16x32_bf16 v[192:195], v[8:11], v[188:191], v[192:195]
v_rcp_f32 v248, v248
v_mfma_f32_16x16x32_bf16 v[152:155], v[184:187], a[48:51], v[152:155]
v_rcp_f32 v249, v249
v_mfma_f32_16x16x32_bf16 v[156:159], v[184:187], a[52:55], v[156:159]
v_rcp_f32 v250, v250
v_mfma_f32_16x16x32_bf16 v[160:163], v[184:187], a[56:59], v[160:163]
v_rcp_f32 v251, v251
v_mfma_f32_16x16x32_bf16 v[164:167], v[184:187], a[60:63], v[164:167]
v_mul_f32 v68, v68, v248
v_mul_f32 v69, v69, v249
v_mfma_f32_16x16x32_bf16 v[148:151], v[184:187], v[8:11], v[148:151]
v_mul_f32 v70, v70, v250
v_mul_f32 v71, v71, v251
s_waitcnt lgkmcnt(5)
v_mfma_f32_16x16x32_bf16 v[112:115], v[212:215], a[64:67], v[112:115]
ds_read_b64_tr_b16 v[176:177], v13 offset:36864
v_cvt_pk_bf16_f32 v68, v68, v69
v_mfma_f32_16x16x32_bf16 v[116:119], v[212:215], a[68:71], v[116:119]
ds_read_b64_tr_b16 v[178:179], v13 offset:37376
v_cvt_pk_bf16_f32 v69, v70, v71
v_mfma_f32_16x16x32_bf16 v[120:123], v[212:215], a[72:75], v[120:123]
ds_read_b64_tr_b16 v[180:181], v13 offset:40960
v_mul_f32 v75, v59, v75
v_mfma_f32_16x16x32_bf16 v[124:127], v[212:215], a[76:79], v[124:127]
ds_read_b64_tr_b16 v[182:183], v13 offset:41472
v_mfma_f32_16x16x32_bf16 v[132:135], v[216:219], a[64:67], v[132:135]
ds_read_b64_tr_b16 v[188:189], v13 offset:45056
v_mfma_f32_16x16x32_bf16 v[136:139], v[216:219], a[68:71], v[136:139]
ds_read_b64_tr_b16 v[190:191], v13 offset:45568
v_mfma_f32_16x16x32_bf16 v[140:143], v[216:219], a[72:75], v[140:143]
ds_read_b64_tr_b16 v[184:185], v173 offset:36864
v_mfma_f32_16x16x32_bf16 v[144:147], v[216:219], a[76:79], v[144:147]
ds_read_b64_tr_b16 v[186:187], v173 offset:37376
s_waitcnt lgkmcnt(8)
v_mfma_f32_16x16x32_bf16 v[128:131], v[216:219], v[4:7], v[128:131]
ds_read_b128 v[8:11], v255 offset:5120
v_mfma_f32_16x16x32_bf16 v[196:199], a[64:67], v[168:171], v[196:199]
s_add_u32 s6, s38, 1327104
s_addc_u32 s7, s39, 0
v_mfma_f32_16x16x32_bf16 v[200:203], a[68:71], v[168:171], v[200:203]
s_add_u32 m0, s71, 53248
s_nop 0
global_load_lds_dwordx4 v175, s[6:7] offset:0
v_mfma_f32_16x16x32_bf16 v[204:207], a[72:75], v[168:171], v[204:207]
s_add_u32 m0, s71, 56192
s_nop 0
global_load_lds_dwordx4 v175, s[6:7] offset:1152
v_mfma_f32_16x16x32_bf16 v[208:211], a[76:79], v[168:171], v[208:211]
s_add_u32 m0, s71, 59136
s_nop 0
global_load_lds_dwordx4 v175, s[6:7] offset:2304
v_mfma_f32_16x16x32_bf16 v[192:195], v[4:7], v[168:171], v[192:195]
v_exp_f32 v244, v244
v_mfma_f32_16x16x32_bf16 v[152:155], v[220:223], a[64:67], v[152:155]
v_exp_f32 v245, v245
v_mfma_f32_16x16x32_bf16 v[156:159], v[220:223], a[68:71], v[156:159]
v_exp_f32 v246, v246
v_mfma_f32_16x16x32_bf16 v[160:163], v[220:223], a[72:75], v[160:163]
v_exp_f32 v247, v247
v_mfma_f32_16x16x32_bf16 v[164:167], v[220:223], a[76:79], v[164:167]
v_fma_f32 v244, v244, v242, v242
v_fma_f32 v245, v245, v242, v242
v_mfma_f32_16x16x32_bf16 v[148:151], v[220:223], v[4:7], v[148:151]
v_fma_f32 v246, v246, v242, v242
v_fma_f32 v247, v247, v242, v242
s_waitcnt lgkmcnt(0)
s_waitcnt vmcnt(15)
s_barrier
v_mfma_f32_16x16x32_bf16 v[112:115], v[176:179], a[80:83], v[112:115]
ds_read_b64_tr_b16 v[212:213], v14 offset:0
v_mul_f32 v248, v60, v239
v_mfma_f32_16x16x32_bf16 v[116:119], v[176:179], a[84:87], v[116:119]
ds_read_b64_tr_b16 v[214:215], v14 offset:512
v_mul_f32 v249, v61, v239
v_mfma_f32_16x16x32_bf16 v[120:123], v[176:179], a[88:91], v[120:123]
ds_read_b64_tr_b16 v[216:217], v14 offset:4096
v_mul_f32 v250, v62, v239
v_mfma_f32_16x16x32_bf16 v[124:127], v[176:179], a[92:95], v[124:127]
ds_read_b64_tr_b16 v[218:219], v14 offset:4608
v_mul_f32 v251, v63, v239
v_mfma_f32_16x16x32_bf16 v[132:135], v[180:183], a[80:83], v[132:135]
ds_read_b64_tr_b16 v[168:169], v14 offset:8192
v_mul_f32 v76, v60, v76
v_mfma_f32_16x16x32_bf16 v[136:139], v[180:183], a[84:87], v[136:139]
ds_read_b64_tr_b16 v[170:171], v14 offset:8704
v_mul_f32 v77, v61, v77
v_mfma_f32_16x16x32_bf16 v[140:143], v[180:183], a[88:91], v[140:143]
ds_read_b64_tr_b16 v[220:221], v174 offset:0
v_mul_f32 v78, v62, v78
v_mfma_f32_16x16x32_bf16 v[144:147], v[180:183], a[92:95], v[144:147]
ds_read_b64_tr_b16 v[222:223], v174 offset:512
v_mfma_f32_16x16x32_bf16 v[128:131], v[180:183], v[8:11], v[128:131]
ds_read_b128 v[4:7], v254 offset:6144
v_mfma_f32_16x16x32_bf16 v[196:199], a[80:83], v[188:191], v[196:199]
s_add_u32 s6, s38, 1437696
s_addc_u32 s7, s39, 0
v_mfma_f32_16x16x32_bf16 v[200:203], a[84:87], v[188:191], v[200:203]
s_add_u32 m0, s71, 65536
s_nop 0
global_load_lds_dwordx4 v175, s[6:7] offset:0
v_mfma_f32_16x16x32_bf16 v[204:207], a[88:91], v[188:191], v[204:207]
s_add_u32 m0, s71, 68480
s_nop 0
global_load_lds_dwordx4 v175, s[6:7] offset:1152
v_mfma_f32_16x16x32_bf16 v[208:211], a[92:95], v[188:191], v[208:211]
s_add_u32 m0, s71, 71424
s_nop 0
global_load_lds_dwordx4 v175, s[6:7] offset:2304
v_mfma_f32_16x16x32_bf16 v[192:195], v[8:11], v[188:191], v[192:195]
v_rcp_f32 v244, v244
v_mfma_f32_16x16x32_bf16 v[152:155], v[184:187], a[80:83], v[152:155]
v_rcp_f32 v245, v245
v_mfma_f32_16x16x32_bf16 v[156:159], v[184:187], a[84:87], v[156:159]
v_rcp_f32 v246, v246
v_mfma_f32_16x16x32_bf16 v[160:163], v[184:187], a[88:91], v[160:163]
v_rcp_f32 v247, v247
v_mfma_f32_16x16x32_bf16 v[164:167], v[184:187], a[92:95], v[164:167]
v_mul_f32 v72, v72, v244
v_mul_f32 v73, v73, v245
v_mfma_f32_16x16x32_bf16 v[148:151], v[184:187], v[8:11], v[148:151]
v_mul_f32 v74, v74, v246
v_mul_f32 v75, v75, v247
s_waitcnt lgkmcnt(5)
v_mfma_f32_16x16x32_bf16 v[112:115], v[212:215], a[96:99], v[112:115]
ds_read_b64_tr_b16 v[176:177], v14 offset:12288
v_cvt_pk_bf16_f32 v72, v72, v73
v_mfma_f32_16x16x32_bf16 v[116:119], v[212:215], a[100:103], v[116:119]
ds_read_b64_tr_b16 v[178:179], v14 offset:12800
v_cvt_pk_bf16_f32 v73, v74, v75
v_mfma_f32_16x16x32_bf16 v[120:123], v[212:215], a[104:107], v[120:123]
ds_read_b64_tr_b16 v[180:181], v14 offset:16384
v_mul_f32 v79, v63, v79
v_mfma_f32_16x16x32_bf16 v[124:127], v[212:215], a[108:111], v[124:127]
ds_read_b64_tr_b16 v[182:183], v14 offset:16896
v_mfma_f32_16x16x32_bf16 v[132:135], v[216:219], a[96:99], v[132:135]
ds_read_b64_tr_b16 v[188:189], v14 offset:20480
v_mfma_f32_16x16x32_bf16 v[136:139], v[216:219], a[100:103], v[136:139]
ds_read_b64_tr_b16 v[190:191], v14 offset:20992
v_mfma_f32_16x16x32_bf16 v[140:143], v[216:219], a[104:107], v[140:143]
ds_read_b64_tr_b16 v[184:185], v174 offset:12288
v_mfma_f32_16x16x32_bf16 v[144:147], v[216:219], a[108:111], v[144:147]
ds_read_b64_tr_b16 v[186:187], v174 offset:12800
s_waitcnt lgkmcnt(8)
v_mfma_f32_16x16x32_bf16 v[128:131], v[216:219], v[4:7], v[128:131]
ds_read_b128 v[8:11], v255 offset:7168
v_mfma_f32_16x16x32_bf16 v[196:199], a[96:99], v[168:171], v[196:199]
s_add_u32 s6, s38, 1548288
s_addc_u32 s7, s39, 0
v_mfma_f32_16x16x32_bf16 v[200:203], a[100:103], v[168:171], v[200:203]
s_add_u32 m0, s71, 77824
s_nop 0
global_load_lds_dwordx4 v175, s[6:7] offset:0
v_mfma_f32_16x16x32_bf16 v[204:207], a[104:107], v[168:171], v[204:207]
s_add_u32 m0, s71, 80768
s_nop 0
global_load_lds_dwordx4 v175, s[6:7] offset:1152
v_mfma_f32_16x16x32_bf16 v[208:211], a[108:111], v[168:171], v[208:211]
s_add_u32 m0, s71, 83712
s_nop 0
global_load_lds_dwordx4 v175, s[6:7] offset:2304
v_mfma_f32_16x16x32_bf16 v[192:195], v[4:7], v[168:171], v[192:195]
v_exp_f32 v248, v248
v_mfma_f32_16x16x32_bf16 v[152:155], v[220:223], a[96:99], v[152:155]
v_exp_f32 v249, v249
v_mfma_f32_16x16x32_bf16 v[156:159], v[220:223], a[100:103], v[156:159]
v_exp_f32 v250, v250
v_mfma_f32_16x16x32_bf16 v[160:163], v[220:223], a[104:107], v[160:163]
v_exp_f32 v251, v251
v_mfma_f32_16x16x32_bf16 v[164:167], v[220:223], a[108:111], v[164:167]
v_fma_f32 v248, v248, v243, v243
v_fma_f32 v249, v249, v243, v243
v_mfma_f32_16x16x32_bf16 v[148:151], v[220:223], v[4:7], v[148:151]
v_fma_f32 v250, v250, v243, v243
v_fma_f32 v251, v251, v243, v243
s_waitcnt lgkmcnt(0)
s_waitcnt vmcnt(15)
s_barrier
v_mfma_f32_16x16x32_bf16 v[112:115], v[176:179], a[112:115], v[112:115]
ds_read_b64_tr_b16 v[212:213], v12 offset:0
v_mul_f32 v244, v80, v236
v_mfma_f32_16x16x32_bf16 v[116:119], v[176:179], a[116:119], v[116:119]
ds_read_b64_tr_b16 v[214:215], v12 offset:512
v_mul_f32 v245, v81, v236
v_mfma_f32_16x16x32_bf16 v[120:123], v[176:179], a[120:123], v[120:123]
ds_read_b64_tr_b16 v[216:217], v12 offset:4096
v_mul_f32 v246, v82, v236
v_mfma_f32_16x16x32_bf16 v[124:127], v[176:179], a[124:127], v[124:127]
ds_read_b64_tr_b16 v[218:219], v12 offset:4608
v_mul_f32 v247, v83, v236
v_mfma_f32_16x16x32_bf16 v[132:135], v[180:183], a[112:115], v[132:135]
ds_read_b64_tr_b16 v[168:169], v12 offset:8192
v_mul_f32 v96, v80, v96
v_mfma_f32_16x16x32_bf16 v[136:139], v[180:183], a[116:119], v[136:139]
ds_read_b64_tr_b16 v[170:171], v12 offset:8704
v_mul_f32 v97, v81, v97
v_mfma_f32_16x16x32_bf16 v[140:143], v[180:183], a[120:123], v[140:143]
ds_read_b64_tr_b16 v[220:221], v172 offset:0
v_mul_f32 v98, v82, v98
v_mfma_f32_16x16x32_bf16 v[144:147], v[180:183], a[124:127], v[144:147]
ds_read_b64_tr_b16 v[222:223], v172 offset:512
v_mfma_f32_16x16x32_bf16 v[128:131], v[180:183], v[8:11], v[128:131]
ds_read_b128 v[4:7], v254 offset:8192
v_mfma_f32_16x16x32_bf16 v[196:199], a[112:115], v[188:191], v[196:199]
s_add_u32 s6, s38, 1658880
s_addc_u32 s7, s39, 0
v_mfma_f32_16x16x32_bf16 v[200:203], a[116:119], v[188:191], v[200:203]
s_add_u32 m0, s71, 90112
s_nop 0
global_load_lds_dwordx4 v175, s[6:7] offset:0
v_mfma_f32_16x16x32_bf16 v[204:207], a[120:123], v[188:191], v[204:207]
s_add_u32 m0, s71, 93056
s_nop 0
global_load_lds_dwordx4 v175, s[6:7] offset:1152
v_mfma_f32_16x16x32_bf16 v[208:211], a[124:127], v[188:191], v[208:211]
s_add_u32 m0, s71, 96000
s_nop 0
global_load_lds_dwordx4 v175, s[6:7] offset:2304
v_mfma_f32_16x16x32_bf16 v[192:195], v[8:11], v[188:191], v[192:195]
v_rcp_f32 v248, v248
v_mfma_f32_16x16x32_bf16 v[152:155], v[184:187], a[112:115], v[152:155]
v_rcp_f32 v249, v249
v_mfma_f32_16x16x32_bf16 v[156:159], v[184:187], a[116:119], v[156:159]
v_rcp_f32 v250, v250
v_mfma_f32_16x16x32_bf16 v[160:163], v[184:187], a[120:123], v[160:163]
v_rcp_f32 v251, v251
v_mfma_f32_16x16x32_bf16 v[164:167], v[184:187], a[124:127], v[164:167]
v_mul_f32 v76, v76, v248
v_mul_f32 v77, v77, v249
v_mfma_f32_16x16x32_bf16 v[148:151], v[184:187], v[8:11], v[148:151]
v_mul_f32 v78, v78, v250
v_mul_f32 v79, v79, v251
s_waitcnt lgkmcnt(5)
v_mfma_f32_16x16x32_bf16 v[112:115], v[212:215], a[128:131], v[112:115]
ds_read_b64_tr_b16 v[176:177], v12 offset:12288
v_cvt_pk_bf16_f32 v76, v76, v77
v_mfma_f32_16x16x32_bf16 v[116:119], v[212:215], a[132:135], v[116:119]
ds_read_b64_tr_b16 v[178:179], v12 offset:12800
v_cvt_pk_bf16_f32 v77, v78, v79
v_mfma_f32_16x16x32_bf16 v[120:123], v[212:215], a[136:139], v[120:123]
ds_read_b64_tr_b16 v[180:181], v12 offset:16384
v_mul_f32 v99, v83, v99
v_mfma_f32_16x16x32_bf16 v[124:127], v[212:215], a[140:143], v[124:127]
ds_read_b64_tr_b16 v[182:183], v12 offset:16896
v_mfma_f32_16x16x32_bf16 v[132:135], v[216:219], a[128:131], v[132:135]
ds_read_b64_tr_b16 v[188:189], v12 offset:20480
v_mfma_f32_16x16x32_bf16 v[136:139], v[216:219], a[132:135], v[136:139]
ds_read_b64_tr_b16 v[190:191], v12 offset:20992
v_mfma_f32_16x16x32_bf16 v[140:143], v[216:219], a[136:139], v[140:143]
ds_read_b64_tr_b16 v[184:185], v172 offset:12288
v_mfma_f32_16x16x32_bf16 v[144:147], v[216:219], a[140:143], v[144:147]
ds_read_b64_tr_b16 v[186:187], v172 offset:12800
s_waitcnt lgkmcnt(8)
v_mfma_f32_16x16x32_bf16 v[128:131], v[216:219], v[4:7], v[128:131]
ds_read_b128 v[8:11], v255 offset:9216
v_mfma_f32_16x16x32_bf16 v[196:199], a[128:131], v[168:171], v[196:199]
s_add_u32 s6, s38, 1769472
s_addc_u32 s7, s39, 0
v_mfma_f32_16x16x32_bf16 v[200:203], a[132:135], v[168:171], v[200:203]
s_add_u32 m0, s71, 102400
s_nop 0
global_load_lds_dwordx4 v175, s[6:7] offset:0
v_mfma_f32_16x16x32_bf16 v[204:207], a[136:139], v[168:171], v[204:207]
s_add_u32 m0, s71, 105344
s_nop 0
global_load_lds_dwordx4 v175, s[6:7] offset:1152
v_mfma_f32_16x16x32_bf16 v[208:211], a[140:143], v[168:171], v[208:211]
s_add_u32 m0, s71, 108288
s_nop 0
global_load_lds_dwordx4 v175, s[6:7] offset:2304
v_mfma_f32_16x16x32_bf16 v[192:195], v[4:7], v[168:171], v[192:195]
v_exp_f32 v244, v244
v_mfma_f32_16x16x32_bf16 v[152:155], v[220:223], a[128:131], v[152:155]
v_exp_f32 v245, v245
v_mfma_f32_16x16x32_bf16 v[156:159], v[220:223], a[132:135], v[156:159]
v_exp_f32 v246, v246
v_mfma_f32_16x16x32_bf16 v[160:163], v[220:223], a[136:139], v[160:163]
v_exp_f32 v247, v247
v_mfma_f32_16x16x32_bf16 v[164:167], v[220:223], a[140:143], v[164:167]
v_fma_f32 v244, v244, v240, v240
v_fma_f32 v245, v245, v240, v240
v_mfma_f32_16x16x32_bf16 v[148:151], v[220:223], v[4:7], v[148:151]
v_fma_f32 v246, v246, v240, v240
v_fma_f32 v247, v247, v240, v240
s_waitcnt lgkmcnt(0)
s_waitcnt vmcnt(15)
s_barrier
v_mfma_f32_16x16x32_bf16 v[112:115], v[176:179], a[144:147], v[112:115]
ds_read_b64_tr_b16 v[212:213], v12 offset:24576
v_mul_f32 v248, v84, v237
v_mfma_f32_16x16x32_bf16 v[116:119], v[176:179], a[148:151], v[116:119]
ds_read_b64_tr_b16 v[214:215], v12 offset:25088
v_mul_f32 v249, v85, v237
v_mfma_f32_16x16x32_bf16 v[120:123], v[176:179], a[152:155], v[120:123]
ds_read_b64_tr_b16 v[216:217], v12 offset:28672
v_mul_f32 v250, v86, v237
v_mfma_f32_16x16x32_bf16 v[124:127], v[176:179], a[156:159], v[124:127]
ds_read_b64_tr_b16 v[218:219], v12 offset:29184
v_mul_f32 v251, v87, v237
v_mfma_f32_16x16x32_bf16 v[132:135], v[180:183], a[144:147], v[132:135]
ds_read_b64_tr_b16 v[168:169], v12 offset:32768
v_mul_f32 v100, v84, v100
v_mfma_f32_16x16x32_bf16 v[136:139], v[180:183], a[148:151], v[136:139]
ds_read_b64_tr_b16 v[170:171], v12 offset:33280
v_mul_f32 v101, v85, v101
v_mfma_f32_16x16x32_bf16 v[140:143], v[180:183], a[152:155], v[140:143]
ds_read_b64_tr_b16 v[220:221], v172 offset:24576
v_mul_f32 v102, v86, v102
v_mfma_f32_16x16x32_bf16 v[144:147], v[180:183], a[156:159], v[144:147]
ds_read_b64_tr_b16 v[222:223], v172 offset:25088
v_mfma_f32_16x16x32_bf16 v[128:131], v[180:183], v[8:11], v[128:131]
ds_read_b128 v[4:7], v254 offset:10240
v_mfma_f32_16x16x32_bf16 v[196:199], a[144:147], v[188:191], v[196:199]
s_add_u32 s6, s38, 1880064
s_addc_u32 s7, s39, 0
v_mfma_f32_16x16x32_bf16 v[200:203], a[148:151], v[188:191], v[200:203]
s_add_u32 m0, s71, 114688
s_nop 0
global_load_lds_dwordx4 v175, s[6:7] offset:0
v_mfma_f32_16x16x32_bf16 v[204:207], a[152:155], v[188:191], v[204:207]
s_add_u32 m0, s71, 117632
s_nop 0
global_load_lds_dwordx4 v175, s[6:7] offset:1152
v_mfma_f32_16x16x32_bf16 v[208:211], a[156:159], v[188:191], v[208:211]
s_add_u32 m0, s71, 120576
s_nop 0
global_load_lds_dwordx4 v175, s[6:7] offset:2304
v_mfma_f32_16x16x32_bf16 v[192:195], v[8:11], v[188:191], v[192:195]
v_rcp_f32 v244, v244
v_mfma_f32_16x16x32_bf16 v[152:155], v[184:187], a[144:147], v[152:155]
v_rcp_f32 v245, v245
v_mfma_f32_16x16x32_bf16 v[156:159], v[184:187], a[148:151], v[156:159]
v_rcp_f32 v246, v246
v_mfma_f32_16x16x32_bf16 v[160:163], v[184:187], a[152:155], v[160:163]
v_rcp_f32 v247, v247
v_mfma_f32_16x16x32_bf16 v[164:167], v[184:187], a[156:159], v[164:167]
v_mul_f32 v96, v96, v244
v_mul_f32 v97, v97, v245
v_mfma_f32_16x16x32_bf16 v[148:151], v[184:187], v[8:11], v[148:151]
v_mul_f32 v98, v98, v246
v_mul_f32 v99, v99, v247
s_waitcnt lgkmcnt(5)
v_mfma_f32_16x16x32_bf16 v[112:115], v[212:215], a[160:163], v[112:115]
ds_read_b64_tr_b16 v[176:177], v12 offset:36864
v_cvt_pk_bf16_f32 v96, v96, v97
v_mfma_f32_16x16x32_bf16 v[116:119], v[212:215], a[164:167], v[116:119]
ds_read_b64_tr_b16 v[178:179], v12 offset:37376
v_cvt_pk_bf16_f32 v97, v98, v99
v_mfma_f32_16x16x32_bf16 v[120:123], v[212:215], a[168:171], v[120:123]
ds_read_b64_tr_b16 v[180:181], v12 offset:40960
v_mul_f32 v103, v87, v103
v_mfma_f32_16x16x32_bf16 v[124:127], v[212:215], a[172:175], v[124:127]
ds_read_b64_tr_b16 v[182:183], v12 offset:41472
v_mfma_f32_16x16x32_bf16 v[132:135], v[216:219], a[160:163], v[132:135]
ds_read_b64_tr_b16 v[188:189], v12 offset:45056
v_mfma_f32_16x16x32_bf16 v[136:139], v[216:219], a[164:167], v[136:139]
ds_read_b64_tr_b16 v[190:191], v12 offset:45568
v_mfma_f32_16x16x32_bf16 v[140:143], v[216:219], a[168:171], v[140:143]
ds_read_b64_tr_b16 v[184:185], v172 offset:36864
v_mfma_f32_16x16x32_bf16 v[144:147], v[216:219], a[172:175], v[144:147]
ds_read_b64_tr_b16 v[186:187], v172 offset:37376
s_waitcnt lgkmcnt(8)
v_mfma_f32_16x16x32_bf16 v[128:131], v[216:219], v[4:7], v[128:131]
ds_read_b128 v[8:11], v255 offset:11264
v_mfma_f32_16x16x32_bf16 v[196:199], a[160:163], v[168:171], v[196:199]
s_add_u32 s4, s32, 128
s_addc_u32 s5, s33, 0
v_mfma_f32_16x16x32_bf16 v[200:203], a[164:167], v[168:171], v[200:203]
s_add_u32 m0, s73, 0
s_nop 0
global_load_lds_dwordx4 v224, s[4:5] offset:0
v_mfma_f32_16x16x32_bf16 v[204:207], a[168:171], v[168:171], v[204:207]
global_load_lds_dwordx4 v225, s[4:5] offset:1024
v_mfma_f32_16x16x32_bf16 v[208:211], a[172:175], v[168:171], v[208:211]
v_exp_f32 v248, v248
v_mfma_f32_16x16x32_bf16 v[192:195], v[4:7], v[168:171], v[192:195]
v_exp_f32 v249, v249
v_mfma_f32_16x16x32_bf16 v[152:155], v[220:223], a[160:163], v[152:155]
v_exp_f32 v250, v250
v_mfma_f32_16x16x32_bf16 v[156:159], v[220:223], a[164:167], v[156:159]
v_exp_f32 v251, v251
v_mfma_f32_16x16x32_bf16 v[160:163], v[220:223], a[168:171], v[160:163]
v_fma_f32 v248, v248, v241, v241
v_fma_f32 v249, v249, v241, v241
v_mfma_f32_16x16x32_bf16 v[164:167], v[220:223], a[172:175], v[164:167]
v_fma_f32 v250, v250, v241, v241
v_fma_f32 v251, v251, v241, v241
v_mfma_f32_16x16x32_bf16 v[148:151], v[220:223], v[4:7], v[148:151]
v_rcp_f32 v248, v248
s_waitcnt lgkmcnt(0)
s_waitcnt vmcnt(14)
s_barrier
v_mfma_f32_16x16x32_bf16 v[112:115], v[176:179], a[176:179], v[112:115]
ds_read_b64_tr_b16 v[212:213], v13 offset:0
v_mul_f32 v100, v100, v248
v_mfma_f32_16x16x32_bf16 v[116:119], v[176:179], a[180:183], v[116:119]
ds_read_b64_tr_b16 v[214:215], v13 offset:512
v_mul_f32 v244, v88, v238
v_mfma_f32_16x16x32_bf16 v[120:123], v[176:179], a[184:187], v[120:123]
ds_read_b64_tr_b16 v[216:217], v13 offset:4096
v_mul_f32 v245, v89, v238
v_mfma_f32_16x16x32_bf16 v[124:127], v[176:179], a[188:191], v[124:127]
ds_read_b64_tr_b16 v[218:219], v13 offset:4608
v_mul_f32 v246, v90, v238
v_mfma_f32_16x16x32_bf16 v[132:135], v[180:183], a[176:179], v[132:135]
ds_read_b64_tr_b16 v[168:169], v13 offset:8192
v_mul_f32 v247, v91, v238
v_mfma_f32_16x16x32_bf16 v[136:139], v[180:183], a[180:183], v[136:139]
ds_read_b64_tr_b16 v[170:171], v13 offset:8704
v_mul_f32 v104, v88, v104
v_mfma_f32_16x16x32_bf16 v[140:143], v[180:183], a[184:187], v[140:143]
ds_read_b64_tr_b16 v[220:221], v173 offset:0
v_mul_f32 v105, v89, v105
v_mfma_f32_16x16x32_bf16 v[144:147], v[180:183], a[188:191], v[144:147]
ds_read_b64_tr_b16 v[222:223], v173 offset:512
v_mul_f32 v106, v90, v106
v_mfma_f32_16x16x32_bf16 v[128:131], v[180:183], v[8:11], v[128:131]
ds_read_b128 v[4:7], v254 offset:12288
v_mul_f32 v107, v91, v107
v_mfma_f32_16x16x32_bf16 v[196:199], a[176:179], v[188:191], v[196:199]
global_load_lds_dwordx4 v226, s[4:5] offset:2048
v_mfma_f32_16x16x32_bf16 v[200:203], a[180:183], v[188:191], v[200:203]
global_load_lds_dwordx4 v227, s[4:5] offset:3072
v_mfma_f32_16x16x32_bf16 v[204:207], a[184:187], v[188:191], v[204:207]
s_add_u32 m0, s73, 4096
s_nop 0
global_load_lds_dwordx4 v228, s[4:5] offset:0
v_mfma_f32_16x16x32_bf16 v[208:211], a[188:191], v[188:191], v[208:211]
global_load_lds_dwordx4 v229, s[4:5] offset:1024
v_mfma_f32_16x16x32_bf16 v[192:195], v[8:11], v[188:191], v[192:195]
v_rcp_f32 v249, v249
v_mfma_f32_16x16x32_bf16 v[152:155], v[184:187], a[176:179], v[152:155]
v_rcp_f32 v250, v250
v_mfma_f32_16x16x32_bf16 v[156:159], v[184:187], a[180:183], v[156:159]
v_rcp_f32 v251, v251
v_mfma_f32_16x16x32_bf16 v[160:163], v[184:187], a[184:187], v[160:163]
v_mul_f32 v101, v101, v249
v_mul_f32 v102, v102, v250
v_mfma_f32_16x16x32_bf16 v[164:167], v[184:187], a[188:191], v[164:167]
v_mul_f32 v103, v103, v251
v_cvt_pk_bf16_f32 v100, v100, v101
v_mfma_f32_16x16x32_bf16 v[148:151], v[184:187], v[8:11], v[148:151]
v_cvt_pk_bf16_f32 v101, v102, v103
s_waitcnt lgkmcnt(5)
v_mfma_f32_16x16x32_bf16 v[112:115], v[212:215], a[192:195], v[112:115]
ds_read_b64_tr_b16 v[176:177], v13 offset:12288
v_mfma_f32_16x16x32_bf16 v[116:119], v[212:215], a[196:199], v[116:119]
ds_read_b64_tr_b16 v[178:179], v13 offset:12800
v_mfma_f32_16x16x32_bf16 v[120:123], v[212:215], a[200:203], v[120:123]
ds_read_b64_tr_b16 v[180:181], v13 offset:16384
v_mfma_f32_16x16x32_bf16 v[124:127], v[212:215], a[204:207], v[124:127]
ds_read_b64_tr_b16 v[182:183], v13 offset:16896
v_mfma_f32_16x16x32_bf16 v[132:135], v[216:219], a[192:195], v[132:135]
ds_read_b64_tr_b16 v[188:189], v13 offset:20480
v_mfma_f32_16x16x32_bf16 v[136:139], v[216:219], a[196:199], v[136:139]
ds_read_b64_tr_b16 v[190:191], v13 offset:20992
v_mfma_f32_16x16x32_bf16 v[140:143], v[216:219], a[200:203], v[140:143]
ds_read_b64_tr_b16 v[184:185], v173 offset:12288
v_mfma_f32_16x16x32_bf16 v[144:147], v[216:219], a[204:207], v[144:147]
ds_read_b64_tr_b16 v[186:187], v173 offset:12800
s_waitcnt lgkmcnt(8)
v_mfma_f32_16x16x32_bf16 v[128:131], v[216:219], v[4:7], v[128:131]
ds_read_b128 v[8:11], v255 offset:13312
v_mfma_f32_16x16x32_bf16 v[196:199], a[192:195], v[168:171], v[196:199]
s_add_u32 s4, s32, 884864
s_addc_u32 s5, s33, 0
v_mfma_f32_16x16x32_bf16 v[200:203], a[196:199], v[168:171], v[200:203]
s_add_u32 m0, s73, 24576
s_nop 0
global_load_lds_dwordx4 v224, s[4:5] offset:0
v_mfma_f32_16x16x32_bf16 v[204:207], a[200:203], v[168:171], v[204:207]
global_load_lds_dwordx4 v225, s[4:5] offset:1024
v_mfma_f32_16x16x32_bf16 v[208:211], a[204:207], v[168:171], v[208:211]
v_exp_f32 v244, v244
v_mfma_f32_16x16x32_bf16 v[192:195], v[4:7], v[168:171], v[192:195]
v_exp_f32 v245, v245
v_mfma_f32_16x16x32_bf16 v[152:155], v[220:223], a[192:195], v[152:155]
v_exp_f32 v246, v246
v_mfma_f32_16x16x32_bf16 v[156:159], v[220:223], a[196:199], v[156:159]
v_exp_f32 v247, v247
v_mfma_f32_16x16x32_bf16 v[160:163], v[220:223], a[200:203], v[160:163]
v_fma_f32 v244, v244, v242, v242
v_fma_f32 v245, v245, v242, v242
v_mfma_f32_16x16x32_bf16 v[164:167], v[220:223], a[204:207], v[164:167]
v_fma_f32 v246, v246, v242, v242
v_fma_f32 v247, v247, v242, v242
v_mfma_f32_16x16x32_bf16 v[148:151], v[220:223], v[4:7], v[148:151]
v_rcp_f32 v244, v244
s_waitcnt lgkmcnt(0)
s_waitcnt vmcnt(14)
s_barrier
v_mfma_f32_16x16x32_bf16 v[112:115], v[176:179], a[208:211], v[112:115]
ds_read_b64_tr_b16 v[212:213], v13 offset:24576
v_mul_f32 v104, v104, v244
v_mfma_f32_16x16x32_bf16 v[116:119], v[176:179], a[212:215], v[116:119]
ds_read_b64_tr_b16 v[214:215], v13 offset:25088
v_mul_f32 v248, v92, v239
v_mfma_f32_16x16x32_bf16 v[120:123], v[176:179], a[216:219], v[120:123]
ds_read_b64_tr_b16 v[216:217], v13 offset:28672
v_mul_f32 v249, v93, v239
v_mfma_f32_16x16x32_bf16 v[124:127], v[176:179], a[220:223], v[124:127]
ds_read_b64_tr_b16 v[218:219], v13 offset:29184
v_mul_f32 v250, v94, v239
v_mfma_f32_16x16x32_bf16 v[132:135], v[180:183], a[208:211], v[132:135]
ds_read_b64_tr_b16 v[168:169], v13 offset:32768
v_mul_f32 v251, v95, v239
v_mfma_f32_16x16x32_bf16 v[136:139], v[180:183], a[212:215], v[136:139]
ds_read_b64_tr_b16 v[170:171], v13 offset:33280
v_mul_f32 v108, v92, v108
v_mfma_f32_16x16x32_bf16 v[140:143], v[180:183], a[216:219], v[140:143]
ds_read_b64_tr_b16 v[220:221], v173 offset:24576
v_mul_f32 v109, v93, v109
v_mfma_f32_16x16x32_bf16 v[144:147], v[180:183], a[220:223], v[144:147]
ds_read_b64_tr_b16 v[222:223], v173 offset:25088
v_mul_f32 v110, v94, v110
v_mfma_f32_16x16x32_bf16 v[128:131], v[180:183], v[8:11], v[128:131]
ds_read_b128 v[4:7], v254 offset:14336
v_mul_f32 v111, v95, v111
v_mfma_f32_16x16x32_bf16 v[196:199], a[208:211], v[188:191], v[196:199]
global_load_lds_dwordx4 v226, s[4:5] offset:2048
v_mfma_f32_16x16x32_bf16 v[200:203], a[212:215], v[188:191], v[200:203]
global_load_lds_dwordx4 v227, s[4:5] offset:3072
v_mfma_f32_16x16x32_bf16 v[204:207], a[216:219], v[188:191], v[204:207]
s_add_u32 m0, s73, 28672
s_nop 0
global_load_lds_dwordx4 v228, s[4:5] offset:0
v_mfma_f32_16x16x32_bf16 v[208:211], a[220:223], v[188:191], v[208:211]
global_load_lds_dwordx4 v229, s[4:5] offset:1024
v_mfma_f32_16x16x32_bf16 v[192:195], v[8:11], v[188:191], v[192:195]
v_rcp_f32 v245, v245
v_mfma_f32_16x16x32_bf16 v[152:155], v[184:187], a[208:211], v[152:155]
v_rcp_f32 v246, v246
v_mfma_f32_16x16x32_bf16 v[156:159], v[184:187], a[212:215], v[156:159]
v_rcp_f32 v247, v247
v_mfma_f32_16x16x32_bf16 v[160:163], v[184:187], a[216:219], v[160:163]
v_mul_f32 v105, v105, v245
v_mul_f32 v106, v106, v246
v_mfma_f32_16x16x32_bf16 v[164:167], v[184:187], a[220:223], v[164:167]
v_mul_f32 v107, v107, v247
v_cvt_pk_bf16_f32 v104, v104, v105
v_mfma_f32_16x16x32_bf16 v[148:151], v[184:187], v[8:11], v[148:151]
v_cvt_pk_bf16_f32 v105, v106, v107
s_waitcnt lgkmcnt(5)
v_mfma_f32_16x16x32_bf16 v[112:115], v[212:215], a[224:227], v[112:115]
ds_read_b64_tr_b16 v[176:177], v13 offset:36864
v_mfma_f32_16x16x32_bf16 v[116:119], v[212:215], a[228:231], v[116:119]
ds_read_b64_tr_b16 v[178:179], v13 offset:37376
v_mfma_f32_16x16x32_bf16 v[120:123], v[212:215], a[232:235], v[120:123]
ds_read_b64_tr_b16 v[180:181], v13 offset:40960
v_mfma_f32_16x16x32_bf16 v[124:127], v[212:215], a[236:239], v[124:127]
ds_read_b64_tr_b16 v[182:183], v13 offset:41472
v_mfma_f32_16x16x32_bf16 v[132:135], v[216:219], a[224:227], v[132:135]
ds_read_b64_tr_b16 v[188:189], v13 offset:45056
v_mfma_f32_16x16x32_bf16 v[136:139], v[216:219], a[228:231], v[136:139]
ds_read_b64_tr_b16 v[190:191], v13 offset:45568
v_mfma_f32_16x16x32_bf16 v[140:143], v[216:219], a[232:235], v[140:143]
ds_read_b64_tr_b16 v[184:185], v173 offset:36864
v_mfma_f32_16x16x32_bf16 v[144:147], v[216:219], a[236:239], v[144:147]
ds_read_b64_tr_b16 v[186:187], v173 offset:37376
s_waitcnt lgkmcnt(8)
v_mfma_f32_16x16x32_bf16 v[128:131], v[216:219], v[4:7], v[128:131]
ds_read_b128 v[8:11], v255 offset:15360
v_mfma_f32_16x16x32_bf16 v[196:199], a[224:227], v[168:171], v[196:199]
s_add_u32 s4, s32, 1769600
s_addc_u32 s5, s33, 0
v_mfma_f32_16x16x32_bf16 v[200:203], a[228:231], v[168:171], v[200:203]
s_add_u32 m0, s73, 49152
s_nop 0
global_load_lds_dwordx4 v224, s[4:5] offset:0
v_mfma_f32_16x16x32_bf16 v[204:207], a[232:235], v[168:171], v[204:207]
global_load_lds_dwordx4 v225, s[4:5] offset:1024
v_mfma_f32_16x16x32_bf16 v[208:211], a[236:239], v[168:171], v[208:211]
v_exp_f32 v248, v248
v_mfma_f32_16x16x32_bf16 v[192:195], v[4:7], v[168:171], v[192:195]
v_exp_f32 v249, v249
v_mfma_f32_16x16x32_bf16 v[152:155], v[220:223], a[224:227], v[152:155]
v_exp_f32 v250, v250
v_mfma_f32_16x16x32_bf16 v[156:159], v[220:223], a[228:231], v[156:159]
v_exp_f32 v251, v251
v_mfma_f32_16x16x32_bf16 v[160:163], v[220:223], a[232:235], v[160:163]
v_fma_f32 v248, v248, v243, v243
v_fma_f32 v249, v249, v243, v243
v_mfma_f32_16x16x32_bf16 v[164:167], v[220:223], a[236:239], v[164:167]
v_fma_f32 v250, v250, v243, v243
v_fma_f32 v251, v251, v243, v243
v_mfma_f32_16x16x32_bf16 v[148:151], v[220:223], v[4:7], v[148:151]
v_rcp_f32 v248, v248
s_waitcnt lgkmcnt(0)
s_waitcnt vmcnt(14)
s_barrier
v_mfma_f32_16x16x32_bf16 v[112:115], v[176:179], a[240:243], v[112:115]
ds_read_b64_tr_b16 v[212:213], v14 offset:0
v_mul_f32 v108, v108, v248
v_mfma_f32_16x16x32_bf16 v[116:119], v[176:179], a[244:247], v[116:119]
ds_read_b64_tr_b16 v[214:215], v14 offset:512
v_mfma_f32_16x16x32_bf16 v[120:123], v[176:179], a[248:251], v[120:123]
ds_read_b64_tr_b16 v[216:217], v14 offset:4096
v_mfma_f32_16x16x32_bf16 v[124:127], v[176:179], a[252:255], v[124:127]
ds_read_b64_tr_b16 v[218:219], v14 offset:4608
v_mfma_f32_16x16x32_bf16 v[132:135], v[180:183], a[240:243], v[132:135]
ds_read_b64_tr_b16 v[168:169], v14 offset:8192
v_mfma_f32_16x16x32_bf16 v[136:139], v[180:183], a[244:247], v[136:139]
ds_read_b64_tr_b16 v[170:171], v14 offset:8704
v_mfma_f32_16x16x32_bf16 v[140:143], v[180:183], a[248:251], v[140:143]
ds_read_b64_tr_b16 v[220:221], v174 offset:0
v_mfma_f32_16x16x32_bf16 v[144:147], v[180:183], a[252:255], v[144:147]
ds_read_b64_tr_b16 v[222:223], v174 offset:512
v_mfma_f32_16x16x32_bf16 v[128:131], v[180:183], v[8:11], v[128:131]
ds_read_b128 v[4:7], v254 offset:16384
v_mfma_f32_16x16x32_bf16 v[196:199], a[240:243], v[188:191], v[196:199]
global_load_lds_dwordx4 v226, s[4:5] offset:2048
v_mfma_f32_16x16x32_bf16 v[200:203], a[244:247], v[188:191], v[200:203]
global_load_lds_dwordx4 v227, s[4:5] offset:3072
v_mfma_f32_16x16x32_bf16 v[204:207], a[248:251], v[188:191], v[204:207]
s_add_u32 m0, s73, 53248
s_nop 0
global_load_lds_dwordx4 v228, s[4:5] offset:0
v_mfma_f32_16x16x32_bf16 v[208:211], a[252:255], v[188:191], v[208:211]
global_load_lds_dwordx4 v229, s[4:5] offset:1024
v_mfma_f32_16x16x32_bf16 v[192:195], v[8:11], v[188:191], v[192:195]
v_rcp_f32 v249, v249
v_mfma_f32_16x16x32_bf16 v[152:155], v[184:187], a[240:243], v[152:155]
v_rcp_f32 v250, v250
v_mfma_f32_16x16x32_bf16 v[156:159], v[184:187], a[244:247], v[156:159]
v_rcp_f32 v251, v251
v_mfma_f32_16x16x32_bf16 v[160:163], v[184:187], a[248:251], v[160:163]
v_mul_f32 v109, v109, v249
v_mul_f32 v110, v110, v250
v_mfma_f32_16x16x32_bf16 v[164:167], v[184:187], a[252:255], v[164:167]
v_mul_f32 v111, v111, v251
v_cvt_pk_bf16_f32 v108, v108, v109
v_mfma_f32_16x16x32_bf16 v[148:151], v[184:187], v[8:11], v[148:151]
v_cvt_pk_bf16_f32 v109, v110, v111
s_lshl_b32 s3, s51, 13
s_waitcnt lgkmcnt(5)
v_mfma_f32_16x16x32_bf16 v[112:115], v[212:215], v[16:19], v[112:115]
ds_read_b64_tr_b16 v[176:177], v14 offset:12288
s_lshl_b32 s59, s52, 3
v_mfma_f32_16x16x32_bf16 v[116:119], v[212:215], v[20:23], v[116:119]
ds_read_b64_tr_b16 v[178:179], v14 offset:12800
s_add_u32 s3, s3, s59
v_mfma_f32_16x16x32_bf16 v[120:123], v[212:215], v[24:27], v[120:123]
ds_read_b64_tr_b16 v[180:181], v14 offset:16384
s_add_u32 s3, s3, 139264
v_mfma_f32_16x16x32_bf16 v[124:127], v[212:215], v[28:31], v[124:127]
ds_read_b64_tr_b16 v[182:183], v14 offset:16896
v_lshl_add_u32 v15, v1, 4, s3
v_mfma_f32_16x16x32_bf16 v[132:135], v[216:219], v[16:19], v[132:135]
ds_read_b64_tr_b16 v[188:189], v14 offset:20480
v_mfma_f32_16x16x32_bf16 v[136:139], v[216:219], v[20:23], v[136:139]
ds_read_b64_tr_b16 v[190:191], v14 offset:20992
v_mfma_f32_16x16x32_bf16 v[140:143], v[216:219], v[24:27], v[140:143]
ds_read_b64_tr_b16 v[184:185], v174 offset:12288
v_mfma_f32_16x16x32_bf16 v[144:147], v[216:219], v[28:31], v[144:147]
ds_read_b64_tr_b16 v[186:187], v174 offset:12800
s_waitcnt lgkmcnt(8)
v_mfma_f32_16x16x32_bf16 v[128:131], v[216:219], v[4:7], v[128:131]
ds_read_b128 v[8:11], v255 offset:17408
v_mfma_f32_16x16x32_bf16 v[196:199], v[16:19], v[168:171], v[196:199]
s_add_u32 s4, s32, 2654336
s_addc_u32 s5, s33, 0
v_mfma_f32_16x16x32_bf16 v[200:203], v[20:23], v[168:171], v[200:203]
s_add_u32 m0, s73, 73728
s_nop 0
global_load_lds_dwordx4 v224, s[4:5] offset:0
v_mfma_f32_16x16x32_bf16 v[204:207], v[24:27], v[168:171], v[204:207]
global_load_lds_dwordx4 v225, s[4:5] offset:1024
v_mfma_f32_16x16x32_bf16 v[208:211], v[28:31], v[168:171], v[208:211]
v_mfma_f32_16x16x32_bf16 v[192:195], v[4:7], v[168:171], v[192:195]
v_mfma_f32_16x16x32_bf16 v[152:155], v[220:223], v[16:19], v[152:155]
v_mfma_f32_16x16x32_bf16 v[156:159], v[220:223], v[20:23], v[156:159]
v_mfma_f32_16x16x32_bf16 v[160:163], v[220:223], v[24:27], v[160:163]
v_mfma_f32_16x16x32_bf16 v[164:167], v[220:223], v[28:31], v[164:167]
v_mfma_f32_16x16x32_bf16 v[148:151], v[220:223], v[4:7], v[148:151]
s_waitcnt lgkmcnt(0)
s_waitcnt vmcnt(14)
s_barrier
ds_write_b64 v15, v[64:65] offset:0
ds_write_b64 v15, v[68:69] offset:1024
ds_write_b64 v15, v[72:73] offset:2048
ds_write_b64 v15, v[76:77] offset:3072
ds_write_b64 v15, v[96:97] offset:4096
ds_write_b64 v15, v[100:101] offset:5120
ds_write_b64 v15, v[104:105] offset:6144
ds_write_b64 v15, v[108:109] offset:7168
v_mfma_f32_16x16x32_bf16 v[112:115], v[176:179], v[32:35], v[112:115]
v_mfma_f32_16x16x32_bf16 v[116:119], v[176:179], v[36:39], v[116:119]
v_mfma_f32_16x16x32_bf16 v[120:123], v[176:179], v[40:43], v[120:123]
v_mfma_f32_16x16x32_bf16 v[124:127], v[176:179], v[44:47], v[124:127]
v_mfma_f32_16x16x32_bf16 v[132:135], v[180:183], v[32:35], v[132:135]
v_mfma_f32_16x16x32_bf16 v[136:139], v[180:183], v[36:39], v[136:139]
v_mfma_f32_16x16x32_bf16 v[140:143], v[180:183], v[40:43], v[140:143]
v_mfma_f32_16x16x32_bf16 v[144:147], v[180:183], v[44:47], v[144:147]
v_mfma_f32_16x16x32_bf16 v[128:131], v[180:183], v[8:11], v[128:131]
v_mfma_f32_16x16x32_bf16 v[196:199], v[32:35], v[188:191], v[196:199]
ds_read_b64_tr_b16 v[176:177], v230 offset:0
v_mfma_f32_16x16x32_bf16 v[200:203], v[36:39], v[188:191], v[200:203]
ds_read_b64_tr_b16 v[178:179], v230 offset:512
v_mfma_f32_16x16x32_bf16 v[204:207], v[40:43], v[188:191], v[204:207]
ds_read_b64_tr_b16 v[180:181], v230 offset:12288
v_mfma_f32_16x16x32_bf16 v[208:211], v[44:47], v[188:191], v[208:211]
ds_read_b64_tr_b16 v[182:183], v230 offset:12800
v_mfma_f32_16x16x32_bf16 v[192:195], v[8:11], v[188:191], v[192:195]
global_load_lds_dwordx4 v226, s[4:5] offset:2048
v_mfma_f32_16x16x32_bf16 v[152:155], v[184:187], v[32:35], v[152:155]
global_load_lds_dwordx4 v227, s[4:5] offset:3072
v_mfma_f32_16x16x32_bf16 v[156:159], v[184:187], v[36:39], v[156:159]
s_add_u32 m0, s73, 77824
s_nop 0
global_load_lds_dwordx4 v228, s[4:5] offset:0
v_mfma_f32_16x16x32_bf16 v[160:163], v[184:187], v[40:43], v[160:163]
global_load_lds_dwordx4 v229, s[4:5] offset:1024
v_mfma_f32_16x16x32_bf16 v[164:167], v[184:187], v[44:47], v[164:167]
v_mfma_f32_16x16x32_bf16 v[148:151], v[184:187], v[8:11], v[148:151]
s_waitcnt lgkmcnt(0)
v_mfma_f32_16x16x32_bf16 v[48:51], v[176:179], a[0:3], 0
ds_read_b64_tr_b16 v[184:185], v233 offset:0
v_lshlrev_b32 v252, 2, v3
v_mfma_f32_16x16x32_bf16 v[52:55], v[176:179], a[4:7], 0
ds_read_b64_tr_b16 v[186:187], v233 offset:512
v_and_b32 v253, 1, v2
v_mfma_f32_16x16x32_bf16 v[56:59], v[176:179], a[8:11], 0
ds_read_b64_tr_b16 v[188:189], v233 offset:12288
v_cmp_eq_u32 s[98:99], 1, v253
v_mfma_f32_16x16x32_bf16 v[60:63], v[176:179], a[12:15], 0
ds_read_b64_tr_b16 v[190:191], v233 offset:12800
v_add_u32 v253, 0, v252
v_mfma_f32_16x16x32_bf16 v[64:67], v[180:183], a[0:3], 0
s_add_u32 s4, s32, 3539072
s_addc_u32 s5, s33, 0
v_mfma_f32_16x16x32_bf16 v[68:71], v[180:183], a[4:7], 0
v_cmp_le_u32 s[88:89], v253, v2
v_add_u32 v253, 1, v252
v_mfma_f32_16x16x32_bf16 v[72:75], v[180:183], a[8:11], 0
v_cmp_le_u32 s[90:91], v253, v2
v_add_u32 v253, 2, v252
v_mfma_f32_16x16x32_bf16 v[76:79], v[180:183], a[12:15], 0
v_cmp_le_u32 s[92:93], v253, v2
v_add_u32 v253, 3, v252
s_waitcnt lgkmcnt(0)
v_mfma_f32_16x16x32_bf16 v[80:83], v[184:187], a[0:3], 0
ds_read_b64_tr_b16 v[176:177], v230 offset:4096
v_cmp_le_u32 s[100:101], v253, v2
v_mfma_f32_16x16x32_bf16 v[84:87], v[184:187], a[4:7], 0
ds_read_b64_tr_b16 v[178:179], v230 offset:4608
v_mul_f32 v4, 0xbe715bef, v236
v_mfma_f32_16x16x32_bf16 v[88:91], v[184:187], a[8:11], 0
ds_read_b64_tr_b16 v[180:181], v230 offset:16384
v_mul_f32 v5, 0xbe715bef, v237
v_mfma_f32_16x16x32_bf16 v[92:95], v[184:187], a[12:15], 0
ds_read_b64_tr_b16 v[182:183], v230 offset:16896
v_mul_f32 v6, 0xbe715bef, v238
v_mfma_f32_16x16x32_bf16 v[96:99], v[188:191], a[0:3], 0
s_add_u32 m0, s73, 98304
s_nop 0
global_load_lds_dwordx4 v224, s[4:5] offset:0
v_mfma_f32_16x16x32_bf16 v[100:103], v[188:191], a[4:7], 0
v_mul_f32 v7, 0xbe715bef, v239
v_mov_b32 v253, 0xf149f2ca
v_mfma_f32_16x16x32_bf16 v[104:107], v[188:191], a[8:11], 0
s_andn2_b64 vcc, s[88:89], s[98:99]
v_cndmask_b32 v12, v253, 0, vcc
v_mfma_f32_16x16x32_bf16 v[108:111], v[188:191], a[12:15], 0
s_nor_b64 vcc, s[88:89], s[98:99]
v_cndmask_b32 v8, v253, 0, vcc
s_waitcnt lgkmcnt(0)
v_mfma_f32_16x16x32_bf16 v[48:51], v[176:179], a[16:19], v[48:51]
ds_read_b64_tr_b16 v[184:185], v233 offset:4096
s_and_b64 vcc, s[90:91], s[98:99]
v_cndmask_b32 v13, v253, 0, vcc
v_mfma_f32_16x16x32_bf16 v[52:55], v[176:179], a[20:23], v[52:55]
ds_read_b64_tr_b16 v[186:187], v233 offset:4608
s_andn2_b64 vcc, s[98:99], s[90:91]
v_cndmask_b32 v9, v253, 0, vcc
v_mfma_f32_16x16x32_bf16 v[56:59], v[176:179], a[24:27], v[56:59]
ds_read_b64_tr_b16 v[188:189], v233 offset:16384
s_andn2_b64 vcc, s[92:93], s[98:99]
v_cndmask_b32 v14, v253, 0, vcc
v_mfma_f32_16x16x32_bf16 v[60:63], v[176:179], a[28:31], v[60:63]
ds_read_b64_tr_b16 v[190:191], v233 offset:16896
s_nor_b64 vcc, s[92:93], s[98:99]
v_cndmask_b32 v10, v253, 0, vcc
v_mfma_f32_16x16x32_bf16 v[64:67], v[180:183], a[16:19], v[64:67]
global_load_lds_dwordx4 v225, s[4:5] offset:1024
v_mfma_f32_16x16x32_bf16 v[68:71], v[180:183], a[20:23], v[68:71]
s_and_b64 vcc, s[100:101], s[98:99]
v_cndmask_b32 v15, v253, 0, vcc
v_mfma_f32_16x16x32_bf16 v[72:75], v[180:183], a[24:27], v[72:75]
s_andn2_b64 vcc, s[98:99], s[100:101]
v_cndmask_b32 v11, v253, 0, vcc
v_mfma_f32_16x16x32_bf16 v[76:79], v[180:183], a[28:31], v[76:79]
s_lshl_b32 s3, s51, 8
s_add_u32 s3, s3, 159744
s_waitcnt lgkmcnt(0)
v_mfma_f32_16x16x32_bf16 v[80:83], v[184:187], a[16:19], v[80:83]
ds_read_b64_tr_b16 v[176:177], v230 offset:8192
v_lshl_add_u32 v252, v2, 2, s3
v_mfma_f32_16x16x32_bf16 v[84:87], v[184:187], a[20:23], v[84:87]
ds_read_b64_tr_b16 v[178:179], v230 offset:8704
ds_read_b32 v168, v252 offset:0
v_mfma_f32_16x16x32_bf16 v[88:91], v[184:187], a[24:27], v[88:91]
ds_read_b64_tr_b16 v[180:181], v230 offset:20480
ds_read_b32 v169, v252 offset:64
v_mfma_f32_16x16x32_bf16 v[92:95], v[184:187], a[28:31], v[92:95]
ds_read_b64_tr_b16 v[182:183], v230 offset:20992
ds_read_b32 v170, v252 offset:128
v_mfma_f32_16x16x32_bf16 v[96:99], v[188:191], a[16:19], v[96:99]
global_load_lds_dwordx4 v226, s[4:5] offset:2048
v_mfma_f32_16x16x32_bf16 v[100:103], v[188:191], a[20:23], v[100:103]
global_load_lds_dwordx4 v227, s[4:5] offset:3072
v_mfma_f32_16x16x32_bf16 v[104:107], v[188:191], a[24:27], v[104:107]
ds_read_b32 v171, v252 offset:192
ds_read_b32 v172, v252 offset:256
v_mfma_f32_16x16x32_bf16 v[108:111], v[188:191], a[28:31], v[108:111]
v_cmp_eq_u32 vcc, 0, v3
s_waitcnt lgkmcnt(3)
v_mfma_f32_16x16x32_bf16 v[48:51], v[176:179], a[32:35], v[48:51]
ds_read_b64_tr_b16 v[184:185], v233 offset:8192
v_cndmask_b32 v253, 0, v4, vcc
v_mfma_f32_16x16x32_bf16 v[52:55], v[176:179], a[36:39], v[52:55]
ds_read_b64_tr_b16 v[186:187], v233 offset:8704
v_mul_f32 v112, v112, v4
v_mfma_f32_16x16x32_bf16 v[56:59], v[176:179], a[40:43], v[56:59]
ds_read_b64_tr_b16 v[188:189], v233 offset:20480
v_mul_f32 v113, v113, v4
v_mfma_f32_16x16x32_bf16 v[60:63], v[176:179], a[44:47], v[60:63]
ds_read_b64_tr_b16 v[190:191], v233 offset:20992
v_mul_f32 v114, v114, v4
v_mfma_f32_16x16x32_bf16 v[64:67], v[180:183], a[32:35], v[64:67]
s_add_u32 m0, s73, 102400
v_mul_f32 v115, v115, v4
v_mfma_f32_16x16x32_bf16 v[68:71], v[180:183], a[36:39], v[68:71]
v_mul_f32 v254, v154, v253
v_mul_f32 v255, v155, v253
v_mfma_f32_16x16x32_bf16 v[72:75], v[180:183], a[40:43], v[72:75]
v_cvt_pk_bf16_f32 v112, v112, v113
v_cvt_pk_bf16_f32 v113, v114, v115
v_mfma_f32_16x16x32_bf16 v[76:79], v[180:183], a[44:47], v[76:79]
v_cvt_pk_bf16_f32 v114, v254, v255
v_mov_b32 v115, 0
s_waitcnt lgkmcnt(0)
s_waitcnt vmcnt(16)
s_barrier
v_mfma_f32_16x16x32_bf16 v[80:83], v[184:187], a[32:35], v[80:83]
ds_read_b64_tr_b16 v[176:177], v230 offset:24576
v_cndmask_b32 v253, 0, v5, vcc
v_mfma_f32_16x16x32_bf16 v[84:87], v[184:187], a[36:39], v[84:87]
ds_read_b64_tr_b16 v[178:179], v230 offset:25088
v_mul_f32 v116, v116, v5
v_mfma_f32_16x16x32_bf16 v[88:91], v[184:187], a[40:43], v[88:91]
ds_read_b64_tr_b16 v[180:181], v230 offset:36864
v_mul_f32 v117, v117, v5
v_mfma_f32_16x16x32_bf16 v[92:95], v[184:187], a[44:47], v[92:95]
ds_read_b64_tr_b16 v[182:183], v230 offset:37376
v_mul_f32 v118, v118, v5
v_mfma_f32_16x16x32_bf16 v[96:99], v[188:191], a[32:35], v[96:99]
global_load_lds_dwordx4 v228, s[4:5] offset:0
v_mfma_f32_16x16x32_bf16 v[100:103], v[188:191], a[36:39], v[100:103]
global_load_lds_dwordx4 v229, s[4:5] offset:1024
v_mfma_f32_16x16x32_bf16 v[104:107], v[188:191], a[40:43], v[104:107]
v_mul_f32 v119, v119, v5
v_mul_f32 v254, v158, v253
v_mfma_f32_16x16x32_bf16 v[108:111], v[188:191], a[44:47], v[108:111]
v_mul_f32 v255, v159, v253
v_cvt_pk_bf16_f32 v116, v116, v117
s_waitcnt lgkmcnt(0)
v_mfma_f32_16x16x32_bf16 v[48:51], v[176:179], a[48:51], v[48:51]
ds_read_b64_tr_b16 v[184:185], v233 offset:24576
v_cvt_pk_bf16_f32 v117, v118, v119
v_mfma_f32_16x16x32_bf16 v[52:55], v[176:179], a[52:55], v[52:55]
ds_read_b64_tr_b16 v[186:187], v233 offset:25088
v_cvt_pk_bf16_f32 v118, v254, v255
v_mfma_f32_16x16x32_bf16 v[56:59], v[176:179], a[56:59], v[56:59]
ds_read_b64_tr_b16 v[188:189], v233 offset:36864
v_mov_b32 v119, 0
v_mfma_f32_16x16x32_bf16 v[60:63], v[176:179], a[60:63], v[60:63]
ds_read_b64_tr_b16 v[190:191], v233 offset:37376
v_cndmask_b32 v253, 0, v6, vcc
v_mfma_f32_16x16x32_bf16 v[64:67], v[180:183], a[48:51], v[64:67]
s_add_u32 s4, s32, 4423808
s_addc_u32 s5, s33, 0
v_mfma_f32_16x16x32_bf16 v[68:71], v[180:183], a[52:55], v[68:71]
v_mul_f32 v120, v120, v6
v_mul_f32 v121, v121, v6
v_mfma_f32_16x16x32_bf16 v[72:75], v[180:183], a[56:59], v[72:75]
v_mul_f32 v122, v122, v6
v_mul_f32 v123, v123, v6
v_mfma_f32_16x16x32_bf16 v[76:79], v[180:183], a[60:63], v[76:79]
v_mul_f32 v254, v162, v253
v_mul_f32 v255, v163, v253
s_waitcnt lgkmcnt(0)
v_mfma_f32_16x16x32_bf16 v[80:83], v[184:187], a[48:51], v[80:83]
ds_read_b64_tr_b16 v[176:177], v230 offset:28672
v_cvt_pk_bf16_f32 v120, v120, v121
v_mfma_f32_16x16x32_bf16 v[84:87], v[184:187], a[52:55], v[84:87]
ds_read_b64_tr_b16 v[178:179], v230 offset:29184
v_cvt_pk_bf16_f32 v121, v122, v123
v_mfma_f32_16x16x32_bf16 v[88:91], v[184:187], a[56:59], v[88:91]
ds_read_b64_tr_b16 v[180:181], v230 offset:40960
v_cvt_pk_bf16_f32 v122, v254, v255
v_mfma_f32_16x16x32_bf16 v[92:95], v[184:187], a[60:63], v[92:95]
ds_read_b64_tr_b16 v[182:183], v230 offset:41472
v_mov_b32 v123, 0
v_mfma_f32_16x16x32_bf16 v[96:99], v[188:191], a[48:51], v[96:99]
s_add_u32 m0, s73, 0
s_nop 0
global_load_lds_dwordx4 v224, s[4:5] offset:0
v_mfma_f32_16x16x32_bf16 v[100:103], v[188:191], a[52:55], v[100:103]
v_cndmask_b32 v253, 0, v7, vcc
v_mul_f32 v124, v124, v7
v_mfma_f32_16x16x32_bf16 v[104:107], v[188:191], a[56:59], v[104:107]
v_mul_f32 v125, v125, v7
v_mul_f32 v126, v126, v7
v_mfma_f32_16x16x32_bf16 v[108:111], v[188:191], a[60:63], v[108:111]
v_mul_f32 v127, v127, v7
v_mul_f32 v254, v166, v253
s_waitcnt lgkmcnt(0)
v_mfma_f32_16x16x32_bf16 v[48:51], v[176:179], a[64:67], v[48:51]
ds_read_b64_tr_b16 v[184:185], v233 offset:28672
v_mul_f32 v255, v167, v253
v_mfma_f32_16x16x32_bf16 v[52:55], v[176:179], a[68:71], v[52:55]
ds_read_b64_tr_b16 v[186:187], v233 offset:29184
v_cvt_pk_bf16_f32 v124, v124, v125
v_mfma_f32_16x16x32_bf16 v[56:59], v[176:179], a[72:75], v[56:59]
ds_read_b64_tr_b16 v[188:189], v233 offset:40960
v_cvt_pk_bf16_f32 v125, v126, v127
v_mfma_f32_16x16x32_bf16 v[60:63], v[176:179], a[76:79], v[60:63]
ds_read_b64_tr_b16 v[190:191], v233 offset:41472
v_cvt_pk_bf16_f32 v126, v254, v255
v_mfma_f32_16x16x32_bf16 v[64:67], v[180:183], a[64:67], v[64:67]
global_load_lds_dwordx4 v225, s[4:5] offset:1024
v_mfma_f32_16x16x32_bf16 v[68:71], v[180:183], a[68:71], v[68:71]
v_mov_b32 v127, 0
v_mul_f32 v128, v128, v168
v_mfma_f32_16x16x32_bf16 v[72:75], v[180:183], a[72:75], v[72:75]
v_mul_f32 v129, v129, v168
v_mul_f32 v130, v130, v168
v_mfma_f32_16x16x32_bf16 v[76:79], v[180:183], a[76:79], v[76:79]
v_mul_f32 v131, v131, v168
v_mul_f32 v150, v150, v168
s_waitcnt lgkmcnt(0)
v_mfma_f32_16x16x32_bf16 v[80:83], v[184:187], a[64:67], v[80:83]
ds_read_b64_tr_b16 v[176:177], v230 offset:32768
v_mul_f32 v151, v151, v168
v_mfma_f32_16x16x32_bf16 v[84:87], v[184:187], a[68:71], v[84:87]
ds_read_b64_tr_b16 v[178:179], v230 offset:33280
v_cvt_pk_bf16_f32 v128, v128, v129
v_mfma_f32_16x16x32_bf16 v[88:91], v[184:187], a[72:75], v[88:91]
ds_read_b64_tr_b16 v[180:181], v230 offset:45056
v_cvt_pk_bf16_f32 v129, v130, v131
v_mfma_f32_16x16x32_bf16 v[92:95], v[184:187], a[76:79], v[92:95]
ds_read_b64_tr_b16 v[182:183], v230 offset:45568
v_cvt_pk_bf16_f32 v150, v150, v151
v_mfma_f32_16x16x32_bf16 v[96:99], v[188:191], a[64:67], v[96:99]
global_load_lds_dwordx4 v226, s[4:5] offset:2048
v_mfma_f32_16x16x32_bf16 v[100:103], v[188:191], a[68:71], v[100:103]
global_load_lds_dwordx4 v227, s[4:5] offset:3072
v_mfma_f32_16x16x32_bf16 v[104:107], v[188:191], a[72:75], v[104:107]
v_mov_b32 v130, 0
v_mov_b32 v151, v150
v_mfma_f32_16x16x32_bf16 v[108:111], v[188:191], a[76:79], v[108:111]
v_mov_b32 v131, 0
v_permlane16_swap_b32 v151, v130
s_waitcnt lgkmcnt(0)
v_mfma_f32_16x16x32_bf16 v[48:51], v[176:179], a[80:83], v[48:51]
ds_read_b64_tr_b16 v[184:185], v233 offset:32768
v_mul_f32 v132, v132, v169
v_mfma_f32_16x16x32_bf16 v[52:55], v[176:179], a[84:87], v[52:55]
ds_read_b64_tr_b16 v[186:187], v233 offset:33280
v_mul_f32 v133, v133, v169
v_mfma_f32_16x16x32_bf16 v[56:59], v[176:179], a[88:91], v[56:59]
ds_read_b64_tr_b16 v[188:189], v233 offset:45056
v_mul_f32 v134, v134, v169
v_mfma_f32_16x16x32_bf16 v[60:63], v[176:179], a[92:95], v[60:63]
ds_read_b64_tr_b16 v[190:191], v233 offset:45568
v_mul_f32 v135, v135, v169
v_mfma_f32_16x16x32_bf16 v[64:67], v[180:183], a[80:83], v[64:67]
s_add_u32 m0, s73, 4096
v_mul_f32 v154, v154, v169
v_mfma_f32_16x16x32_bf16 v[68:71], v[180:183], a[84:87], v[68:71]
v_mul_f32 v155, v155, v169
v_cvt_pk_bf16_f32 v132, v132, v133
v_mfma_f32_16x16x32_bf16 v[72:75], v[180:183], a[88:91], v[72:75]
v_cvt_pk_bf16_f32 v133, v134, v135
v_cvt_pk_bf16_f32 v154, v154, v155
v_mfma_f32_16x16x32_bf16 v[76:79], v[180:183], a[92:95], v[76:79]
v_mov_b32 v134, 0
v_mov_b32 v155, v154
s_waitcnt lgkmcnt(0)
s_waitcnt vmcnt(16)
s_barrier
v_mfma_f32_16x16x32_bf16 v[80:83], v[184:187], a[80:83], v[80:83]
ds_read_b64_tr_b16 v[176:177], v231 offset:0
v_mov_b32 v135, 0
v_mfma_f32_16x16x32_bf16 v[84:87], v[184:187], a[84:87], v[84:87]
ds_read_b64_tr_b16 v[178:179], v231 offset:512
v_permlane16_swap_b32 v155, v134
v_mfma_f32_16x16x32_bf16 v[88:91], v[184:187], a[88:91], v[88:91]
ds_read_b64_tr_b16 v[180:181], v231 offset:12288
v_mul_f32 v136, v136, v170
v_mfma_f32_16x16x32_bf16 v[92:95], v[184:187], a[92:95], v[92:95]
ds_read_b64_tr_b16 v[182:183], v231 offset:12800
v_mul_f32 v137, v137, v170
v_mfma_f32_16x16x32_bf16 v[96:99], v[188:191], a[80:83], v[96:99]
global_load_lds_dwordx4 v228, s[4:5] offset:0
v_mfma_f32_16x16x32_bf16 v[100:103], v[188:191], a[84:87], v[100:103]
global_load_lds_dwordx4 v229, s[4:5] offset:1024
v_mfma_f32_16x16x32_bf16 v[104:107], v[188:191], a[88:91], v[104:107]
v_mul_f32 v138, v138, v170
v_mul_f32 v139, v139, v170
v_mfma_f32_16x16x32_bf16 v[108:111], v[188:191], a[92:95], v[108:111]
v_mul_f32 v158, v158, v170
v_mul_f32 v159, v159, v170
s_waitcnt lgkmcnt(0)
v_mfma_f32_16x16x32_bf16 v[48:51], v[176:179], a[96:99], v[48:51]
ds_read_b64_tr_b16 v[184:185], v234 offset:0
v_cvt_pk_bf16_f32 v136, v136, v137
v_mfma_f32_16x16x32_bf16 v[52:55], v[176:179], a[100:103], v[52:55]
ds_read_b64_tr_b16 v[186:187], v234 offset:512
v_cvt_pk_bf16_f32 v137, v138, v139
v_mfma_f32_16x16x32_bf16 v[56:59], v[176:179], a[104:107], v[56:59]
ds_read_b64_tr_b16 v[188:189], v234 offset:12288
v_cvt_pk_bf16_f32 v158, v158, v159
v_mfma_f32_16x16x32_bf16 v[60:63], v[176:179], a[108:111], v[60:63]
ds_read_b64_tr_b16 v[190:191], v234 offset:12800
v_mov_b32 v138, 0
v_mfma_f32_16x16x32_bf16 v[64:67], v[180:183], a[96:99], v[64:67]
s_add_u32 s4, s32, 256
s_addc_u32 s5, s33, 0
v_mfma_f32_16x16x32_bf16 v[68:71], v[180:183], a[100:103], v[68:71]
v_mov_b32 v159, v158
v_mov_b32 v139, 0
v_mfma_f32_16x16x32_bf16 v[72:75], v[180:183], a[104:107], v[72:75]
v_permlane16_swap_b32 v159, v138
v_mul_f32 v140, v140, v171
v_mfma_f32_16x16x32_bf16 v[76:79], v[180:183], a[108:111], v[76:79]
v_mul_f32 v141, v141, v171
v_mul_f32 v142, v142, v171
s_waitcnt lgkmcnt(0)
v_mfma_f32_16x16x32_bf16 v[80:83], v[184:187], a[96:99], v[80:83]
ds_read_b64_tr_b16 v[176:177], v231 offset:4096
v_mul_f32 v143, v143, v171
v_mfma_f32_16x16x32_bf16 v[84:87], v[184:187], a[100:103], v[84:87]
ds_read_b64_tr_b16 v[178:179], v231 offset:4608
v_mul_f32 v162, v162, v171
v_mfma_f32_16x16x32_bf16 v[88:91], v[184:187], a[104:107], v[88:91]
ds_read_b64_tr_b16 v[180:181], v231 offset:16384
v_mul_f32 v163, v163, v171
v_mfma_f32_16x16x32_bf16 v[92:95], v[184:187], a[108:111], v[92:95]
ds_read_b64_tr_b16 v[182:183], v231 offset:16896
v_cvt_pk_bf16_f32 v140, v140, v141
v_mfma_f32_16x16x32_bf16 v[96:99], v[188:191], a[96:99], v[96:99]
s_add_u32 m0, s73, 24576
s_nop 0
global_load_lds_dwordx4 v224, s[4:5] offset:0
v_mfma_f32_16x16x32_bf16 v[100:103], v[188:191], a[100:103], v[100:103]
v_cvt_pk_bf16_f32 v141, v142, v143
v_cvt_pk_bf16_f32 v162, v162, v163
v_mfma_f32_16x16x32_bf16 v[104:107], v[188:191], a[104:107], v[104:107]
v_mov_b32 v142, 0
v_mov_b32 v163, v162
v_mfma_f32_16x16x32_bf16 v[108:111], v[188:191], a[108:111], v[108:111]
v_mov_b32 v143, 0
v_permlane16_swap_b32 v163, v142
s_waitcnt lgkmcnt(0)
v_mfma_f32_16x16x32_bf16 v[48:51], v[176:179], a[112:115], v[48:51]
ds_read_b64_tr_b16 v[184:185], v234 offset:4096
v_mul_f32 v144, v144, v172
v_mfma_f32_16x16x32_bf16 v[52:55], v[176:179], a[116:119], v[52:55]
ds_read_b64_tr_b16 v[186:187], v234 offset:4608
v_mul_f32 v145, v145, v172
v_mfma_f32_16x16x32_bf16 v[56:59], v[176:179], a[120:123], v[56:59]
ds_read_b64_tr_b16 v[188:189], v234 offset:16384
v_mul_f32 v146, v146, v172
v_mfma_f32_16x16x32_bf16 v[60:63], v[176:179], a[124:127], v[60:63]
ds_read_b64_tr_b16 v[190:191], v234 offset:16896
v_mul_f32 v147, v147, v172
v_mfma_f32_16x16x32_bf16 v[64:67], v[180:183], a[112:115], v[64:67]
global_load_lds_dwordx4 v225, s[4:5] offset:1024
v_mfma_f32_16x16x32_bf16 v[68:71], v[180:183], a[116:119], v[68:71]
v_mul_f32 v166, v166, v172
v_mul_f32 v167, v167, v172
v_mfma_f32_16x16x32_bf16 v[72:75], v[180:183], a[120:123], v[72:75]
v_cvt_pk_bf16_f32 v144, v144, v145
v_cvt_pk_bf16_f32 v145, v146, v147
v_mfma_f32_16x16x32_bf16 v[76:79], v[180:183], a[124:127], v[76:79]
v_cvt_pk_bf16_f32 v166, v166, v167
v_mov_b32 v146, 0
s_waitcnt lgkmcnt(0)
v_mfma_f32_16x16x32_bf16 v[80:83], v[184:187], a[112:115], v[80:83]
ds_read_b64_tr_b16 v[176:177], v231 offset:8192
v_mov_b32 v167, v166
v_mfma_f32_16x16x32_bf16 v[84:87], v[184:187], a[116:119], v[84:87]
ds_read_b64_tr_b16 v[178:179], v231 offset:8704
v_mov_b32 v147, 0
v_mfma_f32_16x16x32_bf16 v[88:91], v[184:187], a[120:123], v[88:91]
ds_read_b64_tr_b16 v[180:181], v231 offset:20480
v_permlane16_swap_b32 v167, v146
v_mfma_f32_16x16x32_bf16 v[92:95], v[184:187], a[124:127], v[92:95]
ds_read_b64_tr_b16 v[182:183], v231 offset:20992
s_mul_i32 s3, s50, 640
v_mfma_f32_16x16x32_bf16 v[96:99], v[188:191], a[112:115], v[96:99]
global_load_lds_dwordx4 v226, s[4:5] offset:2048
v_mfma_f32_16x16x32_bf16 v[100:103], v[188:191], a[116:119], v[100:103]
global_load_lds_dwordx4 v227, s[4:5] offset:3072
v_mfma_f32_16x16x32_bf16 v[104:107], v[188:191], a[120:123], v[104:107]
s_add_u32 s3, s3, 161280
v_lshlrev_b32 v252, 1, v2
v_mfma_f32_16x16x32_bf16 v[108:111], v[188:191], a[124:127], v[108:111]
v_mov_b32 v253, 340
s_waitcnt lgkmcnt(0)
v_mfma_f32_16x16x32_bf16 v[48:51], v[176:179], a[128:131], v[48:51]
ds_read_b64_tr_b16 v[184:185], v234 offset:8192
v_cmp_eq_u32 vcc, 2, v3
s_nop 1
v_cndmask_b32 v252, v253, v252, vcc
v_mfma_f32_16x16x32_bf16 v[52:55], v[176:179], a[132:135], v[52:55]
ds_read_b64_tr_b16 v[186:187], v234 offset:8704
v_add_u32 v252, s3, v252
v_mfma_f32_16x16x32_bf16 v[56:59], v[176:179], a[136:139], v[56:59]
ds_read_b64_tr_b16 v[188:189], v234 offset:20480
ds_write_b16 v252, v150 offset:0
v_mfma_f32_16x16x32_bf16 v[60:63], v[176:179], a[140:143], v[60:63]
ds_read_b64_tr_b16 v[190:191], v234 offset:20992
ds_write_b16_d16_hi v252, v150 offset:160
v_mfma_f32_16x16x32_bf16 v[64:67], v[180:183], a[128:131], v[64:67]
s_add_u32 m0, s73, 28672
ds_write_b16 v252, v154 offset:32
v_mfma_f32_16x16x32_bf16 v[68:71], v[180:183], a[132:135], v[68:71]
ds_write_b16_d16_hi v252, v154 offset:192
ds_write_b16 v252, v158 offset:64
v_mfma_f32_16x16x32_bf16 v[72:75], v[180:183], a[136:139], v[72:75]
ds_write_b16_d16_hi v252, v158 offset:224
ds_write_b16 v252, v162 offset:96
v_mfma_f32_16x16x32_bf16 v[76:79], v[180:183], a[140:143], v[76:79]
ds_write_b16_d16_hi v252, v162 offset:256
ds_write_b16 v252, v166 offset:128
s_waitcnt lgkmcnt(0)
s_waitcnt vmcnt(16)
s_barrier
v_mfma_f32_16x16x32_bf16 v[80:83], v[184:187], a[128:131], v[80:83]
ds_read_b64_tr_b16 v[176:177], v231 offset:24576
ds_write_b16_d16_hi v252, v166 offset:288
v_mfma_f32_16x16x32_bf16 v[84:87], v[184:187], a[132:135], v[84:87]
ds_read_b64_tr_b16 v[178:179], v231 offset:25088
v_mul_u32_u24 v253, 160, v2
v_mfma_f32_16x16x32_bf16 v[88:91], v[184:187], a[136:139], v[88:91]
ds_read_b64_tr_b16 v[180:181], v231 offset:36864
v_lshl_add_u32 v253, v3, 3, v253
v_mfma_f32_16x16x32_bf16 v[92:95], v[184:187], a[140:143], v[92:95]
ds_read_b64_tr_b16 v[182:183], v231 offset:37376
v_add_u32 v253, s3, v253
v_mfma_f32_16x16x32_bf16 v[96:99], v[188:191], a[128:131], v[96:99]
global_load_lds_dwordx4 v228, s[4:5] offset:0
v_mfma_f32_16x16x32_bf16 v[100:103], v[188:191], a[132:135], v[100:103]
global_load_lds_dwordx4 v229, s[4:5] offset:1024
v_mfma_f32_16x16x32_bf16 v[104:107], v[188:191], a[136:139], v[104:107]
v_mov_b32 v252, 161024
v_mfma_f32_16x16x32_bf16 v[108:111], v[188:191], a[140:143], v[108:111]
v_cmp_gt_u32 vcc, 2, v2
s_nop 1
v_cndmask_b32 v253, v252, v253, vcc
s_waitcnt lgkmcnt(0)
v_mfma_f32_16x16x32_bf16 v[48:51], v[176:179], a[144:147], v[48:51]
ds_read_b64_tr_b16 v[184:185], v234 offset:24576
s_lshl_b32 s3, s51, 8
v_mfma_f32_16x16x32_bf16 v[52:55], v[176:179], a[148:151], v[52:55]
ds_read_b64_tr_b16 v[186:187], v234 offset:25088
s_add_u32 s3, s3, 159744
v_mfma_f32_16x16x32_bf16 v[56:59], v[176:179], a[152:155], v[56:59]
ds_read_b64_tr_b16 v[188:189], v234 offset:36864
v_lshl_add_u32 v252, v3, 4, s3
v_mfma_f32_16x16x32_bf16 v[60:63], v[176:179], a[156:159], v[60:63]
ds_read_b64_tr_b16 v[190:191], v234 offset:37376
ds_read_b128 v[168:171], v252 offset:0
v_mfma_f32_16x16x32_bf16 v[64:67], v[180:183], a[144:147], v[64:67]
s_add_u32 s4, s32, 884992
s_addc_u32 s5, s33, 0
v_mfma_f32_16x16x32_bf16 v[68:71], v[180:183], a[148:151], v[68:71]
ds_read_b128 v[172:175], v252 offset:64
v_mfma_f32_16x16x32_bf16 v[72:75], v[180:183], a[152:155], v[72:75]
v_mfma_f32_16x16x32_bf16 v[76:79], v[180:183], a[156:159], v[76:79]
s_waitcnt lgkmcnt(2)
v_mfma_f32_16x16x32_bf16 v[80:83], v[184:187], a[144:147], v[80:83]
ds_read_b64_tr_b16 v[176:177], v231 offset:28672
v_mfma_f32_16x16x32_bf16 v[84:87], v[184:187], a[148:151], v[84:87]
ds_read_b64_tr_b16 v[178:179], v231 offset:29184
v_mfma_f32_16x16x32_bf16 v[88:91], v[184:187], a[152:155], v[88:91]
ds_read_b64_tr_b16 v[180:181], v231 offset:40960
v_mfma_f32_16x16x32_bf16 v[92:95], v[184:187], a[156:159], v[92:95]
ds_read_b64_tr_b16 v[182:183], v231 offset:41472
v_mfma_f32_16x16x32_bf16 v[96:99], v[188:191], a[144:147], v[96:99]
s_add_u32 m0, s73, 49152
s_nop 0
global_load_lds_dwordx4 v224, s[4:5] offset:0
v_mfma_f32_16x16x32_bf16 v[100:103], v[188:191], a[148:151], v[100:103]
s_waitcnt lgkmcnt(5)
v_mul_f32 v192, v192, v168
v_mul_f32 v193, v193, v169
v_mfma_f32_16x16x32_bf16 v[104:107], v[188:191], a[152:155], v[104:107]
v_mul_f32 v194, v194, v170
v_mul_f32 v195, v195, v171
v_mfma_f32_16x16x32_bf16 v[108:111], v[188:191], a[156:159], v[108:111]
v_cvt_pk_bf16_f32 v212, v192, v193
v_cvt_pk_bf16_f32 v213, v194, v195
s_waitcnt lgkmcnt(0)
v_mfma_f32_16x16x32_bf16 v[48:51], v[176:179], a[160:163], v[48:51]
ds_read_b64_tr_b16 v[184:185], v234 offset:28672
ds_read_b128 v[168:171], v252 offset:128
v_mfma_f32_16x16x32_bf16 v[52:55], v[176:179], a[164:167], v[52:55]
ds_read_b64_tr_b16 v[186:187], v234 offset:29184
v_mul_f32 v196, v196, v172
v_mfma_f32_16x16x32_bf16 v[56:59], v[176:179], a[168:171], v[56:59]
ds_read_b64_tr_b16 v[188:189], v234 offset:40960
v_mul_f32 v197, v197, v173
v_mfma_f32_16x16x32_bf16 v[60:63], v[176:179], a[172:175], v[60:63]
ds_read_b64_tr_b16 v[190:191], v234 offset:41472
v_mul_f32 v198, v198, v174
v_mfma_f32_16x16x32_bf16 v[64:67], v[180:183], a[160:163], v[64:67]
global_load_lds_dwordx4 v225, s[4:5] offset:1024
v_mfma_f32_16x16x32_bf16 v[68:71], v[180:183], a[164:167], v[68:71]
v_mul_f32 v199, v199, v175
v_cvt_pk_bf16_f32 v214, v196, v197
v_mfma_f32_16x16x32_bf16 v[72:75], v[180:183], a[168:171], v[72:75]
v_cvt_pk_bf16_f32 v215, v198, v199
ds_read_b128 v[172:175], v252 offset:192
v_mfma_f32_16x16x32_bf16 v[76:79], v[180:183], a[172:175], v[76:79]
s_waitcnt lgkmcnt(1)
v_mfma_f32_16x16x32_bf16 v[80:83], v[184:187], a[160:163], v[80:83]
ds_read_b64_tr_b16 v[176:177], v231 offset:32768
v_mul_f32 v200, v200, v168
v_mfma_f32_16x16x32_bf16 v[84:87], v[184:187], a[164:167], v[84:87]
ds_read_b64_tr_b16 v[178:179], v231 offset:33280
v_mul_f32 v201, v201, v169
v_mfma_f32_16x16x32_bf16 v[88:91], v[184:187], a[168:171], v[88:91]
ds_read_b64_tr_b16 v[180:181], v231 offset:45056
v_mul_f32 v202, v202, v170
v_mfma_f32_16x16x32_bf16 v[92:95], v[184:187], a[172:175], v[92:95]
ds_read_b64_tr_b16 v[182:183], v231 offset:45568
v_mul_f32 v203, v203, v171
v_mfma_f32_16x16x32_bf16 v[96:99], v[188:191], a[160:163], v[96:99]
global_load_lds_dwordx4 v226, s[4:5] offset:2048
v_mfma_f32_16x16x32_bf16 v[100:103], v[188:191], a[164:167], v[100:103]
global_load_lds_dwordx4 v227, s[4:5] offset:3072
v_mfma_f32_16x16x32_bf16 v[104:107], v[188:191], a[168:171], v[104:107]
v_cvt_pk_bf16_f32 v216, v200, v201
v_cvt_pk_bf16_f32 v217, v202, v203
v_mfma_f32_16x16x32_bf16 v[108:111], v[188:191], a[172:175], v[108:111]
ds_read_b128 v[168:171], v252 offset:256
s_waitcnt lgkmcnt(5)
v_mul_f32 v204, v204, v172
s_waitcnt lgkmcnt(1)
v_mfma_f32_16x16x32_bf16 v[48:51], v[176:179], a[176:179], v[48:51]
ds_read_b64_tr_b16 v[184:185], v234 offset:32768
v_mul_f32 v205, v205, v173
v_mfma_f32_16x16x32_bf16 v[52:55], v[176:179], a[180:183], v[52:55]
ds_read_b64_tr_b16 v[186:187], v234 offset:33280
v_mul_f32 v206, v206, v174
v_mfma_f32_16x16x32_bf16 v[56:59], v[176:179], a[184:187], v[56:59]
ds_read_b64_tr_b16 v[188:189], v234 offset:45056
v_mul_f32 v207, v207, v175
v_mfma_f32_16x16x32_bf16 v[60:63], v[176:179], a[188:191], v[60:63]
ds_read_b64_tr_b16 v[190:191], v234 offset:45568
v_cvt_pk_bf16_f32 v218, v204, v205
v_mfma_f32_16x16x32_bf16 v[64:67], v[180:183], a[176:179], v[64:67]
s_add_u32 m0, s73, 53248
v_cvt_pk_bf16_f32 v219, v206, v207
v_mfma_f32_16x16x32_bf16 v[68:71], v[180:183], a[180:183], v[68:71]
ds_read_b64 v[192:193], v253 offset:0
ds_read_b64 v[194:195], v253 offset:32
v_mfma_f32_16x16x32_bf16 v[72:75], v[180:183], a[184:187], v[72:75]
ds_read_b64 v[196:197], v253 offset:64
ds_read_b64 v[198:199], v253 offset:96
v_mfma_f32_16x16x32_bf16 v[76:79], v[180:183], a[188:191], v[76:79]
ds_read_b64 v[200:201], v253 offset:128
s_waitcnt lgkmcnt(0)
s_waitcnt vmcnt(16)
s_barrier
v_mfma_f32_16x16x32_bf16 v[80:83], v[184:187], a[176:179], v[80:83]
ds_read_b64_tr_b16 v[176:177], v232 offset:0
v_mul_f32 v208, v208, v168
v_mfma_f32_16x16x32_bf16 v[84:87], v[184:187], a[180:183], v[84:87]
ds_read_b64_tr_b16 v[178:179], v232 offset:512
v_mul_f32 v209, v209, v169
v_mfma_f32_16x16x32_bf16 v[88:91], v[184:187], a[184:187], v[88:91]
ds_read_b64_tr_b16 v[180:181], v232 offset:12288
v_mul_f32 v210, v210, v170
v_mfma_f32_16x16x32_bf16 v[92:95], v[184:187], a[188:191], v[92:95]
ds_read_b64_tr_b16 v[182:183], v232 offset:12800
v_mul_f32 v211, v211, v171
v_mfma_f32_16x16x32_bf16 v[96:99], v[188:191], a[176:179], v[96:99]
global_load_lds_dwordx4 v228, s[4:5] offset:0
v_mfma_f32_16x16x32_bf16 v[100:103], v[188:191], a[180:183], v[100:103]
global_load_lds_dwordx4 v229, s[4:5] offset:1024
v_mfma_f32_16x16x32_bf16 v[104:107], v[188:191], a[184:187], v[104:107]
v_cvt_pk_bf16_f32 v220, v208, v209
v_cvt_pk_bf16_f32 v221, v210, v211
v_mfma_f32_16x16x32_bf16 v[108:111], v[188:191], a[188:191], v[108:111]
s_lshl_b32 s3, s51, 6
s_add_u32 s3, s3, s55
s_waitcnt lgkmcnt(0)
v_mfma_f32_16x16x32_bf16 v[48:51], v[176:179], a[192:195], v[48:51]
ds_read_b64_tr_b16 v[184:185], v235 offset:0
v_mov_b32 v253, 0xf149f2ca
v_mfma_f32_16x16x32_bf16 v[52:55], v[176:179], a[196:199], v[52:55]
ds_read_b64_tr_b16 v[186:187], v235 offset:512
s_cmp_eq_u32 s3, 0
s_cselect_b64 vcc, -1, 0
v_mfma_f32_16x16x32_bf16 v[56:59], v[176:179], a[200:203], v[56:59]
ds_read_b64_tr_b16 v[188:189], v235 offset:12288
v_cndmask_b32 v204, v8, v253, vcc
v_mfma_f32_16x16x32_bf16 v[60:63], v[176:179], a[204:207], v[60:63]
ds_read_b64_tr_b16 v[190:191], v235 offset:12800
v_cndmask_b32 v205, v9, v253, vcc
v_mfma_f32_16x16x32_bf16 v[64:67], v[180:183], a[192:195], v[64:67]
s_add_u32 s4, s32, 1769728
s_addc_u32 s5, s33, 0
v_mfma_f32_16x16x32_bf16 v[68:71], v[180:183], a[196:199], v[68:71]
v_cndmask_b32 v206, v10, v253, vcc
v_cndmask_b32 v207, v11, v253, vcc
v_mfma_f32_16x16x32_bf16 v[72:75], v[180:183], a[200:203], v[72:75]
s_lshl_b32 s3, s50, 12
s_add_u32 s3, s3, 122880
v_mfma_f32_16x16x32_bf16 v[76:79], v[180:183], a[204:207], v[76:79]
v_lshl_add_u32 v252, v1, 4, s3
s_waitcnt lgkmcnt(0)
v_mfma_f32_16x16x32_bf16 v[80:83], v[184:187], a[192:195], v[80:83]
ds_read_b64_tr_b16 v[176:177], v232 offset:4096
v_mfma_f32_16x16x32_bf16 v[84:87], v[184:187], a[196:199], v[84:87]
ds_read_b64_tr_b16 v[178:179], v232 offset:4608
v_mfma_f32_16x16x32_bf16 v[88:91], v[184:187], a[200:203], v[88:91]
ds_read_b64_tr_b16 v[180:181], v232 offset:16384
v_mfma_f32_16x16x32_bf16 v[92:95], v[184:187], a[204:207], v[92:95]
ds_read_b64_tr_b16 v[182:183], v232 offset:16896
v_mfma_f32_16x16x32_bf16 v[96:99], v[188:191], a[192:195], v[96:99]
s_add_u32 m0, s73, 73728
s_nop 0
global_load_lds_dwordx4 v224, s[4:5] offset:0
v_mfma_f32_16x16x32_bf16 v[100:103], v[188:191], a[196:199], v[100:103]
v_mfma_f32_16x16x32_bf16 v[148:151], v[128:131], v[112:115], v[204:207]
v_mfma_f32_16x16x32_bf16 v[152:155], v[132:135], v[112:115], v[12:15]
v_mfma_f32_16x16x32_bf16 v[164:167], v[136:139], v[120:123], v[8:11]
v_mfma_f32_16x16x32_bf16 v[168:171], v[140:143], v[120:123], v[12:15]
v_mfma_f32_16x16x32_bf16 v[104:107], v[188:191], a[200:203], v[104:107]
v_mfma_f32_16x16x32_bf16 v[108:111], v[188:191], a[204:207], v[108:111]
s_waitcnt lgkmcnt(0)
v_mfma_f32_16x16x32_bf16 v[48:51], v[176:179], a[208:211], v[48:51]
ds_read_b64_tr_b16 v[184:185], v235 offset:4096
v_max3_f32 v160, v148, v149, v150
v_mfma_f32_16x16x32_bf16 v[52:55], v[176:179], a[212:215], v[52:55]
ds_read_b64_tr_b16 v[186:187], v235 offset:4608
v_max3_f32 v160, v160, v151, v152
v_mfma_f32_16x16x32_bf16 v[56:59], v[176:179], a[216:219], v[56:59]
ds_read_b64_tr_b16 v[188:189], v235 offset:16384
v_max3_f32 v160, v160, v153, v154
v_mfma_f32_16x16x32_bf16 v[60:63], v[176:179], a[220:223], v[60:63]
ds_read_b64_tr_b16 v[190:191], v235 offset:16896
v_max_f32 v160, v160, v155
v_mfma_f32_16x16x32_bf16 v[64:67], v[180:183], a[208:211], v[64:67]
global_load_lds_dwordx4 v225, s[4:5] offset:1024
v_mfma_f32_16x16x32_bf16 v[68:71], v[180:183], a[212:215], v[68:71]
v_mov_b32 v161, v160
v_max3_f32 v172, v164, v165, v166
v_mfma_f32_16x16x32_bf16 v[72:75], v[180:183], a[216:219], v[72:75]
v_permlane16_swap_b32 v160, v161
v_max_f32 v160, v160, v161
v_mfma_f32_16x16x32_bf16 v[76:79], v[180:183], a[220:223], v[76:79]
v_mov_b32 v161, v160
v_max3_f32 v172, v172, v167, v168
s_waitcnt lgkmcnt(0)
v_mfma_f32_16x16x32_bf16 v[80:83], v[184:187], a[208:211], v[80:83]
ds_read_b64_tr_b16 v[176:177], v232 offset:8192
v_permlane32_swap_b32 v160, v161
v_mfma_f32_16x16x32_bf16 v[84:87], v[184:187], a[212:215], v[84:87]
ds_read_b64_tr_b16 v[178:179], v232 offset:8704
v_max_f32 v160, v160, v161
v_mfma_f32_16x16x32_bf16 v[88:91], v[184:187], a[216:219], v[88:91]
ds_read_b64_tr_b16 v[180:181], v232 offset:20480
v_sub_f32 v148, v148, v160
v_mfma_f32_16x16x32_bf16 v[92:95], v[184:187], a[220:223], v[92:95]
ds_read_b64_tr_b16 v[182:183], v232 offset:20992
v_sub_f32 v149, v149, v160
v_mfma_f32_16x16x32_bf16 v[96:99], v[188:191], a[208:211], v[96:99]
global_load_lds_dwordx4 v226, s[4:5] offset:2048
v_mfma_f32_16x16x32_bf16 v[100:103], v[188:191], a[212:215], v[100:103]
global_load_lds_dwordx4 v227, s[4:5] offset:3072
v_mfma_f32_16x16x32_bf16 v[104:107], v[188:191], a[216:219], v[104:107]
v_sub_f32 v150, v150, v160
v_sub_f32 v151, v151, v160
v_mfma_f32_16x16x32_bf16 v[108:111], v[188:191], a[220:223], v[108:111]
v_sub_f32 v152, v152, v160
v_sub_f32 v153, v153, v160
s_waitcnt lgkmcnt(0)
v_mfma_f32_16x16x32_bf16 v[48:51], v[176:179], a[224:227], v[48:51]
ds_read_b64_tr_b16 v[184:185], v235 offset:8192
v_sub_f32 v154, v154, v160
v_mfma_f32_16x16x32_bf16 v[52:55], v[176:179], a[228:231], v[52:55]
ds_read_b64_tr_b16 v[186:187], v235 offset:8704
v_sub_f32 v155, v155, v160
v_mfma_f32_16x16x32_bf16 v[56:59], v[176:179], a[232:235], v[56:59]
ds_read_b64_tr_b16 v[188:189], v235 offset:20480
v_max3_f32 v172, v172, v169, v170
v_mfma_f32_16x16x32_bf16 v[60:63], v[176:179], a[236:239], v[60:63]
ds_read_b64_tr_b16 v[190:191], v235 offset:20992
v_max_f32 v172, v172, v171
v_mfma_f32_16x16x32_bf16 v[64:67], v[180:183], a[224:227], v[64:67]
s_add_u32 m0, s73, 77824
v_mov_b32 v173, v172
v_mfma_f32_16x16x32_bf16 v[68:71], v[180:183], a[228:231], v[68:71]
v_exp_f32 v148, v148
v_mfma_f32_16x16x32_bf16 v[72:75], v[180:183], a[232:235], v[72:75]
v_exp_f32 v149, v149
v_mfma_f32_16x16x32_bf16 v[76:79], v[180:183], a[236:239], v[76:79]
v_exp_f32 v150, v150
s_waitcnt lgkmcnt(0)
s_waitcnt vmcnt(16)
s_barrier
v_mfma_f32_16x16x32_bf16 v[80:83], v[184:187], a[224:227], v[80:83]
ds_read_b64_tr_b16 v[176:177], v230 offset:0
v_cvt_pk_bf16_f32 v156, v148, v149
v_mfma_f32_16x16x32_bf16 v[84:87], v[184:187], a[228:231], v[84:87]
ds_read_b64_tr_b16 v[178:179], v230 offset:512
v_add_f32 v162, v148, v149
v_mfma_f32_16x16x32_bf16 v[88:91], v[184:187], a[232:235], v[88:91]
ds_read_b64_tr_b16 v[180:181], v230 offset:12288
v_add_f32 v162, v162, v150
v_mfma_f32_16x16x32_bf16 v[92:95], v[184:187], a[236:239], v[92:95]
ds_read_b64_tr_b16 v[182:183], v230 offset:12800
v_permlane16_swap_b32 v172, v173
v_mfma_f32_16x16x32_bf16 v[96:99], v[188:191], a[224:227], v[96:99]
global_load_lds_dwordx4 v228, s[4:5] offset:0
v_mfma_f32_16x16x32_bf16 v[100:103], v[188:191], a[228:231], v[100:103]
global_load_lds_dwordx4 v229, s[4:5] offset:1024
v_mfma_f32_16x16x32_bf16 v[104:107], v[188:191], a[232:235], v[104:107]
v_exp_f32 v151, v151
v_mfma_f32_16x16x32_bf16 v[108:111], v[188:191], a[236:239], v[108:111]
v_exp_f32 v152, v152
s_waitcnt lgkmcnt(0)
v_mfma_f32_16x16x32_bf16 v[48:51], v[176:179], a[240:243], v[48:51]
ds_read_b64_tr_b16 v[184:185], v233 offset:0
v_cvt_pk_bf16_f32 v157, v150, v151
v_mfma_f32_16x16x32_bf16 v[52:55], v[176:179], a[244:247], v[52:55]
ds_read_b64_tr_b16 v[186:187], v233 offset:512
v_add_f32 v162, v162, v151
v_mfma_f32_16x16x32_bf16 v[56:59], v[176:179], a[248:251], v[56:59]
ds_read_b64_tr_b16 v[188:189], v233 offset:12288
v_add_f32 v162, v162, v152
v_mfma_f32_16x16x32_bf16 v[60:63], v[176:179], a[252:255], v[60:63]
ds_read_b64_tr_b16 v[190:191], v233 offset:12800
v_max_f32 v172, v172, v173
v_mfma_f32_16x16x32_bf16 v[64:67], v[180:183], a[240:243], v[64:67]
s_add_u32 s4, s32, 2654464
s_addc_u32 s5, s33, 0
v_mfma_f32_16x16x32_bf16 v[68:71], v[180:183], a[244:247], v[68:71]
v_exp_f32 v153, v153
v_mfma_f32_16x16x32_bf16 v[72:75], v[180:183], a[248:251], v[72:75]
v_exp_f32 v154, v154
v_mfma_f32_16x16x32_bf16 v[76:79], v[180:183], a[252:255], v[76:79]
v_exp_f32 v155, v155
s_waitcnt lgkmcnt(0)
v_mfma_f32_16x16x32_bf16 v[80:83], v[184:187], a[240:243], v[80:83]
ds_read_b64_tr_b16 v[176:177], v230 offset:4096
v_cvt_pk_bf16_f32 v158, v152, v153
v_mfma_f32_16x16x32_bf16 v[84:87], v[184:187], a[244:247], v[84:87]
ds_read_b64_tr_b16 v[178:179], v230 offset:4608
v_cvt_pk_bf16_f32 v159, v154, v155
v_mfma_f32_16x16x32_bf16 v[88:91], v[184:187], a[248:251], v[88:91]
ds_read_b64_tr_b16 v[180:181], v230 offset:16384
v_add_f32 v162, v162, v153
v_mfma_f32_16x16x32_bf16 v[92:95], v[184:187], a[252:255], v[92:95]
ds_read_b64_tr_b16 v[182:183], v230 offset:16896
v_add_f32 v162, v162, v154
v_mfma_f32_16x16x32_bf16 v[96:99], v[188:191], a[240:243], v[96:99]
s_add_u32 m0, s73, 98304
s_nop 0
global_load_lds_dwordx4 v224, s[4:5] offset:0
v_mfma_f32_16x16x32_bf16 v[100:103], v[188:191], a[244:247], v[100:103]
v_add_f32 v162, v162, v155
v_mov_b32 v173, v172
v_mfma_f32_16x16x32_bf16 v[104:107], v[188:191], a[248:251], v[104:107]
v_mfma_f32_16x16x32_bf16 v[148:151], v[212:215], v[156:159], 0
v_mfma_f32_16x16x32_bf16 v[152:155], v[192:195], v[156:159], 0
v_mov_b32 v161, v162
v_permlane32_swap_b32 v172, v173
v_mfma_f32_16x16x32_bf16 v[108:111], v[188:191], a[252:255], v[108:111]
v_permlane16_swap_b32 v162, v161
v_add_f32 v162, v162, v161
s_waitcnt lgkmcnt(0)
v_mfma_f32_16x16x32_bf16 v[48:51], v[176:179], v[16:19], v[48:51]
ds_read_b64_tr_b16 v[184:185], v233 offset:4096
v_mov_b32 v161, v162
v_mfma_f32_16x16x32_bf16 v[52:55], v[176:179], v[20:23], v[52:55]
ds_read_b64_tr_b16 v[186:187], v233 offset:4608
v_permlane32_swap_b32 v162, v161
v_mfma_f32_16x16x32_bf16 v[56:59], v[176:179], v[24:27], v[56:59]
ds_read_b64_tr_b16 v[188:189], v233 offset:16384
v_add_f32 v162, v162, v161
v_mfma_f32_16x16x32_bf16 v[60:63], v[176:179], v[28:31], v[60:63]
ds_read_b64_tr_b16 v[190:191], v233 offset:16896
v_max_f32 v172, v172, v173
v_mfma_f32_16x16x32_bf16 v[64:67], v[180:183], v[16:19], v[64:67]
global_load_lds_dwordx4 v225, s[4:5] offset:1024
v_mfma_f32_16x16x32_bf16 v[68:71], v[180:183], v[20:23], v[68:71]
v_rcp_f32 v162, v162
v_mfma_f32_16x16x32_bf16 v[72:75], v[180:183], v[24:27], v[72:75]
v_mul_f32 v148, v148, v162
v_mul_f32 v149, v149, v162
v_mfma_f32_16x16x32_bf16 v[76:79], v[180:183], v[28:31], v[76:79]
v_mul_f32 v150, v150, v162
v_mul_f32 v151, v151, v162
s_waitcnt lgkmcnt(0)
v_mfma_f32_16x16x32_bf16 v[80:83], v[184:187], v[16:19], v[80:83]
ds_read_b64_tr_b16 v[176:177], v230 offset:8192
v_mul_f32 v152, v152, v162
v_mfma_f32_16x16x32_bf16 v[84:87], v[184:187], v[20:23], v[84:87]
ds_read_b64_tr_b16 v[178:179], v230 offset:8704
v_mul_f32 v153, v153, v162
v_mfma_f32_16x16x32_bf16 v[88:91], v[184:187], v[24:27], v[88:91]
ds_read_b64_tr_b16 v[180:181], v230 offset:20480
v_mul_f32 v154, v154, v162
v_mfma_f32_16x16x32_bf16 v[92:95], v[184:187], v[28:31], v[92:95]
ds_read_b64_tr_b16 v[182:183], v230 offset:20992
v_mul_f32 v155, v155, v162
v_mfma_f32_16x16x32_bf16 v[96:99], v[188:191], v[16:19], v[96:99]
global_load_lds_dwordx4 v226, s[4:5] offset:2048
v_mfma_f32_16x16x32_bf16 v[100:103], v[188:191], v[20:23], v[100:103]
global_load_lds_dwordx4 v227, s[4:5] offset:3072
v_mfma_f32_16x16x32_bf16 v[104:107], v[188:191], v[24:27], v[104:107]
v_cvt_pk_bf16_f32 v156, v148, v149
v_cvt_pk_bf16_f32 v157, v150, v151
v_mfma_f32_16x16x32_bf16 v[108:111], v[188:191], v[28:31], v[108:111]
v_cvt_pk_bf16_f32 v158, v152, v153
v_cvt_pk_bf16_f32 v159, v154, v155
s_waitcnt lgkmcnt(0)
v_mfma_f32_16x16x32_bf16 v[48:51], v[176:179], v[32:35], v[48:51]
ds_read_b64_tr_b16 v[184:185], v233 offset:8192
v_sub_f32 v164, v164, v172
v_mfma_f32_16x16x32_bf16 v[52:55], v[176:179], v[36:39], v[52:55]
ds_read_b64_tr_b16 v[186:187], v233 offset:8704
v_sub_f32 v165, v165, v172
v_mfma_f32_16x16x32_bf16 v[56:59], v[176:179], v[40:43], v[56:59]
ds_read_b64_tr_b16 v[188:189], v233 offset:20480
v_sub_f32 v166, v166, v172
v_mfma_f32_16x16x32_bf16 v[60:63], v[176:179], v[44:47], v[60:63]
ds_read_b64_tr_b16 v[190:191], v233 offset:20992
v_sub_f32 v167, v167, v172
v_mfma_f32_16x16x32_bf16 v[64:67], v[180:183], v[32:35], v[64:67]
s_add_u32 m0, s73, 102400
v_sub_f32 v168, v168, v172
v_mfma_f32_16x16x32_bf16 v[68:71], v[180:183], v[36:39], v[68:71]
ds_write_b128 v252, v[156:159] offset:0
v_mfma_f32_16x16x32_bf16 v[72:75], v[180:183], v[40:43], v[72:75]
v_mfma_f32_16x16x32_bf16 v[148:151], v[132:135], v[116:119], v[8:11]
v_mfma_f32_16x16x32_bf16 v[152:155], v[136:139], v[116:119], v[12:15]
v_sub_f32 v169, v169, v172
v_sub_f32 v170, v170, v172
v_mfma_f32_16x16x32_bf16 v[76:79], v[180:183], v[44:47], v[76:79]
v_sub_f32 v171, v171, v172
s_waitcnt lgkmcnt(0)
s_waitcnt vmcnt(16)
s_barrier
v_mfma_f32_16x16x32_bf16 v[80:83], v[184:187], v[32:35], v[80:83]
ds_read_b64_tr_b16 v[176:177], v230 offset:24576
v_max3_f32 v160, v148, v149, v150
v_mfma_f32_16x16x32_bf16 v[84:87], v[184:187], v[36:39], v[84:87]
ds_read_b64_tr_b16 v[178:179], v230 offset:25088
v_max3_f32 v160, v160, v151, v152
v_mfma_f32_16x16x32_bf16 v[88:91], v[184:187], v[40:43], v[88:91]
ds_read_b64_tr_b16 v[180:181], v230 offset:36864
v_max3_f32 v160, v160, v153, v154
v_mfma_f32_16x16x32_bf16 v[92:95], v[184:187], v[44:47], v[92:95]
ds_read_b64_tr_b16 v[182:183], v230 offset:37376
v_max_f32 v160, v160, v155
v_mfma_f32_16x16x32_bf16 v[96:99], v[188:191], v[32:35], v[96:99]
global_load_lds_dwordx4 v228, s[4:5] offset:0
v_mfma_f32_16x16x32_bf16 v[100:103], v[188:191], v[36:39], v[100:103]
global_load_lds_dwordx4 v229, s[4:5] offset:1024
v_mfma_f32_16x16x32_bf16 v[104:107], v[188:191], v[40:43], v[104:107]
v_mov_b32 v161, v160
v_mfma_f32_16x16x32_bf16 v[108:111], v[188:191], v[44:47], v[108:111]
v_exp_f32 v164, v164
v_permlane16_swap_b32 v160, v161
v_max_f32 v160, v160, v161
v_mov_b32 v161, v160
v_exp_f32 v165, v165
v_exp_f32 v166, v166
v_permlane32_swap_b32 v160, v161
v_max_f32 v160, v160, v161
v_sub_f32 v148, v148, v160
v_sub_f32 v149, v149, v160
v_sub_f32 v150, v150, v160
v_sub_f32 v151, v151, v160
v_sub_f32 v152, v152, v160
v_sub_f32 v153, v153, v160
v_sub_f32 v154, v154, v160
v_sub_f32 v155, v155, v160
v_exp_f32 v167, v167
v_exp_f32 v148, v148
v_exp_f32 v149, v149
v_exp_f32 v150, v150
v_exp_f32 v151, v151
v_exp_f32 v152, v152
v_exp_f32 v153, v153
v_exp_f32 v154, v154
v_exp_f32 v155, v155
v_cvt_pk_bf16_f32 v156, v148, v149
v_exp_f32 v168, v168
v_cvt_pk_bf16_f32 v157, v150, v151
v_cvt_pk_bf16_f32 v158, v152, v153
v_cvt_pk_bf16_f32 v159, v154, v155
v_add_f32 v162, v148, v149
v_add_f32 v162, v162, v150
v_add_f32 v162, v162, v151
v_add_f32 v162, v162, v152
v_add_f32 v162, v162, v153
v_add_f32 v162, v162, v154
v_add_f32 v162, v162, v155
v_mfma_f32_16x16x32_bf16 v[148:151], v[214:217], v[156:159], 0
v_mfma_f32_16x16x32_bf16 v[152:155], v[194:197], v[156:159], 0
v_mov_b32 v161, v162
v_exp_f32 v169, v169
v_exp_f32 v170, v170
v_permlane16_swap_b32 v162, v161
v_add_f32 v162, v162, v161
v_mov_b32 v161, v162
v_exp_f32 v171, v171
v_cvt_pk_bf16_f32 v208, v164, v165
v_permlane32_swap_b32 v162, v161
v_add_f32 v162, v162, v161
v_rcp_f32 v162, v162
v_cvt_pk_bf16_f32 v209, v166, v167
v_mul_f32 v148, v148, v162
v_cvt_pk_bf16_f32 v210, v168, v169
v_mul_f32 v149, v149, v162
v_mul_f32 v150, v150, v162
v_mul_f32 v151, v151, v162
v_mul_f32 v152, v152, v162
v_mul_f32 v153, v153, v162
v_mul_f32 v154, v154, v162
v_mul_f32 v155, v155, v162
v_cvt_pk_bf16_f32 v156, v148, v149
v_cvt_pk_bf16_f32 v157, v150, v151
v_cvt_pk_bf16_f32 v158, v152, v153
v_cvt_pk_bf16_f32 v159, v154, v155
ds_write_b128 v252, v[156:159] offset:1024
v_cvt_pk_bf16_f32 v211, v170, v171
v_add_f32 v174, v164, v165
v_add_f32 v174, v174, v166
v_add_f32 v174, v174, v167
v_add_f32 v174, v174, v168
v_add_f32 v174, v174, v169
v_add_f32 v174, v174, v170
v_add_f32 v174, v174, v171
v_mfma_f32_16x16x32_bf16 v[164:167], v[216:219], v[208:211], 0
v_mfma_f32_16x16x32_bf16 v[168:171], v[196:199], v[208:211], 0
v_mov_b32 v173, v174
s_nop 1
v_permlane16_swap_b32 v174, v173
v_add_f32 v174, v174, v173
v_mov_b32 v173, v174
s_nop 1
v_permlane32_swap_b32 v174, v173
v_add_f32 v174, v174, v173
v_rcp_f32 v174, v174
s_nop 0
v_mul_f32 v164, v164, v174
v_mul_f32 v165, v165, v174
v_mul_f32 v166, v166, v174
v_mul_f32 v167, v167, v174
v_mul_f32 v168, v168, v174
v_mul_f32 v169, v169, v174
v_mul_f32 v170, v170, v174
v_mul_f32 v171, v171, v174
v_cvt_pk_bf16_f32 v208, v164, v165
v_cvt_pk_bf16_f32 v209, v166, v167
v_cvt_pk_bf16_f32 v210, v168, v169
v_cvt_pk_bf16_f32 v211, v170, v171
ds_write_b128 v252, v[208:211] offset:2048
v_mfma_f32_16x16x32_bf16 v[164:167], v[140:143], v[124:127], v[8:11]
v_mfma_f32_16x16x32_bf16 v[168:171], v[144:147], v[124:127], v[12:15]
s_nop 6
v_max3_f32 v172, v164, v165, v166
v_max3_f32 v172, v172, v167, v168
v_max3_f32 v172, v172, v169, v170
v_max_f32 v172, v172, v171
v_mov_b32 v173, v172
s_nop 1
v_permlane16_swap_b32 v172, v173
v_max_f32 v172, v172, v173
v_mov_b32 v173, v172
s_nop 1
v_permlane32_swap_b32 v172, v173
v_max_f32 v172, v172, v173
v_sub_f32 v164, v164, v172
v_sub_f32 v165, v165, v172
v_sub_f32 v166, v166, v172
v_sub_f32 v167, v167, v172
v_sub_f32 v168, v168, v172
v_sub_f32 v169, v169, v172
v_sub_f32 v170, v170, v172
v_sub_f32 v171, v171, v172
v_exp_f32 v164, v164
v_exp_f32 v165, v165
v_exp_f32 v166, v166
v_cvt_pk_bf16_f32 v208, v164, v165
v_exp_f32 v167, v167
v_exp_f32 v168, v168
v_exp_f32 v169, v169
v_exp_f32 v170, v170
v_exp_f32 v171, v171
v_cvt_pk_bf16_f32 v209, v166, v167
v_cvt_pk_bf16_f32 v210, v168, v169
v_cvt_pk_bf16_f32 v211, v170, v171
v_add_f32 v174, v164, v165
v_add_f32 v174, v174, v166
v_add_f32 v174, v174, v167
v_add_f32 v174, v174, v168
v_add_f32 v174, v174, v169
v_add_f32 v174, v174, v170
v_add_f32 v174, v174, v171
v_mfma_f32_16x16x32_bf16 v[164:167], v[218:221], v[208:211], 0
v_mfma_f32_16x16x32_bf16 v[168:171], v[198:201], v[208:211], 0
v_mov_b32 v173, v174
s_nop 1
v_permlane16_swap_b32 v174, v173
v_add_f32 v174, v174, v173
v_mov_b32 v173, v174
s_nop 1
v_permlane32_swap_b32 v174, v173
v_add_f32 v174, v174, v173
v_rcp_f32 v174, v174
s_nop 0
v_mul_f32 v164, v164, v174
v_mul_f32 v165, v165, v174
v_mul_f32 v166, v166, v174
v_mul_f32 v167, v167, v174
v_mul_f32 v168, v168, v174
v_mul_f32 v169, v169, v174
v_mul_f32 v170, v170, v174
v_mul_f32 v171, v171, v174
v_cvt_pk_bf16_f32 v208, v164, v165
v_cvt_pk_bf16_f32 v209, v166, v167
v_cvt_pk_bf16_f32 v210, v168, v169
v_cvt_pk_bf16_f32 v211, v170, v171
ds_write_b128 v252, v[208:211] offset:3072
s_waitcnt lgkmcnt(3)
v_mfma_f32_16x16x32_bf16 v[112:115], v[176:179], a[0:3], 0
ds_read_b64_tr_b16 v[184:185], v233 offset:24576
s_lshr_b32 s98, s2, 3
v_mfma_f32_16x16x32_bf16 v[116:119], v[176:179], a[4:7], 0
ds_read_b64_tr_b16 v[186:187], v233 offset:25088
s_and_b32 s99, s2, 7
v_mfma_f32_16x16x32_bf16 v[120:123], v[176:179], a[8:11], 0
ds_read_b64_tr_b16 v[188:189], v233 offset:36864
v_min_u32 v8, 40, v1
v_mfma_f32_16x16x32_bf16 v[124:127], v[176:179], a[12:15], 0
ds_read_b64_tr_b16 v[190:191], v233 offset:37376
v_lshlrev_b32 v8, 7, v8
v_mfma_f32_16x16x32_bf16 v[128:131], v[180:183], a[0:3], 0
s_add_u32 s4, s32, 3539200
s_addc_u32 s5, s33, 0
v_mfma_f32_16x16x32_bf16 v[132:135], v[180:183], a[4:7], 0
s_mul_i32 s100, s99, 663552
s_mul_i32 s101, s98, 20736
v_mfma_f32_16x16x32_bf16 v[136:139], v[180:183], a[8:11], 0
s_add_u32 s100, s100, s101
s_mul_i32 s101, s50, 5248
v_mfma_f32_16x16x32_bf16 v[140:143], v[180:183], a[12:15], 0
s_add_u32 s100, s100, s101
v_mul_f32 v244, v48, v236
s_waitcnt lgkmcnt(0)
v_mfma_f32_16x16x32_bf16 v[144:147], v[184:187], a[0:3], 0
ds_read_b64_tr_b16 v[176:177], v230 offset:28672
v_mul_f32 v245, v49, v236
v_mfma_f32_16x16x32_bf16 v[148:151], v[184:187], a[4:7], 0
ds_read_b64_tr_b16 v[178:179], v230 offset:29184
v_mul_f32 v246, v50, v236
v_mfma_f32_16x16x32_bf16 v[152:155], v[184:187], a[8:11], 0
ds_read_b64_tr_b16 v[180:181], v230 offset:40960
v_mul_f32 v247, v51, v236
v_mfma_f32_16x16x32_bf16 v[156:159], v[184:187], a[12:15], 0
ds_read_b64_tr_b16 v[182:183], v230 offset:41472
v_mul_f32 v64, v48, v64
v_mfma_f32_16x16x32_bf16 v[160:163], v[188:191], a[0:3], 0
s_add_u32 m0, s73, 0
s_nop 0
global_load_lds_dwordx4 v224, s[4:5] offset:0
v_mfma_f32_16x16x32_bf16 v[164:167], v[188:191], a[4:7], 0
buffer_load_dword v9, v8, s[24:27], s100 offen
v_mfma_f32_16x16x32_bf16 v[168:171], v[188:191], a[8:11], 0
v_min_u32 v8, 5, v1
v_lshlrev_b32 v8, 7, v8
v_mfma_f32_16x16x32_bf16 v[172:175], v[188:191], a[12:15], 0
s_mul_i32 s100, s99, 82944
s_mul_i32 s101, s98, 2688
s_waitcnt lgkmcnt(0)
v_mfma_f32_16x16x32_bf16 v[112:115], v[176:179], a[16:19], v[112:115]
ds_read_b64_tr_b16 v[184:185], v233 offset:28672
s_add_u32 s100, s100, s101
v_mfma_f32_16x16x32_bf16 v[116:119], v[176:179], a[20:23], v[116:119]
ds_read_b64_tr_b16 v[186:187], v233 offset:29184
s_mul_i32 s101, s50, 768
v_mfma_f32_16x16x32_bf16 v[120:123], v[176:179], a[24:27], v[120:123]
ds_read_b64_tr_b16 v[188:189], v233 offset:40960
s_add_u32 s100, s100, s101
v_mfma_f32_16x16x32_bf16 v[124:127], v[176:179], a[28:31], v[124:127]
ds_read_b64_tr_b16 v[190:191], v233 offset:41472
v_mul_f32 v65, v49, v65
v_mfma_f32_16x16x32_bf16 v[128:131], v[180:183], a[16:19], v[128:131]
global_load_lds_dwordx4 v225, s[4:5] offset:1024
v_mfma_f32_16x16x32_bf16 v[132:135], v[180:183], a[20:23], v[132:135]
buffer_load_dword v9, v8, s[16:19], s100 offen
v_mfma_f32_16x16x32_bf16 v[136:139], v[180:183], a[24:27], v[136:139]
v_exp_f32 v244, v244
v_mfma_f32_16x16x32_bf16 v[140:143], v[180:183], a[28:31], v[140:143]
v_exp_f32 v245, v245
s_waitcnt lgkmcnt(0)
v_mfma_f32_16x16x32_bf16 v[144:147], v[184:187], a[16:19], v[144:147]
ds_read_b64_tr_b16 v[176:177], v230 offset:32768
v_mul_f32 v66, v50, v66
v_mfma_f32_16x16x32_bf16 v[148:151], v[184:187], a[20:23], v[148:151]
ds_read_b64_tr_b16 v[178:179], v230 offset:33280
v_mul_f32 v67, v51, v67
v_mfma_f32_16x16x32_bf16 v[152:155], v[184:187], a[24:27], v[152:155]
ds_read_b64_tr_b16 v[180:181], v230 offset:45056
v_fma_f32 v244, v244, v240, v240
v_mfma_f32_16x16x32_bf16 v[156:159], v[184:187], a[28:31], v[156:159]
ds_read_b64_tr_b16 v[182:183], v230 offset:45568
v_fma_f32 v245, v245, v240, v240
v_mfma_f32_16x16x32_bf16 v[160:163], v[188:191], a[16:19], v[160:163]
global_load_lds_dwordx4 v226, s[4:5] offset:2048
v_mfma_f32_16x16x32_bf16 v[164:167], v[188:191], a[20:23], v[164:167]
global_load_lds_dwordx4 v227, s[4:5] offset:3072
v_mfma_f32_16x16x32_bf16 v[168:171], v[188:191], a[24:27], v[168:171]
v_exp_f32 v246, v246
v_mfma_f32_16x16x32_bf16 v[172:175], v[188:191], a[28:31], v[172:175]
v_exp_f32 v247, v247
s_waitcnt lgkmcnt(0)
v_mfma_f32_16x16x32_bf16 v[112:115], v[176:179], a[32:35], v[112:115]
ds_read_b64_tr_b16 v[184:185], v233 offset:32768
v_fma_f32 v246, v246, v240, v240
v_mfma_f32_16x16x32_bf16 v[116:119], v[176:179], a[36:39], v[116:119]
ds_read_b64_tr_b16 v[186:187], v233 offset:33280
v_fma_f32 v247, v247, v240, v240
v_mfma_f32_16x16x32_bf16 v[120:123], v[176:179], a[40:43], v[120:123]
ds_read_b64_tr_b16 v[188:189], v233 offset:45056
v_mul_f32 v248, v52, v237
v_mfma_f32_16x16x32_bf16 v[124:127], v[176:179], a[44:47], v[124:127]
ds_read_b64_tr_b16 v[190:191], v233 offset:45568
v_mul_f32 v249, v53, v237
v_mfma_f32_16x16x32_bf16 v[128:131], v[180:183], a[32:35], v[128:131]
s_add_u32 m0, s73, 4096
v_mul_f32 v250, v54, v237
v_mfma_f32_16x16x32_bf16 v[132:135], v[180:183], a[36:39], v[132:135]
v_rcp_f32 v244, v244
v_mfma_f32_16x16x32_bf16 v[136:139], v[180:183], a[40:43], v[136:139]
v_rcp_f32 v245, v245
v_mfma_f32_16x16x32_bf16 v[140:143], v[180:183], a[44:47], v[140:143]
v_rcp_f32 v246, v246
s_waitcnt lgkmcnt(0)
s_waitcnt vmcnt(18)
s_barrier
v_mfma_f32_16x16x32_bf16 v[144:147], v[184:187], a[32:35], v[144:147]
ds_read_b64_tr_b16 v[176:177], v231 offset:0
v_mul_f32 v64, v64, v244
v_mfma_f32_16x16x32_bf16 v[148:151], v[184:187], a[36:39], v[148:151]
ds_read_b64_tr_b16 v[178:179], v231 offset:512
v_mul_f32 v65, v65, v245
v_mfma_f32_16x16x32_bf16 v[152:155], v[184:187], a[40:43], v[152:155]
ds_read_b64_tr_b16 v[180:181], v231 offset:12288
v_mul_f32 v66, v66, v246
v_mfma_f32_16x16x32_bf16 v[156:159], v[184:187], a[44:47], v[156:159]
ds_read_b64_tr_b16 v[182:183], v231 offset:12800
v_cvt_pk_bf16_f32 v192, v64, v65
v_mfma_f32_16x16x32_bf16 v[160:163], v[188:191], a[32:35], v[160:163]
global_load_lds_dwordx4 v228, s[4:5] offset:0
v_mfma_f32_16x16x32_bf16 v[164:167], v[188:191], a[36:39], v[164:167]
global_load_lds_dwordx4 v229, s[4:5] offset:1024
v_mfma_f32_16x16x32_bf16 v[168:171], v[188:191], a[40:43], v[168:171]
v_rcp_f32 v247, v247
v_mfma_f32_16x16x32_bf16 v[172:175], v[188:191], a[44:47], v[172:175]
v_mul_f32 v67, v67, v247
v_cvt_pk_bf16_f32 v193, v66, v67
s_waitcnt lgkmcnt(0)
v_mfma_f32_16x16x32_bf16 v[112:115], v[176:179], a[48:51], v[112:115]
ds_read_b64_tr_b16 v[184:185], v234 offset:0
v_mul_f32 v251, v55, v237
v_mfma_f32_16x16x32_bf16 v[116:119], v[176:179], a[52:55], v[116:119]
ds_read_b64_tr_b16 v[186:187], v234 offset:512
v_mul_f32 v68, v52, v68
v_mfma_f32_16x16x32_bf16 v[120:123], v[176:179], a[56:59], v[120:123]
ds_read_b64_tr_b16 v[188:189], v234 offset:12288
v_mul_f32 v69, v53, v69
v_mfma_f32_16x16x32_bf16 v[124:127], v[176:179], a[60:63], v[124:127]
ds_read_b64_tr_b16 v[190:191], v234 offset:12800
v_mul_f32 v70, v54, v70
v_mfma_f32_16x16x32_bf16 v[128:131], v[180:183], a[48:51], v[128:131]
s_add_u32 s4, s32, 4423936
s_addc_u32 s5, s33, 0
v_mfma_f32_16x16x32_bf16 v[132:135], v[180:183], a[52:55], v[132:135]
v_exp_f32 v248, v248
v_mfma_f32_16x16x32_bf16 v[136:139], v[180:183], a[56:59], v[136:139]
v_exp_f32 v249, v249
v_mfma_f32_16x16x32_bf16 v[140:143], v[180:183], a[60:63], v[140:143]
v_exp_f32 v250, v250
s_waitcnt lgkmcnt(0)
v_mfma_f32_16x16x32_bf16 v[144:147], v[184:187], a[48:51], v[144:147]
ds_read_b64_tr_b16 v[176:177], v231 offset:4096
v_mul_f32 v71, v55, v71
v_mfma_f32_16x16x32_bf16 v[148:151], v[184:187], a[52:55], v[148:151]
ds_read_b64_tr_b16 v[178:179], v231 offset:4608
v_fma_f32 v248, v248, v241, v241
v_mfma_f32_16x16x32_bf16 v[152:155], v[184:187], a[56:59], v[152:155]
ds_read_b64_tr_b16 v[180:181], v231 offset:16384
v_fma_f32 v249, v249, v241, v241
v_mfma_f32_16x16x32_bf16 v[156:159], v[184:187], a[60:63], v[156:159]
ds_read_b64_tr_b16 v[182:183], v231 offset:16896
v_fma_f32 v250, v250, v241, v241
v_mfma_f32_16x16x32_bf16 v[160:163], v[188:191], a[48:51], v[160:163]
s_add_u32 m0, s73, 24576
s_nop 0
global_load_lds_dwordx4 v224, s[4:5] offset:0
v_mfma_f32_16x16x32_bf16 v[164:167], v[188:191], a[52:55], v[164:167]
v_exp_f32 v251, v251
v_mfma_f32_16x16x32_bf16 v[168:171], v[188:191], a[56:59], v[168:171]
v_fma_f32 v251, v251, v241, v241
v_mul_f32 v244, v56, v238
v_mfma_f32_16x16x32_bf16 v[172:175], v[188:191], a[60:63], v[172:175]
v_rcp_f32 v248, v248
s_waitcnt lgkmcnt(0)
v_mfma_f32_16x16x32_bf16 v[112:115], v[176:179], a[64:67], v[112:115]
ds_read_b64_tr_b16 v[184:185], v234 offset:4096
v_mul_f32 v68, v68, v248
v_mfma_f32_16x16x32_bf16 v[116:119], v[176:179], a[68:71], v[116:119]
ds_read_b64_tr_b16 v[186:187], v234 offset:4608
v_mul_f32 v245, v57, v238
v_mfma_f32_16x16x32_bf16 v[120:123], v[176:179], a[72:75], v[120:123]
ds_read_b64_tr_b16 v[188:189], v234 offset:16384
v_mul_f32 v246, v58, v238
v_mfma_f32_16x16x32_bf16 v[124:127], v[176:179], a[76:79], v[124:127]
ds_read_b64_tr_b16 v[190:191], v234 offset:16896
v_mul_f32 v247, v59, v238
v_mfma_f32_16x16x32_bf16 v[128:131], v[180:183], a[64:67], v[128:131]
global_load_lds_dwordx4 v225, s[4:5] offset:1024
v_mfma_f32_16x16x32_bf16 v[132:135], v[180:183], a[68:71], v[132:135]
v_rcp_f32 v249, v249
v_mfma_f32_16x16x32_bf16 v[136:139], v[180:183], a[72:75], v[136:139]
v_rcp_f32 v250, v250
v_mfma_f32_16x16x32_bf16 v[140:143], v[180:183], a[76:79], v[140:143]
v_rcp_f32 v251, v251
s_waitcnt lgkmcnt(0)
v_mfma_f32_16x16x32_bf16 v[144:147], v[184:187], a[64:67], v[144:147]
ds_read_b64_tr_b16 v[176:177], v231 offset:8192
v_mul_f32 v69, v69, v249
v_mfma_f32_16x16x32_bf16 v[148:151], v[184:187], a[68:71], v[148:151]
ds_read_b64_tr_b16 v[178:179], v231 offset:8704
v_mul_f32 v70, v70, v250
v_mfma_f32_16x16x32_bf16 v[152:155], v[184:187], a[72:75], v[152:155]
ds_read_b64_tr_b16 v[180:181], v231 offset:20480
v_mul_f32 v71, v71, v251
v_mfma_f32_16x16x32_bf16 v[156:159], v[184:187], a[76:79], v[156:159]
ds_read_b64_tr_b16 v[182:183], v231 offset:20992
v_cvt_pk_bf16_f32 v194, v68, v69
v_mfma_f32_16x16x32_bf16 v[160:163], v[188:191], a[64:67], v[160:163]
global_load_lds_dwordx4 v226, s[4:5] offset:2048
v_mfma_f32_16x16x32_bf16 v[164:167], v[188:191], a[68:71], v[164:167]
global_load_lds_dwordx4 v227, s[4:5] offset:3072
v_mfma_f32_16x16x32_bf16 v[168:171], v[188:191], a[72:75], v[168:171]
v_cvt_pk_bf16_f32 v195, v70, v71
v_mul_f32 v72, v56, v72
v_mfma_f32_16x16x32_bf16 v[172:175], v[188:191], a[76:79], v[172:175]
v_exp_f32 v244, v244
s_waitcnt lgkmcnt(0)
v_mfma_f32_16x16x32_bf16 v[112:115], v[176:179], a[80:83], v[112:115]
ds_read_b64_tr_b16 v[184:185], v234 offset:8192
v_mul_f32 v73, v57, v73
v_mfma_f32_16x16x32_bf16 v[116:119], v[176:179], a[84:87], v[116:119]
ds_read_b64_tr_b16 v[186:187], v234 offset:8704
v_mul_f32 v74, v58, v74
v_mfma_f32_16x16x32_bf16 v[120:123], v[176:179], a[88:91], v[120:123]
ds_read_b64_tr_b16 v[188:189], v234 offset:20480
v_mul_f32 v75, v59, v75
v_mfma_f32_16x16x32_bf16 v[124:127], v[176:179], a[92:95], v[124:127]
ds_read_b64_tr_b16 v[190:191], v234 offset:20992
v_fma_f32 v244, v244, v242, v242
v_mfma_f32_16x16x32_bf16 v[128:131], v[180:183], a[80:83], v[128:131]
s_add_u32 m0, s73, 28672
v_mfma_f32_16x16x32_bf16 v[132:135], v[180:183], a[84:87], v[132:135]
v_exp_f32 v245, v245
v_mfma_f32_16x16x32_bf16 v[136:139], v[180:183], a[88:91], v[136:139]
v_exp_f32 v246, v246
v_mfma_f32_16x16x32_bf16 v[140:143], v[180:183], a[92:95], v[140:143]
v_exp_f32 v247, v247
s_waitcnt lgkmcnt(0)
s_waitcnt vmcnt(18)
s_barrier
v_mfma_f32_16x16x32_bf16 v[144:147], v[184:187], a[80:83], v[144:147]
ds_read_b64_tr_b16 v[176:177], v231 offset:24576
v_fma_f32 v245, v245, v242, v242
v_mfma_f32_16x16x32_bf16 v[148:151], v[184:187], a[84:87], v[148:151]
ds_read_b64_tr_b16 v[178:179], v231 offset:25088
v_fma_f32 v246, v246, v242, v242
v_mfma_f32_16x16x32_bf16 v[152:155], v[184:187], a[88:91], v[152:155]
ds_read_b64_tr_b16 v[180:181], v231 offset:36864
v_fma_f32 v247, v247, v242, v242
v_mfma_f32_16x16x32_bf16 v[156:159], v[184:187], a[92:95], v[156:159]
ds_read_b64_tr_b16 v[182:183], v231 offset:37376
v_mul_f32 v248, v60, v239
v_mfma_f32_16x16x32_bf16 v[160:163], v[188:191], a[80:83], v[160:163]
global_load_lds_dwordx4 v228, s[4:5] offset:0
v_mfma_f32_16x16x32_bf16 v[164:167], v[188:191], a[84:87], v[164:167]
global_load_lds_dwordx4 v229, s[4:5] offset:1024
v_mfma_f32_16x16x32_bf16 v[168:171], v[188:191], a[88:91], v[168:171]
v_rcp_f32 v244, v244
v_mfma_f32_16x16x32_bf16 v[172:175], v[188:191], a[92:95], v[172:175]
v_rcp_f32 v245, v245
s_waitcnt lgkmcnt(0)
v_mfma_f32_16x16x32_bf16 v[112:115], v[176:179], a[96:99], v[112:115]
ds_read_b64_tr_b16 v[184:185], v234 offset:24576
v_mul_f32 v72, v72, v244
v_mfma_f32_16x16x32_bf16 v[116:119], v[176:179], a[100:103], v[116:119]
ds_read_b64_tr_b16 v[186:187], v234 offset:25088
v_mul_f32 v73, v73, v245
v_mfma_f32_16x16x32_bf16 v[120:123], v[176:179], a[104:107], v[120:123]
ds_read_b64_tr_b16 v[188:189], v234 offset:36864
v_cvt_pk_bf16_f32 v196, v72, v73
v_mfma_f32_16x16x32_bf16 v[124:127], v[176:179], a[108:111], v[124:127]
ds_read_b64_tr_b16 v[190:191], v234 offset:37376
v_mul_f32 v249, v61, v239
v_mfma_f32_16x16x32_bf16 v[128:131], v[180:183], a[96:99], v[128:131]
s_add_u32 s4, s32, 384
s_addc_u32 s5, s33, 0
v_mfma_f32_16x16x32_bf16 v[132:135], v[180:183], a[100:103], v[132:135]
v_rcp_f32 v246, v246
v_mfma_f32_16x16x32_bf16 v[136:139], v[180:183], a[104:107], v[136:139]
v_rcp_f32 v247, v247
v_mfma_f32_16x16x32_bf16 v[140:143], v[180:183], a[108:111], v[140:143]
v_mul_f32 v74, v74, v246
v_mul_f32 v75, v75, v247
s_waitcnt lgkmcnt(0)
v_mfma_f32_16x16x32_bf16 v[144:147], v[184:187], a[96:99], v[144:147]
ds_read_b64_tr_b16 v[176:177], v231 offset:28672
v_cvt_pk_bf16_f32 v197, v74, v75
v_mfma_f32_16x16x32_bf16 v[148:151], v[184:187], a[100:103], v[148:151]
ds_read_b64_tr_b16 v[178:179], v231 offset:29184
v_mul_f32 v250, v62, v239
v_mfma_f32_16x16x32_bf16 v[152:155], v[184:187], a[104:107], v[152:155]
ds_read_b64_tr_b16 v[180:181], v231 offset:40960
v_mul_f32 v251, v63, v239
v_mfma_f32_16x16x32_bf16 v[156:159], v[184:187], a[108:111], v[156:159]
ds_read_b64_tr_b16 v[182:183], v231 offset:41472
v_mul_f32 v76, v60, v76
v_mfma_f32_16x16x32_bf16 v[160:163], v[188:191], a[96:99], v[160:163]
s_add_u32 m0, s73, 49152
s_nop 0
global_load_lds_dwordx4 v224, s[4:5] offset:0
v_mfma_f32_16x16x32_bf16 v[164:167], v[188:191], a[100:103], v[164:167]
v_exp_f32 v248, v248
v_mfma_f32_16x16x32_bf16 v[168:171], v[188:191], a[104:107], v[168:171]
v_exp_f32 v249, v249
v_mfma_f32_16x16x32_bf16 v[172:175], v[188:191], a[108:111], v[172:175]
v_mul_f32 v77, v61, v77
v_mul_f32 v78, v62, v78
s_waitcnt lgkmcnt(0)
v_mfma_f32_16x16x32_bf16 v[112:115], v[176:179], a[112:115], v[112:115]
ds_read_b64_tr_b16 v[184:185], v234 offset:28672
v_mul_f32 v79, v63, v79
v_mfma_f32_16x16x32_bf16 v[116:119], v[176:179], a[116:119], v[116:119]
ds_read_b64_tr_b16 v[186:187], v234 offset:29184
v_fma_f32 v248, v248, v243, v243
v_mfma_f32_16x16x32_bf16 v[120:123], v[176:179], a[120:123], v[120:123]
ds_read_b64_tr_b16 v[188:189], v234 offset:40960
v_fma_f32 v249, v249, v243, v243
v_mfma_f32_16x16x32_bf16 v[124:127], v[176:179], a[124:127], v[124:127]
ds_read_b64_tr_b16 v[190:191], v234 offset:41472
v_mfma_f32_16x16x32_bf16 v[128:131], v[180:183], a[112:115], v[128:131]
global_load_lds_dwordx4 v225, s[4:5] offset:1024
v_mfma_f32_16x16x32_bf16 v[132:135], v[180:183], a[116:119], v[132:135]
v_exp_f32 v250, v250
v_mfma_f32_16x16x32_bf16 v[136:139], v[180:183], a[120:123], v[136:139]
v_exp_f32 v251, v251
v_mfma_f32_16x16x32_bf16 v[140:143], v[180:183], a[124:127], v[140:143]
v_fma_f32 v250, v250, v243, v243
v_fma_f32 v251, v251, v243, v243
s_waitcnt lgkmcnt(0)
v_mfma_f32_16x16x32_bf16 v[144:147], v[184:187], a[112:115], v[144:147]
ds_read_b64_tr_b16 v[176:177], v231 offset:32768
v_mul_f32 v244, v80, v236
v_mfma_f32_16x16x32_bf16 v[148:151], v[184:187], a[116:119], v[148:151]
ds_read_b64_tr_b16 v[178:179], v231 offset:33280
v_mul_f32 v245, v81, v236
v_mfma_f32_16x16x32_bf16 v[152:155], v[184:187], a[120:123], v[152:155]
ds_read_b64_tr_b16 v[180:181], v231 offset:45056
v_mul_f32 v246, v82, v236
v_mfma_f32_16x16x32_bf16 v[156:159], v[184:187], a[124:127], v[156:159]
ds_read_b64_tr_b16 v[182:183], v231 offset:45568
v_mul_f32 v247, v83, v236
v_mfma_f32_16x16x32_bf16 v[160:163], v[188:191], a[112:115], v[160:163]
global_load_lds_dwordx4 v226, s[4:5] offset:2048
v_mfma_f32_16x16x32_bf16 v[164:167], v[188:191], a[116:119], v[164:167]
global_load_lds_dwordx4 v227, s[4:5] offset:3072
v_mfma_f32_16x16x32_bf16 v[168:171], v[188:191], a[120:123], v[168:171]
v_rcp_f32 v248, v248
v_mfma_f32_16x16x32_bf16 v[172:175], v[188:191], a[124:127], v[172:175]
v_rcp_f32 v249, v249
s_waitcnt lgkmcnt(0)
v_mfma_f32_16x16x32_bf16 v[112:115], v[176:179], a[128:131], v[112:115]
ds_read_b64_tr_b16 v[184:185], v234 offset:32768
v_mul_f32 v76, v76, v248
v_mfma_f32_16x16x32_bf16 v[116:119], v[176:179], a[132:135], v[116:119]
ds_read_b64_tr_b16 v[186:187], v234 offset:33280
v_mul_f32 v77, v77, v249
v_mfma_f32_16x16x32_bf16 v[120:123], v[176:179], a[136:139], v[120:123]
ds_read_b64_tr_b16 v[188:189], v234 offset:45056
v_cvt_pk_bf16_f32 v198, v76, v77
v_mfma_f32_16x16x32_bf16 v[124:127], v[176:179], a[140:143], v[124:127]
ds_read_b64_tr_b16 v[190:191], v234 offset:45568
v_mul_f32 v96, v80, v96
v_mfma_f32_16x16x32_bf16 v[128:131], v[180:183], a[128:131], v[128:131]
s_add_u32 m0, s73, 53248
v_mul_f32 v97, v81, v97
v_mfma_f32_16x16x32_bf16 v[132:135], v[180:183], a[132:135], v[132:135]
v_rcp_f32 v250, v250
v_mfma_f32_16x16x32_bf16 v[136:139], v[180:183], a[136:139], v[136:139]
v_rcp_f32 v251, v251
v_mfma_f32_16x16x32_bf16 v[140:143], v[180:183], a[140:143], v[140:143]
v_mul_f32 v78, v78, v250
v_mul_f32 v79, v79, v251
s_waitcnt lgkmcnt(0)
s_waitcnt vmcnt(18)
s_barrier
v_mfma_f32_16x16x32_bf16 v[144:147], v[184:187], a[128:131], v[144:147]
ds_read_b64_tr_b16 v[176:177], v232 offset:0
v_cvt_pk_bf16_f32 v199, v78, v79
v_mfma_f32_16x16x32_bf16 v[148:151], v[184:187], a[132:135], v[148:151]
ds_read_b64_tr_b16 v[178:179], v232 offset:512
v_mul_f32 v98, v82, v98
v_mfma_f32_16x16x32_bf16 v[152:155], v[184:187], a[136:139], v[152:155]
ds_read_b64_tr_b16 v[180:181], v232 offset:12288
v_mul_f32 v99, v83, v99
v_mfma_f32_16x16x32_bf16 v[156:159], v[184:187], a[140:143], v[156:159]
ds_read_b64_tr_b16 v[182:183], v232 offset:12800
v_mfma_f32_16x16x32_bf16 v[160:163], v[188:191], a[128:131], v[160:163]
global_load_lds_dwordx4 v228, s[4:5] offset:0
v_mfma_f32_16x16x32_bf16 v[164:167], v[188:191], a[132:135], v[164:167]
global_load_lds_dwordx4 v229, s[4:5] offset:1024
v_mfma_f32_16x16x32_bf16 v[168:171], v[188:191], a[136:139], v[168:171]
v_exp_f32 v244, v244
v_mfma_f32_16x16x32_bf16 v[172:175], v[188:191], a[140:143], v[172:175]
v_exp_f32 v245, v245
s_waitcnt lgkmcnt(0)
v_mfma_f32_16x16x32_bf16 v[112:115], v[176:179], a[144:147], v[112:115]
ds_read_b64_tr_b16 v[184:185], v235 offset:0
v_fma_f32 v244, v244, v240, v240
v_mfma_f32_16x16x32_bf16 v[116:119], v[176:179], a[148:151], v[116:119]
ds_read_b64_tr_b16 v[186:187], v235 offset:512
v_fma_f32 v245, v245, v240, v240
v_mfma_f32_16x16x32_bf16 v[120:123], v[176:179], a[152:155], v[120:123]
ds_read_b64_tr_b16 v[188:189], v235 offset:12288
v_mfma_f32_16x16x32_bf16 v[124:127], v[176:179], a[156:159], v[124:127]
ds_read_b64_tr_b16 v[190:191], v235 offset:12800
v_mfma_f32_16x16x32_bf16 v[128:131], v[180:183], a[144:147], v[128:131]
s_add_u32 s4, s32, 885120
s_addc_u32 s5, s33, 0
v_mfma_f32_16x16x32_bf16 v[132:135], v[180:183], a[148:151], v[132:135]
v_exp_f32 v246, v246
v_mfma_f32_16x16x32_bf16 v[136:139], v[180:183], a[152:155], v[136:139]
v_exp_f32 v247, v247
v_mfma_f32_16x16x32_bf16 v[140:143], v[180:183], a[156:159], v[140:143]
v_fma_f32 v246, v246, v240, v240
v_fma_f32 v247, v247, v240, v240
s_waitcnt lgkmcnt(0)
v_mfma_f32_16x16x32_bf16 v[144:147], v[184:187], a[144:147], v[144:147]
ds_read_b64_tr_b16 v[176:177], v232 offset:4096
v_mul_f32 v248, v84, v237
v_mfma_f32_16x16x32_bf16 v[148:151], v[184:187], a[148:151], v[148:151]
ds_read_b64_tr_b16 v[178:179], v232 offset:4608
v_mul_f32 v249, v85, v237
v_mfma_f32_16x16x32_bf16 v[152:155], v[184:187], a[152:155], v[152:155]
ds_read_b64_tr_b16 v[180:181], v232 offset:16384
v_mul_f32 v250, v86, v237
v_mfma_f32_16x16x32_bf16 v[156:159], v[184:187], a[156:159], v[156:159]
ds_read_b64_tr_b16 v[182:183], v232 offset:16896
v_mul_f32 v251, v87, v237
v_mfma_f32_16x16x32_bf16 v[160:163], v[188:191], a[144:147], v[160:163]
s_add_u32 m0, s73, 73728
s_nop 0
global_load_lds_dwordx4 v224, s[4:5] offset:0
v_mfma_f32_16x16x32_bf16 v[164:167], v[188:191], a[148:151], v[164:167]
v_rcp_f32 v244, v244
v_mfma_f32_16x16x32_bf16 v[168:171], v[188:191], a[152:155], v[168:171]
v_rcp_f32 v245, v245
v_mfma_f32_16x16x32_bf16 v[172:175], v[188:191], a[156:159], v[172:175]
v_rcp_f32 v246, v246
s_waitcnt lgkmcnt(0)
v_mfma_f32_16x16x32_bf16 v[112:115], v[176:179], a[160:163], v[112:115]
ds_read_b64_tr_b16 v[184:185], v235 offset:4096
v_mul_f32 v96, v96, v244
v_mfma_f32_16x16x32_bf16 v[116:119], v[176:179], a[164:167], v[116:119]
ds_read_b64_tr_b16 v[186:187], v235 offset:4608
v_mul_f32 v97, v97, v245
v_mfma_f32_16x16x32_bf16 v[120:123], v[176:179], a[168:171], v[120:123]
ds_read_b64_tr_b16 v[188:189], v235 offset:16384
v_mul_f32 v98, v98, v246
v_mfma_f32_16x16x32_bf16 v[124:127], v[176:179], a[172:175], v[124:127]
ds_read_b64_tr_b16 v[190:191], v235 offset:16896
v_cvt_pk_bf16_f32 v200, v96, v97
v_mfma_f32_16x16x32_bf16 v[128:131], v[180:183], a[160:163], v[128:131]
global_load_lds_dwordx4 v225, s[4:5] offset:1024
v_mfma_f32_16x16x32_bf16 v[132:135], v[180:183], a[164:167], v[132:135]
v_rcp_f32 v247, v247
v_mfma_f32_16x16x32_bf16 v[136:139], v[180:183], a[168:171], v[136:139]
v_mul_f32 v99, v99, v247
v_cvt_pk_bf16_f32 v201, v98, v99
v_mfma_f32_16x16x32_bf16 v[140:143], v[180:183], a[172:175], v[140:143]
v_exp_f32 v248, v248
s_waitcnt lgkmcnt(0)
v_mfma_f32_16x16x32_bf16 v[144:147], v[184:187], a[160:163], v[144:147]
ds_read_b64_tr_b16 v[176:177], v232 offset:8192
v_mul_f32 v100, v84, v100
v_mfma_f32_16x16x32_bf16 v[148:151], v[184:187], a[164:167], v[148:151]
ds_read_b64_tr_b16 v[178:179], v232 offset:8704
v_mul_f32 v101, v85, v101
v_mfma_f32_16x16x32_bf16 v[152:155], v[184:187], a[168:171], v[152:155]
ds_read_b64_tr_b16 v[180:181], v232 offset:20480
v_mul_f32 v102, v86, v102
v_mfma_f32_16x16x32_bf16 v[156:159], v[184:187], a[172:175], v[156:159]
ds_read_b64_tr_b16 v[182:183], v232 offset:20992
v_mul_f32 v103, v87, v103
v_mfma_f32_16x16x32_bf16 v[160:163], v[188:191], a[160:163], v[160:163]
global_load_lds_dwordx4 v226, s[4:5] offset:2048
v_mfma_f32_16x16x32_bf16 v[164:167], v[188:191], a[164:167], v[164:167]
global_load_lds_dwordx4 v227, s[4:5] offset:3072
v_mfma_f32_16x16x32_bf16 v[168:171], v[188:191], a[168:171], v[168:171]
v_exp_f32 v249, v249
v_mfma_f32_16x16x32_bf16 v[172:175], v[188:191], a[172:175], v[172:175]
v_exp_f32 v250, v250
s_waitcnt lgkmcnt(0)
v_mfma_f32_16x16x32_bf16 v[112:115], v[176:179], a[176:179], v[112:115]
ds_read_b64_tr_b16 v[184:185], v235 offset:8192
v_fma_f32 v248, v248, v241, v241
v_mfma_f32_16x16x32_bf16 v[116:119], v[176:179], a[180:183], v[116:119]
ds_read_b64_tr_b16 v[186:187], v235 offset:8704
v_fma_f32 v249, v249, v241, v241
v_mfma_f32_16x16x32_bf16 v[120:123], v[176:179], a[184:187], v[120:123]
ds_read_b64_tr_b16 v[188:189], v235 offset:20480
v_fma_f32 v250, v250, v241, v241
v_mfma_f32_16x16x32_bf16 v[124:127], v[176:179], a[188:191], v[124:127]
ds_read_b64_tr_b16 v[190:191], v235 offset:20992
v_mul_f32 v244, v88, v238
v_mfma_f32_16x16x32_bf16 v[128:131], v[180:183], a[176:179], v[128:131]
s_add_u32 m0, s73, 77824
v_mul_f32 v245, v89, v238
v_mfma_f32_16x16x32_bf16 v[132:135], v[180:183], a[180:183], v[132:135]
v_exp_f32 v251, v251
v_mfma_f32_16x16x32_bf16 v[136:139], v[180:183], a[184:187], v[136:139]
v_fma_f32 v251, v251, v241, v241
v_mul_f32 v246, v90, v238
v_mfma_f32_16x16x32_bf16 v[140:143], v[180:183], a[188:191], v[140:143]
v_rcp_f32 v248, v248
s_waitcnt lgkmcnt(0)
s_waitcnt vmcnt(16)
s_barrier
v_mfma_f32_16x16x32_bf16 v[144:147], v[184:187], a[176:179], v[144:147]
ds_read_b64_tr_b16 v[176:177], v230 offset:0
v_mul_f32 v100, v100, v248
v_mfma_f32_16x16x32_bf16 v[148:151], v[184:187], a[180:183], v[148:151]
ds_read_b64_tr_b16 v[178:179], v230 offset:512
v_mul_f32 v247, v91, v238
v_mfma_f32_16x16x32_bf16 v[152:155], v[184:187], a[184:187], v[152:155]
ds_read_b64_tr_b16 v[180:181], v230 offset:12288
v_mul_f32 v104, v88, v104
v_mfma_f32_16x16x32_bf16 v[156:159], v[184:187], a[188:191], v[156:159]
ds_read_b64_tr_b16 v[182:183], v230 offset:12800
v_mul_f32 v105, v89, v105
v_mfma_f32_16x16x32_bf16 v[160:163], v[188:191], a[176:179], v[160:163]
global_load_lds_dwordx4 v228, s[4:5] offset:0
v_mfma_f32_16x16x32_bf16 v[164:167], v[188:191], a[180:183], v[164:167]
global_load_lds_dwordx4 v229, s[4:5] offset:1024
v_mfma_f32_16x16x32_bf16 v[168:171], v[188:191], a[184:187], v[168:171]
v_rcp_f32 v249, v249
v_mfma_f32_16x16x32_bf16 v[172:175], v[188:191], a[188:191], v[172:175]
v_rcp_f32 v250, v250
s_waitcnt lgkmcnt(0)
v_mfma_f32_16x16x32_bf16 v[112:115], v[176:179], a[192:195], v[112:115]
ds_read_b64_tr_b16 v[184:185], v233 offset:0
v_mul_f32 v101, v101, v249
v_mfma_f32_16x16x32_bf16 v[116:119], v[176:179], a[196:199], v[116:119]
ds_read_b64_tr_b16 v[186:187], v233 offset:512
v_mul_f32 v102, v102, v250
v_mfma_f32_16x16x32_bf16 v[120:123], v[176:179], a[200:203], v[120:123]
ds_read_b64_tr_b16 v[188:189], v233 offset:12288
v_cvt_pk_bf16_f32 v202, v100, v101
v_mfma_f32_16x16x32_bf16 v[124:127], v[176:179], a[204:207], v[124:127]
ds_read_b64_tr_b16 v[190:191], v233 offset:12800
v_mul_f32 v106, v90, v106
v_mfma_f32_16x16x32_bf16 v[128:131], v[180:183], a[192:195], v[128:131]
s_add_u32 s4, s32, 1769856
s_addc_u32 s5, s33, 0
v_mfma_f32_16x16x32_bf16 v[132:135], v[180:183], a[196:199], v[132:135]
v_rcp_f32 v251, v251
v_mfma_f32_16x16x32_bf16 v[136:139], v[180:183], a[200:203], v[136:139]
v_mul_f32 v103, v103, v251
v_cvt_pk_bf16_f32 v203, v102, v103
v_mfma_f32_16x16x32_bf16 v[140:143], v[180:183], a[204:207], v[140:143]
v_exp_f32 v244, v244
s_waitcnt lgkmcnt(0)
v_mfma_f32_16x16x32_bf16 v[144:147], v[184:187], a[192:195], v[144:147]
ds_read_b64_tr_b16 v[176:177], v230 offset:4096
v_mul_f32 v107, v91, v107
v_mfma_f32_16x16x32_bf16 v[148:151], v[184:187], a[196:199], v[148:151]
ds_read_b64_tr_b16 v[178:179], v230 offset:4608
v_fma_f32 v244, v244, v242, v242
v_mfma_f32_16x16x32_bf16 v[152:155], v[184:187], a[200:203], v[152:155]
ds_read_b64_tr_b16 v[180:181], v230 offset:16384
v_mfma_f32_16x16x32_bf16 v[156:159], v[184:187], a[204:207], v[156:159]
ds_read_b64_tr_b16 v[182:183], v230 offset:16896
v_mfma_f32_16x16x32_bf16 v[160:163], v[188:191], a[192:195], v[160:163]
s_add_u32 m0, s73, 98304
s_nop 0
global_load_lds_dwordx4 v224, s[4:5] offset:0
v_mfma_f32_16x16x32_bf16 v[164:167], v[188:191], a[196:199], v[164:167]
v_exp_f32 v245, v245
v_mfma_f32_16x16x32_bf16 v[168:171], v[188:191], a[200:203], v[168:171]
v_exp_f32 v246, v246
v_mfma_f32_16x16x32_bf16 v[172:175], v[188:191], a[204:207], v[172:175]
v_exp_f32 v247, v247
s_waitcnt lgkmcnt(0)
v_mfma_f32_16x16x32_bf16 v[112:115], v[176:179], a[208:211], v[112:115]
ds_read_b64_tr_b16 v[184:185], v233 offset:4096
v_fma_f32 v245, v245, v242, v242
v_mfma_f32_16x16x32_bf16 v[116:119], v[176:179], a[212:215], v[116:119]
ds_read_b64_tr_b16 v[186:187], v233 offset:4608
v_fma_f32 v246, v246, v242, v242
v_mfma_f32_16x16x32_bf16 v[120:123], v[176:179], a[216:219], v[120:123]
ds_read_b64_tr_b16 v[188:189], v233 offset:16384
v_fma_f32 v247, v247, v242, v242
v_mfma_f32_16x16x32_bf16 v[124:127], v[176:179], a[220:223], v[124:127]
ds_read_b64_tr_b16 v[190:191], v233 offset:16896
v_mul_f32 v248, v92, v239
v_mfma_f32_16x16x32_bf16 v[128:131], v[180:183], a[208:211], v[128:131]
global_load_lds_dwordx4 v225, s[4:5] offset:1024
v_mfma_f32_16x16x32_bf16 v[132:135], v[180:183], a[212:215], v[132:135]
v_rcp_f32 v244, v244
v_mfma_f32_16x16x32_bf16 v[136:139], v[180:183], a[216:219], v[136:139]
v_rcp_f32 v245, v245
v_mfma_f32_16x16x32_bf16 v[140:143], v[180:183], a[220:223], v[140:143]
v_rcp_f32 v246, v246
s_waitcnt lgkmcnt(0)
v_mfma_f32_16x16x32_bf16 v[144:147], v[184:187], a[208:211], v[144:147]
ds_read_b64_tr_b16 v[176:177], v230 offset:8192
v_mul_f32 v104, v104, v244
v_mfma_f32_16x16x32_bf16 v[148:151], v[184:187], a[212:215], v[148:151]
ds_read_b64_tr_b16 v[178:179], v230 offset:8704
v_mul_f32 v105, v105, v245
v_mfma_f32_16x16x32_bf16 v[152:155], v[184:187], a[216:219], v[152:155]
ds_read_b64_tr_b16 v[180:181], v230 offset:20480
v_mul_f32 v106, v106, v246
v_mfma_f32_16x16x32_bf16 v[156:159], v[184:187], a[220:223], v[156:159]
ds_read_b64_tr_b16 v[182:183], v230 offset:20992
v_cvt_pk_bf16_f32 v204, v104, v105
v_mfma_f32_16x16x32_bf16 v[160:163], v[188:191], a[208:211], v[160:163]
global_load_lds_dwordx4 v226, s[4:5] offset:2048
v_mfma_f32_16x16x32_bf16 v[164:167], v[188:191], a[212:215], v[164:167]
global_load_lds_dwordx4 v227, s[4:5] offset:3072
v_mfma_f32_16x16x32_bf16 v[168:171], v[188:191], a[216:219], v[168:171]
v_rcp_f32 v247, v247
v_mfma_f32_16x16x32_bf16 v[172:175], v[188:191], a[220:223], v[172:175]
v_mul_f32 v107, v107, v247
v_cvt_pk_bf16_f32 v205, v106, v107
s_waitcnt lgkmcnt(0)
v_mfma_f32_16x16x32_bf16 v[112:115], v[176:179], a[224:227], v[112:115]
ds_read_b64_tr_b16 v[184:185], v233 offset:8192
v_mul_f32 v249, v93, v239
v_mfma_f32_16x16x32_bf16 v[116:119], v[176:179], a[228:231], v[116:119]
ds_read_b64_tr_b16 v[186:187], v233 offset:8704
v_mul_f32 v250, v94, v239
v_mfma_f32_16x16x32_bf16 v[120:123], v[176:179], a[232:235], v[120:123]
ds_read_b64_tr_b16 v[188:189], v233 offset:20480
v_mul_f32 v251, v95, v239
v_mfma_f32_16x16x32_bf16 v[124:127], v[176:179], a[236:239], v[124:127]
ds_read_b64_tr_b16 v[190:191], v233 offset:20992
v_mul_f32 v108, v92, v108
v_mfma_f32_16x16x32_bf16 v[128:131], v[180:183], a[224:227], v[128:131]
s_add_u32 m0, s73, 102400
v_mul_f32 v109, v93, v109
v_mfma_f32_16x16x32_bf16 v[132:135], v[180:183], a[228:231], v[132:135]
v_exp_f32 v248, v248
v_mfma_f32_16x16x32_bf16 v[136:139], v[180:183], a[232:235], v[136:139]
v_exp_f32 v249, v249
v_mfma_f32_16x16x32_bf16 v[140:143], v[180:183], a[236:239], v[140:143]
v_exp_f32 v250, v250
s_waitcnt lgkmcnt(0)
s_waitcnt vmcnt(16)
s_barrier
v_mfma_f32_16x16x32_bf16 v[144:147], v[184:187], a[224:227], v[144:147]
ds_read_b64_tr_b16 v[176:177], v230 offset:24576
v_mul_f32 v110, v94, v110
v_mfma_f32_16x16x32_bf16 v[148:151], v[184:187], a[228:231], v[148:151]
ds_read_b64_tr_b16 v[178:179], v230 offset:25088
v_mul_f32 v111, v95, v111
v_mfma_f32_16x16x32_bf16 v[152:155], v[184:187], a[232:235], v[152:155]
ds_read_b64_tr_b16 v[180:181], v230 offset:36864
v_fma_f32 v248, v248, v243, v243
v_mfma_f32_16x16x32_bf16 v[156:159], v[184:187], a[236:239], v[156:159]
ds_read_b64_tr_b16 v[182:183], v230 offset:37376
v_fma_f32 v249, v249, v243, v243
v_mfma_f32_16x16x32_bf16 v[160:163], v[188:191], a[224:227], v[160:163]
global_load_lds_dwordx4 v228, s[4:5] offset:0
v_mfma_f32_16x16x32_bf16 v[164:167], v[188:191], a[228:231], v[164:167]
global_load_lds_dwordx4 v229, s[4:5] offset:1024
v_mfma_f32_16x16x32_bf16 v[168:171], v[188:191], a[232:235], v[168:171]
v_exp_f32 v251, v251
v_mfma_f32_16x16x32_bf16 v[172:175], v[188:191], a[236:239], v[172:175]
v_fma_f32 v250, v250, v243, v243
v_fma_f32 v251, v251, v243, v243
s_waitcnt lgkmcnt(0)
v_mfma_f32_16x16x32_bf16 v[112:115], v[176:179], a[240:243], v[112:115]
ds_read_b64_tr_b16 v[184:185], v233 offset:24576
v_mfma_f32_16x16x32_bf16 v[116:119], v[176:179], a[244:247], v[116:119]
ds_read_b64_tr_b16 v[186:187], v233 offset:25088
v_mfma_f32_16x16x32_bf16 v[120:123], v[176:179], a[248:251], v[120:123]
ds_read_b64_tr_b16 v[188:189], v233 offset:36864
v_mfma_f32_16x16x32_bf16 v[124:127], v[176:179], a[252:255], v[124:127]
ds_read_b64_tr_b16 v[190:191], v233 offset:37376
v_mfma_f32_16x16x32_bf16 v[128:131], v[180:183], a[240:243], v[128:131]
s_add_u32 s4, s32, 2654592
s_addc_u32 s5, s33, 0
v_mfma_f32_16x16x32_bf16 v[132:135], v[180:183], a[244:247], v[132:135]
v_rcp_f32 v248, v248
v_mfma_f32_16x16x32_bf16 v[136:139], v[180:183], a[248:251], v[136:139]
v_rcp_f32 v249, v249
v_mfma_f32_16x16x32_bf16 v[140:143], v[180:183], a[252:255], v[140:143]
v_rcp_f32 v250, v250
s_waitcnt lgkmcnt(0)
v_mfma_f32_16x16x32_bf16 v[144:147], v[184:187], a[240:243], v[144:147]
ds_read_b64_tr_b16 v[176:177], v230 offset:28672
v_mul_f32 v108, v108, v248
v_mfma_f32_16x16x32_bf16 v[148:151], v[184:187], a[244:247], v[148:151]
ds_read_b64_tr_b16 v[178:179], v230 offset:29184
v_mul_f32 v109, v109, v249
v_mfma_f32_16x16x32_bf16 v[152:155], v[184:187], a[248:251], v[152:155]
ds_read_b64_tr_b16 v[180:181], v230 offset:40960
v_mul_f32 v110, v110, v250
v_mfma_f32_16x16x32_bf16 v[156:159], v[184:187], a[252:255], v[156:159]
ds_read_b64_tr_b16 v[182:183], v230 offset:41472
v_cvt_pk_bf16_f32 v206, v108, v109
v_mfma_f32_16x16x32_bf16 v[160:163], v[188:191], a[240:243], v[160:163]
s_add_u32 m0, s73, 0
s_nop 0
global_load_lds_dwordx4 v224, s[4:5] offset:0
v_mfma_f32_16x16x32_bf16 v[164:167], v[188:191], a[244:247], v[164:167]
v_rcp_f32 v251, v251
v_mfma_f32_16x16x32_bf16 v[168:171], v[188:191], a[248:251], v[168:171]
v_mul_f32 v111, v111, v251
v_cvt_pk_bf16_f32 v207, v110, v111
v_mfma_f32_16x16x32_bf16 v[172:175], v[188:191], a[252:255], v[172:175]
s_waitcnt lgkmcnt(0)
v_mfma_f32_16x16x32_bf16 v[112:115], v[176:179], v[16:19], v[112:115]
ds_read_b64_tr_b16 v[184:185], v233 offset:28672
v_mfma_f32_16x16x32_bf16 v[116:119], v[176:179], v[20:23], v[116:119]
ds_read_b64_tr_b16 v[186:187], v233 offset:29184
v_mfma_f32_16x16x32_bf16 v[120:123], v[176:179], v[24:27], v[120:123]
ds_read_b64_tr_b16 v[188:189], v233 offset:40960
v_mfma_f32_16x16x32_bf16 v[124:127], v[176:179], v[28:31], v[124:127]
ds_read_b64_tr_b16 v[190:191], v233 offset:41472
v_mfma_f32_16x16x32_bf16 v[128:131], v[180:183], v[16:19], v[128:131]
global_load_lds_dwordx4 v225, s[4:5] offset:1024
v_mfma_f32_16x16x32_bf16 v[132:135], v[180:183], v[20:23], v[132:135]
v_mfma_f32_16x16x32_bf16 v[136:139], v[180:183], v[24:27], v[136:139]
v_mfma_f32_16x16x32_bf16 v[140:143], v[180:183], v[28:31], v[140:143]
s_waitcnt lgkmcnt(0)
v_mfma_f32_16x16x32_bf16 v[144:147], v[184:187], v[16:19], v[144:147]
ds_read_b64_tr_b16 v[176:177], v230 offset:32768
v_mfma_f32_16x16x32_bf16 v[148:151], v[184:187], v[20:23], v[148:151]
ds_read_b64_tr_b16 v[178:179], v230 offset:33280
v_mfma_f32_16x16x32_bf16 v[152:155], v[184:187], v[24:27], v[152:155]
ds_read_b64_tr_b16 v[180:181], v230 offset:45056
v_mfma_f32_16x16x32_bf16 v[156:159], v[184:187], v[28:31], v[156:159]
ds_read_b64_tr_b16 v[182:183], v230 offset:45568
v_mfma_f32_16x16x32_bf16 v[160:163], v[188:191], v[16:19], v[160:163]
global_load_lds_dwordx4 v226, s[4:5] offset:2048
v_mfma_f32_16x16x32_bf16 v[164:167], v[188:191], v[20:23], v[164:167]
global_load_lds_dwordx4 v227, s[4:5] offset:3072
v_mfma_f32_16x16x32_bf16 v[168:171], v[188:191], v[24:27], v[168:171]
v_mfma_f32_16x16x32_bf16 v[172:175], v[188:191], v[28:31], v[172:175]
s_waitcnt lgkmcnt(0)
v_mfma_f32_16x16x32_bf16 v[112:115], v[176:179], v[32:35], v[112:115]
ds_read_b64_tr_b16 v[184:185], v233 offset:32768
v_mfma_f32_16x16x32_bf16 v[116:119], v[176:179], v[36:39], v[116:119]
ds_read_b64_tr_b16 v[186:187], v233 offset:33280
v_mfma_f32_16x16x32_bf16 v[120:123], v[176:179], v[40:43], v[120:123]
ds_read_b64_tr_b16 v[188:189], v233 offset:45056
v_mfma_f32_16x16x32_bf16 v[124:127], v[176:179], v[44:47], v[124:127]
ds_read_b64_tr_b16 v[190:191], v233 offset:45568
v_mfma_f32_16x16x32_bf16 v[128:131], v[180:183], v[32:35], v[128:131]
s_add_u32 m0, s73, 4096
v_mfma_f32_16x16x32_bf16 v[132:135], v[180:183], v[36:39], v[132:135]
v_mfma_f32_16x16x32_bf16 v[136:139], v[180:183], v[40:43], v[136:139]
v_mfma_f32_16x16x32_bf16 v[140:143], v[180:183], v[44:47], v[140:143]
s_waitcnt lgkmcnt(0)
s_waitcnt vmcnt(16)
s_barrier
v_mfma_f32_16x16x32_bf16 v[144:147], v[184:187], v[32:35], v[144:147]
ds_read_b64_tr_b16 v[176:177], v231 offset:0
v_mfma_f32_16x16x32_bf16 v[148:151], v[184:187], v[36:39], v[148:151]
ds_read_b64_tr_b16 v[178:179], v231 offset:512
v_mfma_f32_16x16x32_bf16 v[152:155], v[184:187], v[40:43], v[152:155]
ds_read_b64_tr_b16 v[180:181], v231 offset:12288
v_mfma_f32_16x16x32_bf16 v[156:159], v[184:187], v[44:47], v[156:159]
ds_read_b64_tr_b16 v[182:183], v231 offset:12800
v_mfma_f32_16x16x32_bf16 v[160:163], v[188:191], v[32:35], v[160:163]
global_load_lds_dwordx4 v228, s[4:5] offset:0
v_mfma_f32_16x16x32_bf16 v[164:167], v[188:191], v[36:39], v[164:167]
global_load_lds_dwordx4 v229, s[4:5] offset:1024
v_mfma_f32_16x16x32_bf16 v[168:171], v[188:191], v[40:43], v[168:171]
v_mfma_f32_16x16x32_bf16 v[172:175], v[188:191], v[44:47], v[172:175]
s_waitcnt lgkmcnt(0)
v_mfma_f32_16x16x32_bf16 v[48:51], v[176:179], a[0:3], 0
ds_read_b64_tr_b16 v[184:185], v234 offset:0
v_bfe_u32 v252, v1, 2, 2
v_mfma_f32_16x16x32_bf16 v[52:55], v[176:179], a[4:7], 0
ds_read_b64_tr_b16 v[186:187], v234 offset:512
v_and_b32 v253, 3, v1
v_mfma_f32_16x16x32_bf16 v[56:59], v[176:179], a[8:11], 0
ds_read_b64_tr_b16 v[188:189], v234 offset:12288
v_lshlrev_b32 v254, 3, v3
v_mfma_f32_16x16x32_bf16 v[60:63], v[176:179], a[12:15], 0
ds_read_b64_tr_b16 v[190:191], v234 offset:12800
v_add_u32 v254, v254, v252
v_mfma_f32_16x16x32_bf16 v[64:67], v[180:183], a[0:3], 0
s_add_u32 s4, s32, 3539328
s_addc_u32 s5, s33, 0
v_mfma_f32_16x16x32_bf16 v[68:71], v[180:183], a[4:7], 0
v_lshlrev_b32 v254, 6, v254
v_and_b32 v255, 1, v253
v_mfma_f32_16x16x32_bf16 v[72:75], v[180:183], a[8:11], 0
v_lshl_add_u32 v254, v255, 3, v254
v_lshrrev_b32 v253, 1, v253
v_mfma_f32_16x16x32_bf16 v[76:79], v[180:183], a[12:15], 0
s_lshl_b32 s3, s52, 1
v_add_u32 v253, s3, v253
s_waitcnt lgkmcnt(0)
v_mfma_f32_16x16x32_bf16 v[80:83], v[184:187], a[0:3], 0
ds_read_b64_tr_b16 v[176:177], v231 offset:4096
v_and_b32 v255, 1, v3
v_mfma_f32_16x16x32_bf16 v[84:87], v[184:187], a[4:7], 0
ds_read_b64_tr_b16 v[178:179], v231 offset:4608
v_lshlrev_b32 v255, 1, v255
v_mfma_f32_16x16x32_bf16 v[88:91], v[184:187], a[8:11], 0
ds_read_b64_tr_b16 v[180:181], v231 offset:16384
v_xor_b32 v253, v253, v255
v_mfma_f32_16x16x32_bf16 v[92:95], v[184:187], a[12:15], 0
ds_read_b64_tr_b16 v[182:183], v231 offset:16896
v_lshl_add_u32 v4, v253, 4, v254
v_mfma_f32_16x16x32_bf16 v[96:99], v[188:191], a[0:3], 0
s_add_u32 m0, s73, 24576
s_nop 0
global_load_lds_dwordx4 v224, s[4:5] offset:0
v_mfma_f32_16x16x32_bf16 v[100:103], v[188:191], a[4:7], 0
v_add_u32 v5, 49152, v4
v_add_u32 v6, 98304, v4
v_mfma_f32_16x16x32_bf16 v[104:107], v[188:191], a[8:11], 0
v_mul_f32 v244, v112, v236
v_mul_f32 v245, v113, v236
v_mfma_f32_16x16x32_bf16 v[108:111], v[188:191], a[12:15], 0
v_mul_f32 v246, v114, v236
v_mul_f32 v247, v115, v236
s_waitcnt lgkmcnt(0)
v_mfma_f32_16x16x32_bf16 v[48:51], v[176:179], a[16:19], v[48:51]
ds_read_b64_tr_b16 v[184:185], v234 offset:4096
v_mul_f32 v128, v112, v128
v_mfma_f32_16x16x32_bf16 v[52:55], v[176:179], a[20:23], v[52:55]
ds_read_b64_tr_b16 v[186:187], v234 offset:4608
v_mul_f32 v129, v113, v129
v_mfma_f32_16x16x32_bf16 v[56:59], v[176:179], a[24:27], v[56:59]
ds_read_b64_tr_b16 v[188:189], v234 offset:16384
v_mul_f32 v130, v114, v130
v_mfma_f32_16x16x32_bf16 v[60:63], v[176:179], a[28:31], v[60:63]
ds_read_b64_tr_b16 v[190:191], v234 offset:16896
v_mul_f32 v131, v115, v131
v_mfma_f32_16x16x32_bf16 v[64:67], v[180:183], a[16:19], v[64:67]
global_load_lds_dwordx4 v225, s[4:5] offset:1024
v_mfma_f32_16x16x32_bf16 v[68:71], v[180:183], a[20:23], v[68:71]
v_exp_f32 v244, v244
v_mfma_f32_16x16x32_bf16 v[72:75], v[180:183], a[24:27], v[72:75]
v_exp_f32 v245, v245
v_mfma_f32_16x16x32_bf16 v[76:79], v[180:183], a[28:31], v[76:79]
v_exp_f32 v246, v246
s_waitcnt lgkmcnt(0)
v_mfma_f32_16x16x32_bf16 v[80:83], v[184:187], a[16:19], v[80:83]
ds_read_b64_tr_b16 v[176:177], v231 offset:8192
v_fma_f32 v244, v244, v240, v240
v_mfma_f32_16x16x32_bf16 v[84:87], v[184:187], a[20:23], v[84:87]
ds_read_b64_tr_b16 v[178:179], v231 offset:8704
v_fma_f32 v245, v245, v240, v240
v_mfma_f32_16x16x32_bf16 v[88:91], v[184:187], a[24:27], v[88:91]
ds_read_b64_tr_b16 v[180:181], v231 offset:20480
v_fma_f32 v246, v246, v240, v240
v_mfma_f32_16x16x32_bf16 v[92:95], v[184:187], a[28:31], v[92:95]
ds_read_b64_tr_b16 v[182:183], v231 offset:20992
v_mul_f32 v248, v116, v237
v_mfma_f32_16x16x32_bf16 v[96:99], v[188:191], a[16:19], v[96:99]
global_load_lds_dwordx4 v226, s[4:5] offset:2048
v_mfma_f32_16x16x32_bf16 v[100:103], v[188:191], a[20:23], v[100:103]
global_load_lds_dwordx4 v227, s[4:5] offset:3072
v_mfma_f32_16x16x32_bf16 v[104:107], v[188:191], a[24:27], v[104:107]
v_exp_f32 v247, v247
v_mfma_f32_16x16x32_bf16 v[108:111], v[188:191], a[28:31], v[108:111]
v_fma_f32 v247, v247, v240, v240
v_mul_f32 v249, v117, v237
s_waitcnt lgkmcnt(0)
v_mfma_f32_16x16x32_bf16 v[48:51], v[176:179], a[32:35], v[48:51]
ds_read_b64_tr_b16 v[184:185], v234 offset:8192
v_mul_f32 v250, v118, v237
v_mfma_f32_16x16x32_bf16 v[52:55], v[176:179], a[36:39], v[52:55]
ds_read_b64_tr_b16 v[186:187], v234 offset:8704
v_mul_f32 v251, v119, v237
v_mfma_f32_16x16x32_bf16 v[56:59], v[176:179], a[40:43], v[56:59]
ds_read_b64_tr_b16 v[188:189], v234 offset:20480
v_mul_f32 v132, v116, v132
v_mfma_f32_16x16x32_bf16 v[60:63], v[176:179], a[44:47], v[60:63]
ds_read_b64_tr_b16 v[190:191], v234 offset:20992
v_mul_f32 v133, v117, v133
v_mfma_f32_16x16x32_bf16 v[64:67], v[180:183], a[32:35], v[64:67]
s_add_u32 m0, s73, 28672
v_mul_f32 v134, v118, v134
v_mfma_f32_16x16x32_bf16 v[68:71], v[180:183], a[36:39], v[68:71]
v_rcp_f32 v244, v244
v_mfma_f32_16x16x32_bf16 v[72:75], v[180:183], a[40:43], v[72:75]
v_rcp_f32 v245, v245
v_mfma_f32_16x16x32_bf16 v[76:79], v[180:183], a[44:47], v[76:79]
v_rcp_f32 v246, v246
s_waitcnt lgkmcnt(0)
s_waitcnt vmcnt(16)
s_barrier
v_mfma_f32_16x16x32_bf16 v[80:83], v[184:187], a[32:35], v[80:83]
ds_read_b64_tr_b16 v[176:177], v231 offset:24576
v_mul_f32 v128, v128, v244
v_mfma_f32_16x16x32_bf16 v[84:87], v[184:187], a[36:39], v[84:87]
ds_read_b64_tr_b16 v[178:179], v231 offset:25088
v_mul_f32 v129, v129, v245
v_mfma_f32_16x16x32_bf16 v[88:91], v[184:187], a[40:43], v[88:91]
ds_read_b64_tr_b16 v[180:181], v231 offset:36864
v_mul_f32 v130, v130, v246
v_mfma_f32_16x16x32_bf16 v[92:95], v[184:187], a[44:47], v[92:95]
ds_read_b64_tr_b16 v[182:183], v231 offset:37376
v_cvt_pk_bf16_f32 v208, v128, v129
v_mfma_f32_16x16x32_bf16 v[96:99], v[188:191], a[32:35], v[96:99]
global_load_lds_dwordx4 v228, s[4:5] offset:0
v_mfma_f32_16x16x32_bf16 v[100:103], v[188:191], a[36:39], v[100:103]
global_load_lds_dwordx4 v229, s[4:5] offset:1024
v_mfma_f32_16x16x32_bf16 v[104:107], v[188:191], a[40:43], v[104:107]
v_rcp_f32 v247, v247
v_mfma_f32_16x16x32_bf16 v[108:111], v[188:191], a[44:47], v[108:111]
v_mul_f32 v131, v131, v247
v_cvt_pk_bf16_f32 v209, v130, v131
s_waitcnt lgkmcnt(0)
v_mfma_f32_16x16x32_bf16 v[48:51], v[176:179], a[48:51], v[48:51]
ds_read_b64_tr_b16 v[184:185], v234 offset:24576
v_mul_f32 v135, v119, v135
v_mfma_f32_16x16x32_bf16 v[52:55], v[176:179], a[52:55], v[52:55]
ds_read_b64_tr_b16 v[186:187], v234 offset:25088
v_mfma_f32_16x16x32_bf16 v[56:59], v[176:179], a[56:59], v[56:59]
ds_read_b64_tr_b16 v[188:189], v234 offset:36864
v_mfma_f32_16x16x32_bf16 v[60:63], v[176:179], a[60:63], v[60:63]
ds_read_b64_tr_b16 v[190:191], v234 offset:37376
v_mfma_f32_16x16x32_bf16 v[64:67], v[180:183], a[48:51], v[64:67]
s_add_u32 s4, s32, 4424064
s_addc_u32 s5, s33, 0
v_mfma_f32_16x16x32_bf16 v[68:71], v[180:183], a[52:55], v[68:71]
v_exp_f32 v248, v248
v_mfma_f32_16x16x32_bf16 v[72:75], v[180:183], a[56:59], v[72:75]
v_exp_f32 v249, v249
v_mfma_f32_16x16x32_bf16 v[76:79], v[180:183], a[60:63], v[76:79]
v_exp_f32 v250, v250
s_waitcnt lgkmcnt(0)
v_mfma_f32_16x16x32_bf16 v[80:83], v[184:187], a[48:51], v[80:83]
ds_read_b64_tr_b16 v[176:177], v231 offset:28672
v_fma_f32 v248, v248, v241, v241
v_mfma_f32_16x16x32_bf16 v[84:87], v[184:187], a[52:55], v[84:87]
ds_read_b64_tr_b16 v[178:179], v231 offset:29184
v_fma_f32 v249, v249, v241, v241
v_mfma_f32_16x16x32_bf16 v[88:91], v[184:187], a[56:59], v[88:91]
ds_read_b64_tr_b16 v[180:181], v231 offset:40960
v_fma_f32 v250, v250, v241, v241
v_mfma_f32_16x16x32_bf16 v[92:95], v[184:187], a[60:63], v[92:95]
ds_read_b64_tr_b16 v[182:183], v231 offset:41472
v_mul_f32 v244, v120, v238
v_mfma_f32_16x16x32_bf16 v[96:99], v[188:191], a[48:51], v[96:99]
s_add_u32 m0, s73, 49152
s_nop 0
global_load_lds_dwordx4 v224, s[4:5] offset:0
v_mfma_f32_16x16x32_bf16 v[100:103], v[188:191], a[52:55], v[100:103]
v_exp_f32 v251, v251
v_mfma_f32_16x16x32_bf16 v[104:107], v[188:191], a[56:59], v[104:107]
v_fma_f32 v251, v251, v241, v241
v_mul_f32 v245, v121, v238
v_mfma_f32_16x16x32_bf16 v[108:111], v[188:191], a[60:63], v[108:111]
v_rcp_f32 v248, v248
s_waitcnt lgkmcnt(0)
v_mfma_f32_16x16x32_bf16 v[48:51], v[176:179], a[64:67], v[48:51]
ds_read_b64_tr_b16 v[184:185], v234 offset:28672
v_mul_f32 v132, v132, v248
v_mfma_f32_16x16x32_bf16 v[52:55], v[176:179], a[68:71], v[52:55]
ds_read_b64_tr_b16 v[186:187], v234 offset:29184
v_mul_f32 v246, v122, v238
v_mfma_f32_16x16x32_bf16 v[56:59], v[176:179], a[72:75], v[56:59]
ds_read_b64_tr_b16 v[188:189], v234 offset:40960
v_mul_f32 v247, v123, v238
v_mfma_f32_16x16x32_bf16 v[60:63], v[176:179], a[76:79], v[60:63]
ds_read_b64_tr_b16 v[190:191], v234 offset:41472
v_mul_f32 v136, v120, v136
v_mfma_f32_16x16x32_bf16 v[64:67], v[180:183], a[64:67], v[64:67]
global_load_lds_dwordx4 v225, s[4:5] offset:1024
v_mfma_f32_16x16x32_bf16 v[68:71], v[180:183], a[68:71], v[68:71]
v_rcp_f32 v249, v249
v_mfma_f32_16x16x32_bf16 v[72:75], v[180:183], a[72:75], v[72:75]
v_rcp_f32 v250, v250
v_mfma_f32_16x16x32_bf16 v[76:79], v[180:183], a[76:79], v[76:79]
v_rcp_f32 v251, v251
s_waitcnt lgkmcnt(0)
v_mfma_f32_16x16x32_bf16 v[80:83], v[184:187], a[64:67], v[80:83]
ds_read_b64_tr_b16 v[176:177], v231 offset:32768
v_mul_f32 v133, v133, v249
v_mfma_f32_16x16x32_bf16 v[84:87], v[184:187], a[68:71], v[84:87]
ds_read_b64_tr_b16 v[178:179], v231 offset:33280
v_mul_f32 v134, v134, v250
v_mfma_f32_16x16x32_bf16 v[88:91], v[184:187], a[72:75], v[88:91]
ds_read_b64_tr_b16 v[180:181], v231 offset:45056
v_mul_f32 v135, v135, v251
v_mfma_f32_16x16x32_bf16 v[92:95], v[184:187], a[76:79], v[92:95]
ds_read_b64_tr_b16 v[182:183], v231 offset:45568
v_cvt_pk_bf16_f32 v210, v132, v133
v_mfma_f32_16x16x32_bf16 v[96:99], v[188:191], a[64:67], v[96:99]
global_load_lds_dwordx4 v226, s[4:5] offset:2048
v_mfma_f32_16x16x32_bf16 v[100:103], v[188:191], a[68:71], v[100:103]
global_load_lds_dwordx4 v227, s[4:5] offset:3072
v_mfma_f32_16x16x32_bf16 v[104:107], v[188:191], a[72:75], v[104:107]
v_cvt_pk_bf16_f32 v211, v134, v135
v_mul_f32 v137, v121, v137
v_mfma_f32_16x16x32_bf16 v[108:111], v[188:191], a[76:79], v[108:111]
v_exp_f32 v244, v244
s_waitcnt lgkmcnt(0)
v_mfma_f32_16x16x32_bf16 v[48:51], v[176:179], a[80:83], v[48:51]
ds_read_b64_tr_b16 v[184:185], v234 offset:32768
v_mul_f32 v138, v122, v138
v_mfma_f32_16x16x32_bf16 v[52:55], v[176:179], a[84:87], v[52:55]
ds_read_b64_tr_b16 v[186:187], v234 offset:33280
v_mul_f32 v139, v123, v139
v_mfma_f32_16x16x32_bf16 v[56:59], v[176:179], a[88:91], v[56:59]
ds_read_b64_tr_b16 v[188:189], v234 offset:45056
v_fma_f32 v244, v244, v242, v242
v_mfma_f32_16x16x32_bf16 v[60:63], v[176:179], a[92:95], v[60:63]
ds_read_b64_tr_b16 v[190:191], v234 offset:45568
v_mfma_f32_16x16x32_bf16 v[64:67], v[180:183], a[80:83], v[64:67]
s_add_u32 m0, s73, 53248
v_mfma_f32_16x16x32_bf16 v[68:71], v[180:183], a[84:87], v[68:71]
v_exp_f32 v245, v245
v_mfma_f32_16x16x32_bf16 v[72:75], v[180:183], a[88:91], v[72:75]
v_exp_f32 v246, v246
v_mfma_f32_16x16x32_bf16 v[76:79], v[180:183], a[92:95], v[76:79]
v_exp_f32 v247, v247
s_waitcnt lgkmcnt(0)
s_waitcnt vmcnt(16)
s_barrier
v_mfma_f32_16x16x32_bf16 v[80:83], v[184:187], a[80:83], v[80:83]
ds_read_b64_tr_b16 v[176:177], v232 offset:0
v_fma_f32 v245, v245, v242, v242
v_mfma_f32_16x16x32_bf16 v[84:87], v[184:187], a[84:87], v[84:87]
ds_read_b64_tr_b16 v[178:179], v232 offset:512
v_fma_f32 v246, v246, v242, v242
v_mfma_f32_16x16x32_bf16 v[88:91], v[184:187], a[88:91], v[88:91]
ds_read_b64_tr_b16 v[180:181], v232 offset:12288
v_fma_f32 v247, v247, v242, v242
v_mfma_f32_16x16x32_bf16 v[92:95], v[184:187], a[92:95], v[92:95]
ds_read_b64_tr_b16 v[182:183], v232 offset:12800
v_mul_f32 v248, v124, v239
v_mfma_f32_16x16x32_bf16 v[96:99], v[188:191], a[80:83], v[96:99]
global_load_lds_dwordx4 v228, s[4:5] offset:0
v_mfma_f32_16x16x32_bf16 v[100:103], v[188:191], a[84:87], v[100:103]
global_load_lds_dwordx4 v229, s[4:5] offset:1024
v_mfma_f32_16x16x32_bf16 v[104:107], v[188:191], a[88:91], v[104:107]
v_rcp_f32 v244, v244
v_mfma_f32_16x16x32_bf16 v[108:111], v[188:191], a[92:95], v[108:111]
v_rcp_f32 v245, v245
s_waitcnt lgkmcnt(0)
v_mfma_f32_16x16x32_bf16 v[48:51], v[176:179], a[96:99], v[48:51]
ds_read_b64_tr_b16 v[184:185], v235 offset:0
v_mul_f32 v136, v136, v244
v_mfma_f32_16x16x32_bf16 v[52:55], v[176:179], a[100:103], v[52:55]
ds_read_b64_tr_b16 v[186:187], v235 offset:512
v_mul_f32 v137, v137, v245
v_mfma_f32_16x16x32_bf16 v[56:59], v[176:179], a[104:107], v[56:59]
ds_read_b64_tr_b16 v[188:189], v235 offset:12288
v_cvt_pk_bf16_f32 v212, v136, v137
v_mfma_f32_16x16x32_bf16 v[60:63], v[176:179], a[108:111], v[60:63]
ds_read_b64_tr_b16 v[190:191], v235 offset:12800
v_mul_f32 v249, v125, v239
v_mfma_f32_16x16x32_bf16 v[64:67], v[180:183], a[96:99], v[64:67]
s_and_b32 s94, s50, 1
s_mul_i32 s95, s94, 884736
v_mfma_f32_16x16x32_bf16 v[68:71], v[180:183], a[100:103], v[68:71]
v_lshrrev_b32 v8, 2, v1
v_and_b32 v9, 3, v1
v_mfma_f32_16x16x32_bf16 v[72:75], v[180:183], a[104:107], v[72:75]
v_rcp_f32 v246, v246
v_mfma_f32_16x16x32_bf16 v[76:79], v[180:183], a[108:111], v[76:79]
v_rcp_f32 v247, v247
s_waitcnt lgkmcnt(0)
v_mfma_f32_16x16x32_bf16 v[80:83], v[184:187], a[96:99], v[80:83]
ds_read_b64_tr_b16 v[176:177], v232 offset:4096
v_mul_f32 v138, v138, v246
v_mfma_f32_16x16x32_bf16 v[84:87], v[184:187], a[100:103], v[84:87]
ds_read_b64_tr_b16 v[178:179], v232 offset:4608
v_mul_f32 v139, v139, v247
v_mfma_f32_16x16x32_bf16 v[88:91], v[184:187], a[104:107], v[88:91]
ds_read_b64_tr_b16 v[180:181], v232 offset:16384
v_cvt_pk_bf16_f32 v213, v138, v139
v_mfma_f32_16x16x32_bf16 v[92:95], v[184:187], a[108:111], v[92:95]
ds_read_b64_tr_b16 v[182:183], v232 offset:16896
v_mul_f32 v250, v126, v239
v_mfma_f32_16x16x32_bf16 v[96:99], v[188:191], a[96:99], v[96:99]
v_lshrrev_b32 v10, 3, v8
v_lshlrev_b32 v10, 1, v10
v_mfma_f32_16x16x32_bf16 v[100:103], v[188:191], a[100:103], v[100:103]
v_xor_b32 v9, v9, v10
v_mul_u32_u24 v8, 9216, v8
v_mfma_f32_16x16x32_bf16 v[104:107], v[188:191], a[104:107], v[104:107]
v_mul_f32 v251, v127, v239
v_mul_f32 v140, v124, v140
v_mfma_f32_16x16x32_bf16 v[108:111], v[188:191], a[108:111], v[108:111]
v_exp_f32 v248, v248
s_waitcnt lgkmcnt(0)
v_mfma_f32_16x16x32_bf16 v[48:51], v[176:179], a[112:115], v[48:51]
ds_read_b64_tr_b16 v[184:185], v235 offset:4096
v_mul_f32 v141, v125, v141
v_mfma_f32_16x16x32_bf16 v[52:55], v[176:179], a[116:119], v[52:55]
ds_read_b64_tr_b16 v[186:187], v235 offset:4608
v_mul_f32 v142, v126, v142
v_mfma_f32_16x16x32_bf16 v[56:59], v[176:179], a[120:123], v[56:59]
ds_read_b64_tr_b16 v[188:189], v235 offset:16384
v_mul_f32 v143, v127, v143
v_mfma_f32_16x16x32_bf16 v[60:63], v[176:179], a[124:127], v[60:63]
ds_read_b64_tr_b16 v[190:191], v235 offset:16896
v_fma_f32 v248, v248, v243, v243
v_mfma_f32_16x16x32_bf16 v[64:67], v[180:183], a[112:115], v[64:67]
v_add_u32 v8, s95, v8
v_lshl_add_u32 v8, v9, 4, v8
v_mfma_f32_16x16x32_bf16 v[68:71], v[180:183], a[116:119], v[68:71]
v_add_u32 v224, 0, v8
v_add_u32 v225, 146432, v8
v_mfma_f32_16x16x32_bf16 v[72:75], v[180:183], a[120:123], v[72:75]
v_exp_f32 v249, v249
v_mfma_f32_16x16x32_bf16 v[76:79], v[180:183], a[124:127], v[76:79]
v_exp_f32 v250, v250
s_waitcnt lgkmcnt(0)
v_mfma_f32_16x16x32_bf16 v[80:83], v[184:187], a[112:115], v[80:83]
ds_read_b64_tr_b16 v[176:177], v232 offset:8192
v_fma_f32 v249, v249, v243, v243
v_mfma_f32_16x16x32_bf16 v[84:87], v[184:187], a[116:119], v[84:87]
ds_read_b64_tr_b16 v[178:179], v232 offset:8704
v_fma_f32 v250, v250, v243, v243
v_mfma_f32_16x16x32_bf16 v[88:91], v[184:187], a[120:123], v[88:91]
ds_read_b64_tr_b16 v[180:181], v232 offset:20480
v_mul_f32 v244, v144, v236
v_mfma_f32_16x16x32_bf16 v[92:95], v[184:187], a[124:127], v[92:95]
ds_read_b64_tr_b16 v[182:183], v232 offset:20992
v_mul_f32 v245, v145, v236
v_mfma_f32_16x16x32_bf16 v[96:99], v[188:191], a[112:115], v[96:99]
v_add_u32 v226, 292864, v8
v_add_u32 v227, 439296, v8
v_mfma_f32_16x16x32_bf16 v[100:103], v[188:191], a[116:119], v[100:103]
v_add_u32 v228, 589824, v8
v_add_u32 v229, 736256, v8
v_mfma_f32_16x16x32_bf16 v[104:107], v[188:191], a[120:123], v[104:107]
v_exp_f32 v251, v251
v_mfma_f32_16x16x32_bf16 v[108:111], v[188:191], a[124:127], v[108:111]
v_fma_f32 v251, v251, v243, v243
v_mul_f32 v246, v146, v236
s_waitcnt lgkmcnt(0)
v_mfma_f32_16x16x32_bf16 v[48:51], v[176:179], a[128:131], v[48:51]
ds_read_b64_tr_b16 v[184:185], v235 offset:8192
v_mul_f32 v247, v147, v236
v_mfma_f32_16x16x32_bf16 v[52:55], v[176:179], a[132:135], v[52:55]
ds_read_b64_tr_b16 v[186:187], v235 offset:8704
v_mul_f32 v160, v144, v160
v_mfma_f32_16x16x32_bf16 v[56:59], v[176:179], a[136:139], v[56:59]
ds_read_b64_tr_b16 v[188:189], v235 offset:20480
v_mul_f32 v161, v145, v161
v_mfma_f32_16x16x32_bf16 v[60:63], v[176:179], a[140:143], v[60:63]
ds_read_b64_tr_b16 v[190:191], v235 offset:20992
v_mul_f32 v162, v146, v162
v_mfma_f32_16x16x32_bf16 v[64:67], v[180:183], a[128:131], v[64:67]
s_add_u32 s4, s34, 0
s_addc_u32 s5, s35, 0
v_mfma_f32_16x16x32_bf16 v[68:71], v[180:183], a[132:135], v[68:71]
s_add_u32 m0, s73, 73728
s_nop 0
global_load_lds_dwordx4 v224, s[4:5] offset:0
v_mfma_f32_16x16x32_bf16 v[72:75], v[180:183], a[136:139], v[72:75]
global_load_lds_dwordx4 v225, s[4:5] offset:1024
v_mfma_f32_16x16x32_bf16 v[76:79], v[180:183], a[140:143], v[76:79]
v_rcp_f32 v248, v248
s_waitcnt lgkmcnt(0)
s_waitcnt vmcnt(14)
s_barrier
v_mfma_f32_16x16x32_bf16 v[80:83], v[184:187], a[128:131], v[80:83]
ds_read_b64_tr_b16 v[176:177], v230 offset:0
v_mul_f32 v140, v140, v248
v_mfma_f32_16x16x32_bf16 v[84:87], v[184:187], a[132:135], v[84:87]
ds_read_b64_tr_b16 v[178:179], v230 offset:512
v_mul_f32 v163, v147, v163
v_mfma_f32_16x16x32_bf16 v[88:91], v[184:187], a[136:139], v[88:91]
ds_read_b64_tr_b16 v[180:181], v230 offset:12288
v_mfma_f32_16x16x32_bf16 v[92:95], v[184:187], a[140:143], v[92:95]
ds_read_b64_tr_b16 v[182:183], v230 offset:12800
v_mfma_f32_16x16x32_bf16 v[96:99], v[188:191], a[128:131], v[96:99]
global_load_lds_dwordx4 v226, s[4:5] offset:2048
v_mfma_f32_16x16x32_bf16 v[100:103], v[188:191], a[132:135], v[100:103]
global_load_lds_dwordx4 v227, s[4:5] offset:3072
v_mfma_f32_16x16x32_bf16 v[104:107], v[188:191], a[136:139], v[104:107]
s_add_u32 m0, s73, 77824
s_nop 0
global_load_lds_dwordx4 v228, s[4:5] offset:0
v_mfma_f32_16x16x32_bf16 v[108:111], v[188:191], a[140:143], v[108:111]
global_load_lds_dwordx4 v229, s[4:5] offset:1024
s_waitcnt lgkmcnt(0)
v_mfma_f32_16x16x32_bf16 v[48:51], v[176:179], a[144:147], v[48:51]
ds_read_b64_tr_b16 v[184:185], v233 offset:0
v_mfma_f32_16x16x32_bf16 v[52:55], v[176:179], a[148:151], v[52:55]
ds_read_b64_tr_b16 v[186:187], v233 offset:512
v_mfma_f32_16x16x32_bf16 v[56:59], v[176:179], a[152:155], v[56:59]
ds_read_b64_tr_b16 v[188:189], v233 offset:12288
v_mfma_f32_16x16x32_bf16 v[60:63], v[176:179], a[156:159], v[60:63]
ds_read_b64_tr_b16 v[190:191], v233 offset:12800
v_mfma_f32_16x16x32_bf16 v[64:67], v[180:183], a[144:147], v[64:67]
s_add_u32 s4, s34, 1769472
s_addc_u32 s5, s35, 0
v_mfma_f32_16x16x32_bf16 v[68:71], v[180:183], a[148:151], v[68:71]
v_rcp_f32 v249, v249
v_mfma_f32_16x16x32_bf16 v[72:75], v[180:183], a[152:155], v[72:75]
v_rcp_f32 v250, v250
v_mfma_f32_16x16x32_bf16 v[76:79], v[180:183], a[156:159], v[76:79]
v_rcp_f32 v251, v251
s_waitcnt lgkmcnt(0)
v_mfma_f32_16x16x32_bf16 v[80:83], v[184:187], a[144:147], v[80:83]
ds_read_b64_tr_b16 v[176:177], v230 offset:4096
v_mul_f32 v141, v141, v249
v_mfma_f32_16x16x32_bf16 v[84:87], v[184:187], a[148:151], v[84:87]
ds_read_b64_tr_b16 v[178:179], v230 offset:4608
v_mul_f32 v142, v142, v250
v_mfma_f32_16x16x32_bf16 v[88:91], v[184:187], a[152:155], v[88:91]
ds_read_b64_tr_b16 v[180:181], v230 offset:16384
v_mul_f32 v143, v143, v251
v_mfma_f32_16x16x32_bf16 v[92:95], v[184:187], a[156:159], v[92:95]
ds_read_b64_tr_b16 v[182:183], v230 offset:16896
v_cvt_pk_bf16_f32 v214, v140, v141
v_mfma_f32_16x16x32_bf16 v[96:99], v[188:191], a[144:147], v[96:99]
s_add_u32 m0, s73, 98304
s_nop 0
global_load_lds_dwordx4 v224, s[4:5] offset:0
v_mfma_f32_16x16x32_bf16 v[100:103], v[188:191], a[148:151], v[100:103]
v_cvt_pk_bf16_f32 v215, v142, v143
v_mfma_f32_16x16x32_bf16 v[104:107], v[188:191], a[152:155], v[104:107]
v_exp_f32 v244, v244
v_mfma_f32_16x16x32_bf16 v[108:111], v[188:191], a[156:159], v[108:111]
v_exp_f32 v245, v245
s_waitcnt lgkmcnt(0)
v_mfma_f32_16x16x32_bf16 v[48:51], v[176:179], a[160:163], v[48:51]
ds_read_b64_tr_b16 v[184:185], v233 offset:4096
v_fma_f32 v244, v244, v240, v240
v_mfma_f32_16x16x32_bf16 v[52:55], v[176:179], a[164:167], v[52:55]
ds_read_b64_tr_b16 v[186:187], v233 offset:4608
v_fma_f32 v245, v245, v240, v240
v_mfma_f32_16x16x32_bf16 v[56:59], v[176:179], a[168:171], v[56:59]
ds_read_b64_tr_b16 v[188:189], v233 offset:16384
v_mfma_f32_16x16x32_bf16 v[60:63], v[176:179], a[172:175], v[60:63]
ds_read_b64_tr_b16 v[190:191], v233 offset:16896
v_mfma_f32_16x16x32_bf16 v[64:67], v[180:183], a[160:163], v[64:67]
global_load_lds_dwordx4 v225, s[4:5] offset:1024
v_mfma_f32_16x16x32_bf16 v[68:71], v[180:183], a[164:167], v[68:71]
v_exp_f32 v246, v246
v_mfma_f32_16x16x32_bf16 v[72:75], v[180:183], a[168:171], v[72:75]
v_exp_f32 v247, v247
v_mfma_f32_16x16x32_bf16 v[76:79], v[180:183], a[172:175], v[76:79]
v_fma_f32 v246, v246, v240, v240
v_fma_f32 v247, v247, v240, v240
s_waitcnt lgkmcnt(0)
v_mfma_f32_16x16x32_bf16 v[80:83], v[184:187], a[160:163], v[80:83]
ds_read_b64_tr_b16 v[176:177], v230 offset:8192
v_mul_f32 v248, v148, v237
v_mfma_f32_16x16x32_bf16 v[84:87], v[184:187], a[164:167], v[84:87]
ds_read_b64_tr_b16 v[178:179], v230 offset:8704
v_mul_f32 v249, v149, v237
v_mfma_f32_16x16x32_bf16 v[88:91], v[184:187], a[168:171], v[88:91]
ds_read_b64_tr_b16 v[180:181], v230 offset:20480
v_mul_f32 v250, v150, v237
v_mfma_f32_16x16x32_bf16 v[92:95], v[184:187], a[172:175], v[92:95]
ds_read_b64_tr_b16 v[182:183], v230 offset:20992
v_mul_f32 v251, v151, v237
v_mfma_f32_16x16x32_bf16 v[96:99], v[188:191], a[160:163], v[96:99]
global_load_lds_dwordx4 v226, s[4:5] offset:2048
v_mfma_f32_16x16x32_bf16 v[100:103], v[188:191], a[164:167], v[100:103]
global_load_lds_dwordx4 v227, s[4:5] offset:3072
v_mfma_f32_16x16x32_bf16 v[104:107], v[188:191], a[168:171], v[104:107]
v_rcp_f32 v244, v244
v_mfma_f32_16x16x32_bf16 v[108:111], v[188:191], a[172:175], v[108:111]
v_rcp_f32 v245, v245
s_waitcnt lgkmcnt(0)
v_mfma_f32_16x16x32_bf16 v[48:51], v[176:179], a[176:179], v[48:51]
ds_read_b64_tr_b16 v[184:185], v233 offset:8192
v_mul_f32 v160, v160, v244
v_mfma_f32_16x16x32_bf16 v[52:55], v[176:179], a[180:183], v[52:55]
ds_read_b64_tr_b16 v[186:187], v233 offset:8704
v_mul_f32 v161, v161, v245
v_mfma_f32_16x16x32_bf16 v[56:59], v[176:179], a[184:187], v[56:59]
ds_read_b64_tr_b16 v[188:189], v233 offset:20480
v_cvt_pk_bf16_f32 v216, v160, v161
v_mfma_f32_16x16x32_bf16 v[60:63], v[176:179], a[188:191], v[60:63]
ds_read_b64_tr_b16 v[190:191], v233 offset:20992
v_mul_f32 v164, v148, v164
v_mfma_f32_16x16x32_bf16 v[64:67], v[180:183], a[176:179], v[64:67]
s_add_u32 m0, s73, 102400
v_mul_f32 v165, v149, v165
v_mfma_f32_16x16x32_bf16 v[68:71], v[180:183], a[180:183], v[68:71]
v_rcp_f32 v246, v246
v_mfma_f32_16x16x32_bf16 v[72:75], v[180:183], a[184:187], v[72:75]
v_rcp_f32 v247, v247
v_mfma_f32_16x16x32_bf16 v[76:79], v[180:183], a[188:191], v[76:79]
v_mul_f32 v162, v162, v246
v_mul_f32 v163, v163, v247
s_waitcnt lgkmcnt(0)
s_waitcnt vmcnt(16)
s_barrier
v_mfma_f32_16x16x32_bf16 v[80:83], v[184:187], a[176:179], v[80:83]
ds_read_b64_tr_b16 v[176:177], v230 offset:24576
v_cvt_pk_bf16_f32 v217, v162, v163
v_mfma_f32_16x16x32_bf16 v[84:87], v[184:187], a[180:183], v[84:87]
ds_read_b64_tr_b16 v[178:179], v230 offset:25088
v_mul_f32 v166, v150, v166
v_mfma_f32_16x16x32_bf16 v[88:91], v[184:187], a[184:187], v[88:91]
ds_read_b64_tr_b16 v[180:181], v230 offset:36864
v_mul_f32 v167, v151, v167
v_mfma_f32_16x16x32_bf16 v[92:95], v[184:187], a[188:191], v[92:95]
ds_read_b64_tr_b16 v[182:183], v230 offset:37376
v_mfma_f32_16x16x32_bf16 v[96:99], v[188:191], a[176:179], v[96:99]
global_load_lds_dwordx4 v228, s[4:5] offset:0
v_mfma_f32_16x16x32_bf16 v[100:103], v[188:191], a[180:183], v[100:103]
global_load_lds_dwordx4 v229, s[4:5] offset:1024
v_mfma_f32_16x16x32_bf16 v[104:107], v[188:191], a[184:187], v[104:107]
v_exp_f32 v248, v248
v_mfma_f32_16x16x32_bf16 v[108:111], v[188:191], a[188:191], v[108:111]
v_exp_f32 v249, v249
s_waitcnt lgkmcnt(0)
v_mfma_f32_16x16x32_bf16 v[48:51], v[176:179], a[192:195], v[48:51]
ds_read_b64_tr_b16 v[184:185], v233 offset:24576
v_fma_f32 v248, v248, v241, v241
v_mfma_f32_16x16x32_bf16 v[52:55], v[176:179], a[196:199], v[52:55]
ds_read_b64_tr_b16 v[186:187], v233 offset:25088
v_fma_f32 v249, v249, v241, v241
v_mfma_f32_16x16x32_bf16 v[56:59], v[176:179], a[200:203], v[56:59]
ds_read_b64_tr_b16 v[188:189], v233 offset:36864
v_mfma_f32_16x16x32_bf16 v[60:63], v[176:179], a[204:207], v[60:63]
ds_read_b64_tr_b16 v[190:191], v233 offset:37376
v_mfma_f32_16x16x32_bf16 v[64:67], v[180:183], a[192:195], v[64:67]
s_add_u32 s4, s34, 3538944
s_addc_u32 s5, s35, 0
v_mfma_f32_16x16x32_bf16 v[68:71], v[180:183], a[196:199], v[68:71]
v_exp_f32 v250, v250
v_mfma_f32_16x16x32_bf16 v[72:75], v[180:183], a[200:203], v[72:75]
v_exp_f32 v251, v251
v_mfma_f32_16x16x32_bf16 v[76:79], v[180:183], a[204:207], v[76:79]
v_fma_f32 v250, v250, v241, v241
v_fma_f32 v251, v251, v241, v241
s_waitcnt lgkmcnt(0)
v_mfma_f32_16x16x32_bf16 v[80:83], v[184:187], a[192:195], v[80:83]
ds_read_b64_tr_b16 v[176:177], v230 offset:28672
v_mul_f32 v244, v152, v238
v_mfma_f32_16x16x32_bf16 v[84:87], v[184:187], a[196:199], v[84:87]
ds_read_b64_tr_b16 v[178:179], v230 offset:29184
v_mul_f32 v245, v153, v238
v_mfma_f32_16x16x32_bf16 v[88:91], v[184:187], a[200:203], v[88:91]
ds_read_b64_tr_b16 v[180:181], v230 offset:40960
v_mul_f32 v246, v154, v238
v_mfma_f32_16x16x32_bf16 v[92:95], v[184:187], a[204:207], v[92:95]
ds_read_b64_tr_b16 v[182:183], v230 offset:41472
v_mul_f32 v247, v155, v238
v_mfma_f32_16x16x32_bf16 v[96:99], v[188:191], a[192:195], v[96:99]
s_add_u32 m0, s73, 0
s_nop 0
global_load_lds_dwordx4 v224, s[4:5] offset:0
v_mfma_f32_16x16x32_bf16 v[100:103], v[188:191], a[196:199], v[100:103]
v_rcp_f32 v248, v248
v_mfma_f32_16x16x32_bf16 v[104:107], v[188:191], a[200:203], v[104:107]
v_rcp_f32 v249, v249
v_mfma_f32_16x16x32_bf16 v[108:111], v[188:191], a[204:207], v[108:111]
v_rcp_f32 v250, v250
s_waitcnt lgkmcnt(0)
v_mfma_f32_16x16x32_bf16 v[48:51], v[176:179], a[208:211], v[48:51]
ds_read_b64_tr_b16 v[184:185], v233 offset:28672
v_mul_f32 v164, v164, v248
v_mfma_f32_16x16x32_bf16 v[52:55], v[176:179], a[212:215], v[52:55]
ds_read_b64_tr_b16 v[186:187], v233 offset:29184
v_mul_f32 v165, v165, v249
v_mfma_f32_16x16x32_bf16 v[56:59], v[176:179], a[216:219], v[56:59]
ds_read_b64_tr_b16 v[188:189], v233 offset:40960
v_mul_f32 v166, v166, v250
v_mfma_f32_16x16x32_bf16 v[60:63], v[176:179], a[220:223], v[60:63]
ds_read_b64_tr_b16 v[190:191], v233 offset:41472
v_cvt_pk_bf16_f32 v218, v164, v165
v_mfma_f32_16x16x32_bf16 v[64:67], v[180:183], a[208:211], v[64:67]
global_load_lds_dwordx4 v225, s[4:5] offset:1024
v_mfma_f32_16x16x32_bf16 v[68:71], v[180:183], a[212:215], v[68:71]
v_rcp_f32 v251, v251
v_mfma_f32_16x16x32_bf16 v[72:75], v[180:183], a[216:219], v[72:75]
v_mul_f32 v167, v167, v251
v_cvt_pk_bf16_f32 v219, v166, v167
v_mfma_f32_16x16x32_bf16 v[76:79], v[180:183], a[220:223], v[76:79]
v_exp_f32 v244, v244
s_waitcnt lgkmcnt(0)
v_mfma_f32_16x16x32_bf16 v[80:83], v[184:187], a[208:211], v[80:83]
ds_read_b64_tr_b16 v[176:177], v230 offset:32768
v_mul_f32 v168, v152, v168
v_mfma_f32_16x16x32_bf16 v[84:87], v[184:187], a[212:215], v[84:87]
ds_read_b64_tr_b16 v[178:179], v230 offset:33280
v_mul_f32 v169, v153, v169
v_mfma_f32_16x16x32_bf16 v[88:91], v[184:187], a[216:219], v[88:91]
ds_read_b64_tr_b16 v[180:181], v230 offset:45056
v_mul_f32 v170, v154, v170
v_mfma_f32_16x16x32_bf16 v[92:95], v[184:187], a[220:223], v[92:95]
ds_read_b64_tr_b16 v[182:183], v230 offset:45568
v_mul_f32 v171, v155, v171
v_mfma_f32_16x16x32_bf16 v[96:99], v[188:191], a[208:211], v[96:99]
global_load_lds_dwordx4 v226, s[4:5] offset:2048
v_mfma_f32_16x16x32_bf16 v[100:103], v[188:191], a[212:215], v[100:103]
global_load_lds_dwordx4 v227, s[4:5] offset:3072
v_mfma_f32_16x16x32_bf16 v[104:107], v[188:191], a[216:219], v[104:107]
v_exp_f32 v245, v245
v_mfma_f32_16x16x32_bf16 v[108:111], v[188:191], a[220:223], v[108:111]
v_exp_f32 v246, v246
s_waitcnt lgkmcnt(0)
v_mfma_f32_16x16x32_bf16 v[48:51], v[176:179], a[224:227], v[48:51]
ds_read_b64_tr_b16 v[184:185], v233 offset:32768
v_fma_f32 v244, v244, v242, v242
v_mfma_f32_16x16x32_bf16 v[52:55], v[176:179], a[228:231], v[52:55]
ds_read_b64_tr_b16 v[186:187], v233 offset:33280
v_fma_f32 v245, v245, v242, v242
v_mfma_f32_16x16x32_bf16 v[56:59], v[176:179], a[232:235], v[56:59]
ds_read_b64_tr_b16 v[188:189], v233 offset:45056
v_fma_f32 v246, v246, v242, v242
v_mfma_f32_16x16x32_bf16 v[60:63], v[176:179], a[236:239], v[60:63]
ds_read_b64_tr_b16 v[190:191], v233 offset:45568
v_mul_f32 v248, v156, v239
v_mfma_f32_16x16x32_bf16 v[64:67], v[180:183], a[224:227], v[64:67]
s_add_u32 m0, s73, 4096
v_mul_f32 v249, v157, v239
v_mfma_f32_16x16x32_bf16 v[68:71], v[180:183], a[228:231], v[68:71]
v_exp_f32 v247, v247
v_mfma_f32_16x16x32_bf16 v[72:75], v[180:183], a[232:235], v[72:75]
v_fma_f32 v247, v247, v242, v242
v_mul_f32 v250, v158, v239
v_mfma_f32_16x16x32_bf16 v[76:79], v[180:183], a[236:239], v[76:79]
v_rcp_f32 v244, v244
s_waitcnt lgkmcnt(0)
s_waitcnt vmcnt(16)
s_barrier
v_mfma_f32_16x16x32_bf16 v[80:83], v[184:187], a[224:227], v[80:83]
ds_read_b64_tr_b16 v[176:177], v231 offset:0
v_mul_f32 v168, v168, v244
v_mfma_f32_16x16x32_bf16 v[84:87], v[184:187], a[228:231], v[84:87]
ds_read_b64_tr_b16 v[178:179], v231 offset:512
v_mul_f32 v251, v159, v239
v_mfma_f32_16x16x32_bf16 v[88:91], v[184:187], a[232:235], v[88:91]
ds_read_b64_tr_b16 v[180:181], v231 offset:12288
v_mul_f32 v172, v156, v172
v_mfma_f32_16x16x32_bf16 v[92:95], v[184:187], a[236:239], v[92:95]
ds_read_b64_tr_b16 v[182:183], v231 offset:12800
v_mul_f32 v173, v157, v173
v_mfma_f32_16x16x32_bf16 v[96:99], v[188:191], a[224:227], v[96:99]
global_load_lds_dwordx4 v228, s[4:5] offset:0
v_mfma_f32_16x16x32_bf16 v[100:103], v[188:191], a[228:231], v[100:103]
global_load_lds_dwordx4 v229, s[4:5] offset:1024
v_mfma_f32_16x16x32_bf16 v[104:107], v[188:191], a[232:235], v[104:107]
v_rcp_f32 v245, v245
v_mfma_f32_16x16x32_bf16 v[108:111], v[188:191], a[236:239], v[108:111]
v_rcp_f32 v246, v246
s_waitcnt lgkmcnt(0)
v_mfma_f32_16x16x32_bf16 v[48:51], v[176:179], a[240:243], v[48:51]
ds_read_b64_tr_b16 v[184:185], v234 offset:0
v_mul_f32 v169, v169, v245
v_mfma_f32_16x16x32_bf16 v[52:55], v[176:179], a[244:247], v[52:55]
ds_read_b64_tr_b16 v[186:187], v234 offset:512
v_mul_f32 v170, v170, v246
v_mfma_f32_16x16x32_bf16 v[56:59], v[176:179], a[248:251], v[56:59]
ds_read_b64_tr_b16 v[188:189], v234 offset:12288
v_cvt_pk_bf16_f32 v220, v168, v169
v_mfma_f32_16x16x32_bf16 v[60:63], v[176:179], a[252:255], v[60:63]
ds_read_b64_tr_b16 v[190:191], v234 offset:12800
v_mul_f32 v174, v158, v174
v_mfma_f32_16x16x32_bf16 v[64:67], v[180:183], a[240:243], v[64:67]
s_lshl_b32 s73, s50, 10
v_lshrrev_b32 v8, 3, v1
v_mfma_f32_16x16x32_bf16 v[68:71], v[180:183], a[244:247], v[68:71]
v_and_b32 v9, 7, v1
v_and_b32 v10, 6, v8
v_mfma_f32_16x16x32_bf16 v[72:75], v[180:183], a[248:251], v[72:75]
v_xor_b32 v9, v9, v10
v_mul_u32_u24 v10, 1152, v8
v_mfma_f32_16x16x32_bf16 v[76:79], v[180:183], a[252:255], v[76:79]
v_lshl_add_u32 v224, v9, 4, v10
s_cmp_lt_u32 s50, 2
s_cselect_b32 s94, 8, 2
s_waitcnt lgkmcnt(0)
v_mfma_f32_16x16x32_bf16 v[80:83], v[184:187], a[240:243], v[80:83]
ds_read_b64_tr_b16 v[176:177], v231 offset:4096
v_mul_f32 v175, v159, v175
v_mfma_f32_16x16x32_bf16 v[84:87], v[184:187], a[244:247], v[84:87]
ds_read_b64_tr_b16 v[178:179], v231 offset:4608
v_mfma_f32_16x16x32_bf16 v[88:91], v[184:187], a[248:251], v[88:91]
ds_read_b64_tr_b16 v[180:181], v231 offset:16384
v_mfma_f32_16x16x32_bf16 v[92:95], v[184:187], a[252:255], v[92:95]
ds_read_b64_tr_b16 v[182:183], v231 offset:16896
v_mfma_f32_16x16x32_bf16 v[96:99], v[188:191], a[240:243], v[96:99]
s_cmp_eq_u32 s50, 3
s_cselect_b32 s94, 0, s94
v_mfma_f32_16x16x32_bf16 v[100:103], v[188:191], a[244:247], v[100:103]
v_mov_b32 v10, 0x40000000
v_cmp_gt_u32 vcc, s94, v8
s_nop 1
v_cndmask_b32 v225, v10, v224, vcc
v_mfma_f32_16x16x32_bf16 v[104:107], v[188:191], a[248:251], v[104:107]
s_lshr_b32 s94, s50, 1
s_and_b32 s95, s50, 1
v_mfma_f32_16x16x32_bf16 v[108:111], v[188:191], a[252:255], v[108:111]
s_lshl_b32 s95, s95, 3
s_lshl_b32 s96, s94, 5
s_waitcnt lgkmcnt(0)
v_mfma_f32_16x16x32_bf16 v[48:51], v[176:179], v[16:19], v[48:51]
ds_read_b64_tr_b16 v[184:185], v234 offset:4096
v_mfma_f32_16x16x32_bf16 v[52:55], v[176:179], v[20:23], v[52:55]
ds_read_b64_tr_b16 v[186:187], v234 offset:4608
v_mfma_f32_16x16x32_bf16 v[56:59], v[176:179], v[24:27], v[56:59]
ds_read_b64_tr_b16 v[188:189], v234 offset:16384
v_mfma_f32_16x16x32_bf16 v[60:63], v[176:179], v[28:31], v[60:63]
ds_read_b64_tr_b16 v[190:191], v234 offset:16896
v_mfma_f32_16x16x32_bf16 v[64:67], v[180:183], v[16:19], v[64:67]
s_add_u32 s96, s96, s95
s_lshr_b32 s97, s74, 1
v_mfma_f32_16x16x32_bf16 v[68:71], v[180:183], v[20:23], v[68:71]
s_add_u32 s96, s96, s97
s_mul_i32 s96, s96, 1152
v_mfma_f32_16x16x32_bf16 v[72:75], v[180:183], v[24:27], v[72:75]
s_add_u32 s60, s96, 0
s_add_u32 s61, s96, 18432
v_mfma_f32_16x16x32_bf16 v[76:79], v[180:183], v[28:31], v[76:79]
s_add_u32 s62, s96, 73728
s_add_u32 s63, s96, 92160
s_waitcnt lgkmcnt(0)
v_mfma_f32_16x16x32_bf16 v[80:83], v[184:187], v[16:19], v[80:83]
ds_read_b64_tr_b16 v[176:177], v231 offset:8192
v_mfma_f32_16x16x32_bf16 v[84:87], v[184:187], v[20:23], v[84:87]
ds_read_b64_tr_b16 v[178:179], v231 offset:8704
v_mfma_f32_16x16x32_bf16 v[88:91], v[184:187], v[24:27], v[88:91]
ds_read_b64_tr_b16 v[180:181], v231 offset:20480
v_mfma_f32_16x16x32_bf16 v[92:95], v[184:187], v[28:31], v[92:95]
ds_read_b64_tr_b16 v[182:183], v231 offset:20992
v_mfma_f32_16x16x32_bf16 v[96:99], v[188:191], v[16:19], v[96:99]
s_add_u32 s64, s96, 147456
s_add_u32 s65, s96, 165888
v_mfma_f32_16x16x32_bf16 v[100:103], v[188:191], v[20:23], v[100:103]
s_add_u32 s66, s96, 221184
s_add_u32 s67, s96, 239616
v_mfma_f32_16x16x32_bf16 v[104:107], v[188:191], v[24:27], v[104:107]
s_lshl_b32 s96, s94, 4
s_add_u32 s96, s96, s95
v_mfma_f32_16x16x32_bf16 v[108:111], v[188:191], v[28:31], v[108:111]
s_lshr_b32 s97, s75, 1
s_add_u32 s97, s96, s97
s_waitcnt lgkmcnt(0)
v_mfma_f32_16x16x32_bf16 v[48:51], v[176:179], v[32:35], v[48:51]
ds_read_b64_tr_b16 v[184:185], v234 offset:8192
v_mfma_f32_16x16x32_bf16 v[52:55], v[176:179], v[36:39], v[52:55]
ds_read_b64_tr_b16 v[186:187], v234 offset:8704
v_mfma_f32_16x16x32_bf16 v[56:59], v[176:179], v[40:43], v[56:59]
ds_read_b64_tr_b16 v[188:189], v234 offset:20480
v_mfma_f32_16x16x32_bf16 v[60:63], v[176:179], v[44:47], v[60:63]
ds_read_b64_tr_b16 v[190:191], v234 offset:20992
v_mfma_f32_16x16x32_bf16 v[64:67], v[180:183], v[32:35], v[64:67]
s_mul_i32 s68, s97, 1152
s_mul_i32 s97, s54, 36
v_mfma_f32_16x16x32_bf16 v[68:71], v[180:183], v[36:39], v[68:71]
s_add_u32 s96, s96, s97
s_mul_i32 s69, s96, 1152
v_mfma_f32_16x16x32_bf16 v[72:75], v[180:183], v[40:43], v[72:75]
s_add_u32 s70, s69, 20736
v_add_u32 v226, s60, v224
v_mfma_f32_16x16x32_bf16 v[76:79], v[180:183], v[44:47], v[76:79]
s_add_u32 m0, s73, 24576
s_nop 0
global_load_lds_dwordx4 v226, s[42:43]
s_waitcnt lgkmcnt(0)
s_waitcnt vmcnt(13)
s_barrier
v_mfma_f32_16x16x32_bf16 v[80:83], v[184:187], v[32:35], v[80:83]
ds_read_b64_tr_b16 v[176:177], v5 offset:24576
v_mfma_f32_16x16x32_bf16 v[84:87], v[184:187], v[36:39], v[84:87]
ds_read_b64_tr_b16 v[178:179], v5 offset:24832
v_mfma_f32_16x16x32_bf16 v[88:91], v[184:187], v[40:43], v[88:91]
ds_read_b64_tr_b16 v[180:181], v5 offset:36864
v_mfma_f32_16x16x32_bf16 v[92:95], v[184:187], v[44:47], v[92:95]
ds_read_b64_tr_b16 v[182:183], v5 offset:37120
v_mfma_f32_16x16x32_bf16 v[96:99], v[188:191], v[32:35], v[96:99]
v_add_u32 v227, s61, v224
s_add_u32 m0, s73, 28672
v_mfma_f32_16x16x32_bf16 v[100:103], v[188:191], v[36:39], v[100:103]
global_load_lds_dwordx4 v227, s[42:43]
v_mfma_f32_16x16x32_bf16 v[104:107], v[188:191], v[40:43], v[104:107]
s_add_u32 m0, s73, 32768
s_nop 0
buffer_load_dwordx4 v225, s[16:19], s69 offen lds
v_mfma_f32_16x16x32_bf16 v[108:111], v[188:191], v[44:47], v[108:111]
s_add_u32 m0, s73, 36864
s_nop 0
buffer_load_dwordx4 v225, s[16:19], s70 offen lds
v_add_u32 v226, s62, v224
s_add_u32 m0, s73, 40960
s_nop 0
global_load_lds_dwordx4 v226, s[42:43]
v_add_u32 v227, s63, v224
s_add_u32 m0, s73, 45056
s_nop 0
global_load_lds_dwordx4 v227, s[42:43]
v_rcp_f32 v247, v247
s_nop 0
v_mul_f32 v171, v171, v247
v_cvt_pk_bf16_f32 v221, v170, v171
v_exp_f32 v248, v248
v_exp_f32 v249, v249
v_exp_f32 v250, v250
v_exp_f32 v251, v251
v_fma_f32 v248, v248, v243, v243
v_fma_f32 v249, v249, v243, v243
v_fma_f32 v250, v250, v243, v243
v_fma_f32 v251, v251, v243, v243
v_rcp_f32 v248, v248
v_rcp_f32 v249, v249
v_rcp_f32 v250, v250
v_rcp_f32 v251, v251
v_mul_f32 v172, v172, v248
v_mul_f32 v173, v173, v249
v_mul_f32 v174, v174, v250
v_mul_f32 v175, v175, v251
v_cvt_pk_bf16_f32 v222, v172, v173
v_cvt_pk_bf16_f32 v223, v174, v175
s_waitcnt lgkmcnt(0)
v_mfma_f32_16x16x32_bf16 v[112:115], v[176:179], a[0:3], 0
ds_read_b64_tr_b16 v[184:185], v5 offset:26624
v_bfe_u32 v252, v1, 2, 2
v_mfma_f32_16x16x32_bf16 v[116:119], v[176:179], a[4:7], 0
ds_read_b64_tr_b16 v[186:187], v5 offset:26880
v_and_b32 v253, 3, v1
v_mfma_f32_16x16x32_bf16 v[120:123], v[176:179], a[8:11], 0
ds_read_b64_tr_b16 v[188:189], v5 offset:38912
v_lshlrev_b32 v254, 2, v3
v_mfma_f32_16x16x32_bf16 v[124:127], v[176:179], a[12:15], 0
ds_read_b64_tr_b16 v[190:191], v5 offset:39168
v_add_u32 v254, v254, v252
v_mfma_f32_16x16x32_bf16 v[128:131], v[180:183], a[0:3], 0
v_add_u32 v226, s64, v224
s_add_u32 m0, s73, 49152
v_mfma_f32_16x16x32_bf16 v[132:135], v[180:183], a[4:7], 0
v_lshlrev_b32 v254, 7, v254
v_and_b32 v255, 1, v253
v_mfma_f32_16x16x32_bf16 v[136:139], v[180:183], a[8:11], 0
v_lshl_add_u32 v254, v255, 3, v254
v_lshrrev_b32 v253, 1, v253
v_mfma_f32_16x16x32_bf16 v[140:143], v[180:183], a[12:15], 0
v_lshl_add_u32 v254, v253, 4, v254
v_lshrrev_b32 v252, 1, v252
s_waitcnt lgkmcnt(0)
v_mfma_f32_16x16x32_bf16 v[112:115], v[184:187], a[16:19], v[112:115]
ds_read_b64_tr_b16 v[176:177], v5 offset:28672
v_and_b32 v255, 1, v3
v_mfma_f32_16x16x32_bf16 v[116:119], v[184:187], a[20:23], v[116:119]
ds_read_b64_tr_b16 v[178:179], v5 offset:28928
v_lshl_add_u32 v252, v255, 1, v252
v_mfma_f32_16x16x32_bf16 v[120:123], v[184:187], a[24:27], v[120:123]
ds_read_b64_tr_b16 v[180:181], v5 offset:40960
s_lshl_b32 s3, s52, 1
v_mfma_f32_16x16x32_bf16 v[124:127], v[184:187], a[28:31], v[124:127]
ds_read_b64_tr_b16 v[182:183], v5 offset:41216
v_xor_b32 v253, s3, v252
v_mfma_f32_16x16x32_bf16 v[128:131], v[188:191], a[16:19], v[128:131]
global_load_lds_dwordx4 v226, s[42:43]
v_mfma_f32_16x16x32_bf16 v[132:135], v[188:191], a[20:23], v[132:135]
v_add_u32 v227, s65, v224
s_add_u32 m0, s73, 53248
v_mfma_f32_16x16x32_bf16 v[136:139], v[188:191], a[24:27], v[136:139]
v_lshl_add_u32 v230, v253, 5, v254
v_add_u32 v231, 49152, v230
v_mfma_f32_16x16x32_bf16 v[140:143], v[188:191], a[28:31], v[140:143]
v_add_u32 v232, 98304, v230
s_add_u32 s3, s3, 1
s_waitcnt lgkmcnt(0)
v_mfma_f32_16x16x32_bf16 v[112:115], v[176:179], a[32:35], v[112:115]
ds_read_b64_tr_b16 v[184:185], v5 offset:30720
v_xor_b32 v253, s3, v252
v_mfma_f32_16x16x32_bf16 v[116:119], v[176:179], a[36:39], v[116:119]
ds_read_b64_tr_b16 v[186:187], v5 offset:30976
v_lshl_add_u32 v233, v253, 5, v254
v_mfma_f32_16x16x32_bf16 v[120:123], v[176:179], a[40:43], v[120:123]
ds_read_b64_tr_b16 v[188:189], v5 offset:43008
v_add_u32 v234, 49152, v233
v_mfma_f32_16x16x32_bf16 v[124:127], v[176:179], a[44:47], v[124:127]
ds_read_b64_tr_b16 v[190:191], v5 offset:43264
v_add_u32 v235, 98304, v233
v_mfma_f32_16x16x32_bf16 v[128:131], v[180:183], a[32:35], v[128:131]
global_load_lds_dwordx4 v227, s[42:43]
v_mfma_f32_16x16x32_bf16 v[132:135], v[180:183], a[36:39], v[132:135]
v_add_u32 v226, s66, v224
s_add_u32 m0, s73, 57344
v_mfma_f32_16x16x32_bf16 v[136:139], v[180:183], a[40:43], v[136:139]
s_mul_i32 s3, s51, 24576
s_add_u32 s3, s3, 73728
v_mfma_f32_16x16x32_bf16 v[140:143], v[180:183], a[44:47], v[140:143]
v_lshl_add_u32 v15, v1, 4, s3
s_lshl_b32 s59, s52, 3
s_waitcnt lgkmcnt(0)
v_mfma_f32_16x16x32_bf16 v[112:115], v[184:187], a[48:51], v[112:115]
ds_read_b64_tr_b16 v[176:177], v5 offset:32768
v_add_u32 v12, s59, v15
v_mfma_f32_16x16x32_bf16 v[116:119], v[184:187], a[52:55], v[116:119]
ds_read_b64_tr_b16 v[178:179], v5 offset:33024
s_lshl_b32 s3, s51, 12
v_mfma_f32_16x16x32_bf16 v[120:123], v[184:187], a[56:59], v[120:123]
ds_read_b64_tr_b16 v[180:181], v5 offset:45056
v_lshl_add_u32 v7, v1, 4, s3
v_mfma_f32_16x16x32_bf16 v[124:127], v[184:187], a[60:63], v[124:127]
ds_read_b64_tr_b16 v[182:183], v5 offset:45312
v_add_u32 v13, s59, v7
v_mfma_f32_16x16x32_bf16 v[128:131], v[188:191], a[48:51], v[128:131]
global_load_lds_dwordx4 v226, s[42:43]
v_mfma_f32_16x16x32_bf16 v[132:135], v[188:191], a[52:55], v[132:135]
v_add_u32 v227, s67, v224
s_add_u32 m0, s73, 61440
v_mfma_f32_16x16x32_bf16 v[136:139], v[188:191], a[56:59], v[136:139]
s_lshl_b32 s3, s51, 13
s_add_u32 s3, s3, 122880
v_mfma_f32_16x16x32_bf16 v[140:143], v[188:191], a[60:63], v[140:143]
v_lshl_add_u32 v14, v1, 4, s3
v_mul_f32 v244, v48, v236
s_waitcnt lgkmcnt(0)
v_mfma_f32_16x16x32_bf16 v[112:115], v[176:179], a[64:67], v[112:115]
ds_read_b64_tr_b16 v[184:185], v5 offset:34816
v_mul_f32 v245, v49, v236
v_mfma_f32_16x16x32_bf16 v[116:119], v[176:179], a[68:71], v[116:119]
ds_read_b64_tr_b16 v[186:187], v5 offset:35072
v_mul_f32 v246, v50, v236
v_mfma_f32_16x16x32_bf16 v[120:123], v[176:179], a[72:75], v[120:123]
ds_read_b64_tr_b16 v[188:189], v5 offset:47104
v_mul_f32 v247, v51, v236
v_mfma_f32_16x16x32_bf16 v[124:127], v[176:179], a[76:79], v[124:127]
ds_read_b64_tr_b16 v[190:191], v5 offset:47360
v_mul_f32 v64, v48, v64
v_mfma_f32_16x16x32_bf16 v[128:131], v[180:183], a[64:67], v[128:131]
global_load_lds_dwordx4 v227, s[42:43]
v_mfma_f32_16x16x32_bf16 v[132:135], v[180:183], a[68:71], v[132:135]
v_add_u32 v226, s68, v224
s_add_u32 m0, s73, 65536
v_mfma_f32_16x16x32_bf16 v[136:139], v[180:183], a[72:75], v[136:139]
v_exp_f32 v244, v244
v_mfma_f32_16x16x32_bf16 v[140:143], v[180:183], a[76:79], v[140:143]
v_exp_f32 v245, v245
s_waitcnt lgkmcnt(0)
s_waitcnt vmcnt(16)
s_barrier
v_mfma_f32_16x16x32_bf16 v[112:115], v[184:187], a[80:83], v[112:115]
ds_read_b64_tr_b16 v[176:177], v6 offset:0
v_mul_f32 v65, v49, v65
v_mfma_f32_16x16x32_bf16 v[116:119], v[184:187], a[84:87], v[116:119]
ds_read_b64_tr_b16 v[178:179], v6 offset:256
v_mul_f32 v66, v50, v66
v_mfma_f32_16x16x32_bf16 v[120:123], v[184:187], a[88:91], v[120:123]
ds_read_b64_tr_b16 v[180:181], v6 offset:12288
v_mul_f32 v67, v51, v67
v_mfma_f32_16x16x32_bf16 v[124:127], v[184:187], a[92:95], v[124:127]
ds_read_b64_tr_b16 v[182:183], v6 offset:12544
v_fma_f32 v244, v244, v240, v240
v_mfma_f32_16x16x32_bf16 v[128:131], v[188:191], a[80:83], v[128:131]
global_load_lds_dwordx4 v226, s[42:43]
v_mfma_f32_16x16x32_bf16 v[132:135], v[188:191], a[84:87], v[132:135]
v_add_u32 v224, 128, v224
v_add_u32 v225, 128, v225
v_mfma_f32_16x16x32_bf16 v[136:139], v[188:191], a[88:91], v[136:139]
v_exp_f32 v246, v246
v_mfma_f32_16x16x32_bf16 v[140:143], v[188:191], a[92:95], v[140:143]
v_exp_f32 v247, v247
s_waitcnt lgkmcnt(0)
v_mfma_f32_16x16x32_bf16 v[112:115], v[176:179], a[96:99], v[112:115]
ds_read_b64_tr_b16 v[184:185], v6 offset:2048
ds_read_b128 a[0:3], v14 offset:16384
v_mfma_f32_16x16x32_bf16 v[116:119], v[176:179], a[100:103], v[116:119]
ds_read_b64_tr_b16 v[186:187], v6 offset:2304
ds_read_b128 a[4:7], v14 offset:17408
v_mfma_f32_16x16x32_bf16 v[120:123], v[176:179], a[104:107], v[120:123]
ds_read_b64_tr_b16 v[188:189], v6 offset:14336
ds_read_b128 a[8:11], v14 offset:18432
v_mfma_f32_16x16x32_bf16 v[124:127], v[176:179], a[108:111], v[124:127]
ds_read_b64_tr_b16 v[190:191], v6 offset:14592
ds_read_b128 a[12:15], v14 offset:19456
v_mfma_f32_16x16x32_bf16 v[128:131], v[180:183], a[96:99], v[128:131]
ds_read_b128 a[16:19], v14 offset:20480
ds_read_b128 a[20:23], v14 offset:21504
v_mfma_f32_16x16x32_bf16 v[132:135], v[180:183], a[100:103], v[132:135]
ds_read_b128 a[24:27], v14 offset:22528
ds_read_b128 a[28:31], v14 offset:23552
v_mfma_f32_16x16x32_bf16 v[136:139], v[180:183], a[104:107], v[136:139]
ds_read_b128 a[32:35], v14 offset:0
ds_read_b128 a[36:39], v14 offset:1024
v_mfma_f32_16x16x32_bf16 v[140:143], v[180:183], a[108:111], v[140:143]
ds_read_b128 a[40:43], v14 offset:2048
ds_read_b128 a[44:47], v14 offset:3072
s_waitcnt lgkmcnt(9)
v_mfma_f32_16x16x32_bf16 v[112:115], v[184:187], a[112:115], v[112:115]
ds_read_b64_tr_b16 v[176:177], v6 offset:4096
ds_read_b128 a[48:51], v14 offset:4096
v_mfma_f32_16x16x32_bf16 v[116:119], v[184:187], a[116:119], v[116:119]
ds_read_b64_tr_b16 v[178:179], v6 offset:4352
ds_read_b128 a[52:55], v14 offset:5120
v_mfma_f32_16x16x32_bf16 v[120:123], v[184:187], a[120:123], v[120:123]
ds_read_b64_tr_b16 v[180:181], v6 offset:16384
ds_read_b128 a[56:59], v14 offset:6144
v_mfma_f32_16x16x32_bf16 v[124:127], v[184:187], a[124:127], v[124:127]
ds_read_b64_tr_b16 v[182:183], v6 offset:16640
ds_read_b128 a[60:63], v14 offset:7168
v_mfma_f32_16x16x32_bf16 v[128:131], v[188:191], a[112:115], v[128:131]
v_fma_f32 v245, v245, v240, v240
v_fma_f32 v246, v246, v240, v240
v_mfma_f32_16x16x32_bf16 v[132:135], v[188:191], a[116:119], v[132:135]
v_fma_f32 v247, v247, v240, v240
v_mul_f32 v248, v52, v237
v_mfma_f32_16x16x32_bf16 v[136:139], v[188:191], a[120:123], v[136:139]
v_rcp_f32 v244, v244
v_mfma_f32_16x16x32_bf16 v[140:143], v[188:191], a[124:127], v[140:143]
v_rcp_f32 v245, v245
s_waitcnt lgkmcnt(1)
v_mfma_f32_16x16x32_bf16 v[112:115], v[176:179], a[128:131], v[112:115]
ds_read_b64_tr_b16 v[184:185], v6 offset:6144
v_mul_f32 v64, v64, v244
v_mfma_f32_16x16x32_bf16 v[116:119], v[176:179], a[132:135], v[116:119]
ds_read_b64_tr_b16 v[186:187], v6 offset:6400
v_mul_f32 v65, v65, v245
v_mfma_f32_16x16x32_bf16 v[120:123], v[176:179], a[136:139], v[120:123]
ds_read_b64_tr_b16 v[188:189], v6 offset:18432
v_cvt_pk_bf16_f32 v144, v64, v65
v_mfma_f32_16x16x32_bf16 v[124:127], v[176:179], a[140:143], v[124:127]
ds_read_b64_tr_b16 v[190:191], v6 offset:18688
v_mul_f32 v249, v53, v237
v_mfma_f32_16x16x32_bf16 v[128:131], v[180:183], a[128:131], v[128:131]
v_rcp_f32 v246, v246
v_mfma_f32_16x16x32_bf16 v[132:135], v[180:183], a[132:135], v[132:135]
v_rcp_f32 v247, v247
v_mfma_f32_16x16x32_bf16 v[136:139], v[180:183], a[136:139], v[136:139]
v_mul_f32 v66, v66, v246
v_mul_f32 v67, v67, v247
v_mfma_f32_16x16x32_bf16 v[140:143], v[180:183], a[140:143], v[140:143]
v_cvt_pk_bf16_f32 v145, v66, v67
v_mul_f32 v250, v54, v237
s_waitcnt lgkmcnt(0)
v_mfma_f32_16x16x32_bf16 v[112:115], v[184:187], a[144:147], v[112:115]
ds_read_b64_tr_b16 v[176:177], v6 offset:8192
v_mul_f32 v251, v55, v237
v_mfma_f32_16x16x32_bf16 v[116:119], v[184:187], a[148:151], v[116:119]
ds_read_b64_tr_b16 v[178:179], v6 offset:8448
v_mul_f32 v68, v52, v68
v_mfma_f32_16x16x32_bf16 v[120:123], v[184:187], a[152:155], v[120:123]
ds_read_b64_tr_b16 v[180:181], v6 offset:20480
v_mul_f32 v69, v53, v69
v_mfma_f32_16x16x32_bf16 v[124:127], v[184:187], a[156:159], v[124:127]
ds_read_b64_tr_b16 v[182:183], v6 offset:20736
v_mul_f32 v70, v54, v70
v_mfma_f32_16x16x32_bf16 v[128:131], v[188:191], a[144:147], v[128:131]
v_exp_f32 v248, v248
v_mfma_f32_16x16x32_bf16 v[132:135], v[188:191], a[148:151], v[132:135]
v_exp_f32 v249, v249
v_mfma_f32_16x16x32_bf16 v[136:139], v[188:191], a[152:155], v[136:139]
v_exp_f32 v250, v250
v_mfma_f32_16x16x32_bf16 v[140:143], v[188:191], a[156:159], v[140:143]
v_exp_f32 v251, v251
s_waitcnt lgkmcnt(0)
v_mfma_f32_16x16x32_bf16 v[112:115], v[176:179], a[160:163], v[112:115]
ds_read_b64_tr_b16 v[184:185], v6 offset:10240
v_mul_f32 v71, v55, v71
v_mfma_f32_16x16x32_bf16 v[116:119], v[176:179], a[164:167], v[116:119]
ds_read_b64_tr_b16 v[186:187], v6 offset:10496
v_fma_f32 v248, v248, v241, v241
v_mfma_f32_16x16x32_bf16 v[120:123], v[176:179], a[168:171], v[120:123]
ds_read_b64_tr_b16 v[188:189], v6 offset:22528
v_fma_f32 v249, v249, v241, v241
v_mfma_f32_16x16x32_bf16 v[124:127], v[176:179], a[172:175], v[124:127]
ds_read_b64_tr_b16 v[190:191], v6 offset:22784
v_fma_f32 v250, v250, v241, v241
v_mfma_f32_16x16x32_bf16 v[128:131], v[180:183], a[160:163], v[128:131]
v_fma_f32 v251, v251, v241, v241
v_mul_f32 v244, v56, v238
v_mfma_f32_16x16x32_bf16 v[132:135], v[180:183], a[164:167], v[132:135]
v_rcp_f32 v248, v248
v_mfma_f32_16x16x32_bf16 v[136:139], v[180:183], a[168:171], v[136:139]
v_rcp_f32 v249, v249
v_mfma_f32_16x16x32_bf16 v[140:143], v[180:183], a[172:175], v[140:143]
v_rcp_f32 v250, v250
s_waitcnt lgkmcnt(0)
s_waitcnt vmcnt(11)
s_barrier
v_mfma_f32_16x16x32_bf16 v[112:115], v[184:187], a[176:179], v[112:115]
ds_read_b64_tr_b16 v[176:177], v4 offset:0
v_mul_f32 v68, v68, v248
v_mfma_f32_16x16x32_bf16 v[116:119], v[184:187], a[180:183], v[116:119]
ds_read_b64_tr_b16 v[178:179], v4 offset:256
v_mul_f32 v69, v69, v249
v_mfma_f32_16x16x32_bf16 v[120:123], v[184:187], a[184:187], v[120:123]
ds_read_b64_tr_b16 v[180:181], v4 offset:12288
v_mul_f32 v70, v70, v250
v_mfma_f32_16x16x32_bf16 v[124:127], v[184:187], a[188:191], v[124:127]
ds_read_b64_tr_b16 v[182:183], v4 offset:12544
v_cvt_pk_bf16_f32 v146, v68, v69
v_mfma_f32_16x16x32_bf16 v[128:131], v[188:191], a[176:179], v[128:131]
v_rcp_f32 v251, v251
v_mfma_f32_16x16x32_bf16 v[132:135], v[188:191], a[180:183], v[132:135]
v_mul_f32 v71, v71, v251
v_cvt_pk_bf16_f32 v147, v70, v71
v_mfma_f32_16x16x32_bf16 v[136:139], v[188:191], a[184:187], v[136:139]
v_mul_f32 v245, v57, v238
v_mul_f32 v246, v58, v238
v_mfma_f32_16x16x32_bf16 v[140:143], v[188:191], a[188:191], v[140:143]
v_mul_f32 v247, v59, v238
v_mul_f32 v72, v56, v72
s_waitcnt lgkmcnt(0)
v_mfma_f32_16x16x32_bf16 v[112:115], v[176:179], a[192:195], v[112:115]
ds_read_b64_tr_b16 v[184:185], v4 offset:2048
ds_write_b64 v12, v[192:193] offset:0
v_mfma_f32_16x16x32_bf16 v[116:119], v[176:179], a[196:199], v[116:119]
ds_read_b64_tr_b16 v[186:187], v4 offset:2304
ds_write_b64 v12, v[194:195] offset:1024
v_mfma_f32_16x16x32_bf16 v[120:123], v[176:179], a[200:203], v[120:123]
ds_read_b64_tr_b16 v[188:189], v4 offset:14336
ds_write_b64 v12, v[196:197] offset:2048
v_mfma_f32_16x16x32_bf16 v[124:127], v[176:179], a[204:207], v[124:127]
ds_read_b64_tr_b16 v[190:191], v4 offset:14592
ds_write_b64 v12, v[198:199] offset:3072
v_mfma_f32_16x16x32_bf16 v[128:131], v[180:183], a[192:195], v[128:131]
ds_write_b64 v12, v[200:201] offset:4096
ds_write_b64 v12, v[202:203] offset:5120
v_mfma_f32_16x16x32_bf16 v[132:135], v[180:183], a[196:199], v[132:135]
ds_write_b64 v12, v[204:205] offset:6144
ds_write_b64 v12, v[206:207] offset:7168
v_mfma_f32_16x16x32_bf16 v[136:139], v[180:183], a[200:203], v[136:139]
ds_write_b64 v12, v[208:209] offset:8192
ds_write_b64 v12, v[210:211] offset:9216
v_mfma_f32_16x16x32_bf16 v[140:143], v[180:183], a[204:207], v[140:143]
ds_write_b64 v12, v[212:213] offset:10240
ds_write_b64 v12, v[214:215] offset:11264
s_waitcnt lgkmcnt(9)
v_mfma_f32_16x16x32_bf16 v[112:115], v[184:187], a[208:211], v[112:115]
ds_read_b64_tr_b16 v[176:177], v4 offset:4096
ds_write_b64 v12, v[216:217] offset:12288
v_mfma_f32_16x16x32_bf16 v[116:119], v[184:187], a[212:215], v[116:119]
ds_read_b64_tr_b16 v[178:179], v4 offset:4352
ds_write_b64 v12, v[218:219] offset:13312
v_mfma_f32_16x16x32_bf16 v[120:123], v[184:187], a[216:219], v[120:123]
ds_read_b64_tr_b16 v[180:181], v4 offset:16384
ds_write_b64 v12, v[220:221] offset:14336
v_mfma_f32_16x16x32_bf16 v[124:127], v[184:187], a[220:223], v[124:127]
ds_read_b64_tr_b16 v[182:183], v4 offset:16640
ds_write_b64 v12, v[222:223] offset:15360
v_mfma_f32_16x16x32_bf16 v[128:131], v[188:191], a[208:211], v[128:131]
v_exp_f32 v244, v244
v_mfma_f32_16x16x32_bf16 v[132:135], v[188:191], a[212:215], v[132:135]
v_exp_f32 v245, v245
v_mfma_f32_16x16x32_bf16 v[136:139], v[188:191], a[216:219], v[136:139]
v_mul_f32 v73, v57, v73
v_mul_f32 v74, v58, v74
v_mfma_f32_16x16x32_bf16 v[140:143], v[188:191], a[220:223], v[140:143]
v_exp_f32 v246, v246
s_waitcnt lgkmcnt(1)
v_mfma_f32_16x16x32_bf16 v[112:115], v[176:179], a[224:227], v[112:115]
ds_read_b64_tr_b16 v[184:185], v4 offset:6144
v_mul_f32 v75, v59, v75
v_mfma_f32_16x16x32_bf16 v[116:119], v[176:179], a[228:231], v[116:119]
ds_read_b64_tr_b16 v[186:187], v4 offset:6400
v_fma_f32 v244, v244, v242, v242
v_mfma_f32_16x16x32_bf16 v[120:123], v[176:179], a[232:235], v[120:123]
ds_read_b64_tr_b16 v[188:189], v4 offset:18432
v_fma_f32 v245, v245, v242, v242
v_mfma_f32_16x16x32_bf16 v[124:127], v[176:179], a[236:239], v[124:127]
ds_read_b64_tr_b16 v[190:191], v4 offset:18688
v_fma_f32 v246, v246, v242, v242
v_mfma_f32_16x16x32_bf16 v[128:131], v[180:183], a[224:227], v[128:131]
v_exp_f32 v247, v247
v_mfma_f32_16x16x32_bf16 v[132:135], v[180:183], a[228:231], v[132:135]
v_fma_f32 v247, v247, v242, v242
v_mul_f32 v248, v60, v239
v_mfma_f32_16x16x32_bf16 v[136:139], v[180:183], a[232:235], v[136:139]
v_rcp_f32 v244, v244
v_mfma_f32_16x16x32_bf16 v[140:143], v[180:183], a[236:239], v[140:143]
v_rcp_f32 v245, v245
s_waitcnt lgkmcnt(0)
v_mfma_f32_16x16x32_bf16 v[112:115], v[184:187], a[240:243], v[112:115]
ds_read_b64_tr_b16 v[176:177], v4 offset:8192
v_mul_f32 v72, v72, v244
v_mfma_f32_16x16x32_bf16 v[116:119], v[184:187], a[244:247], v[116:119]
ds_read_b64_tr_b16 v[178:179], v4 offset:8448
v_mul_f32 v73, v73, v245
v_mfma_f32_16x16x32_bf16 v[120:123], v[184:187], a[248:251], v[120:123]
ds_read_b64_tr_b16 v[180:181], v4 offset:20480
v_cvt_pk_bf16_f32 v148, v72, v73
v_mfma_f32_16x16x32_bf16 v[124:127], v[184:187], a[252:255], v[124:127]
ds_read_b64_tr_b16 v[182:183], v4 offset:20736
v_mul_f32 v249, v61, v239
v_mfma_f32_16x16x32_bf16 v[128:131], v[188:191], a[240:243], v[128:131]
v_rcp_f32 v246, v246
v_mfma_f32_16x16x32_bf16 v[132:135], v[188:191], a[244:247], v[132:135]
v_rcp_f32 v247, v247
v_mfma_f32_16x16x32_bf16 v[136:139], v[188:191], a[248:251], v[136:139]
v_mul_f32 v74, v74, v246
v_mul_f32 v75, v75, v247
v_mfma_f32_16x16x32_bf16 v[140:143], v[188:191], a[252:255], v[140:143]
v_cvt_pk_bf16_f32 v149, v74, v75
v_mul_f32 v250, v62, v239
s_waitcnt lgkmcnt(0)
v_mfma_f32_16x16x32_bf16 v[112:115], v[176:179], v[16:19], v[112:115]
ds_read_b64_tr_b16 v[184:185], v4 offset:10240
v_mul_f32 v251, v63, v239
v_mfma_f32_16x16x32_bf16 v[116:119], v[176:179], v[20:23], v[116:119]
ds_read_b64_tr_b16 v[186:187], v4 offset:10496
v_mul_f32 v76, v60, v76
v_mfma_f32_16x16x32_bf16 v[120:123], v[176:179], v[24:27], v[120:123]
ds_read_b64_tr_b16 v[188:189], v4 offset:22528
v_mul_f32 v77, v61, v77
v_mfma_f32_16x16x32_bf16 v[124:127], v[176:179], v[28:31], v[124:127]
ds_read_b64_tr_b16 v[190:191], v4 offset:22784
v_mul_f32 v78, v62, v78
v_mfma_f32_16x16x32_bf16 v[128:131], v[180:183], v[16:19], v[128:131]
v_exp_f32 v248, v248
v_mfma_f32_16x16x32_bf16 v[132:135], v[180:183], v[20:23], v[132:135]
v_exp_f32 v249, v249
v_mfma_f32_16x16x32_bf16 v[136:139], v[180:183], v[24:27], v[136:139]
v_exp_f32 v250, v250
v_mfma_f32_16x16x32_bf16 v[140:143], v[180:183], v[28:31], v[140:143]
v_exp_f32 v251, v251
s_waitcnt lgkmcnt(0)
s_waitcnt vmcnt(5)
s_barrier
v_mfma_f32_16x16x32_bf16 v[112:115], v[184:187], v[32:35], v[112:115]
ds_read_b64_tr_b16 v[176:177], v230 offset:24576
v_mul_f32 v79, v63, v79
v_mfma_f32_16x16x32_bf16 v[116:119], v[184:187], v[36:39], v[116:119]
ds_read_b64_tr_b16 v[178:179], v230 offset:26624
v_fma_f32 v248, v248, v243, v243
v_mfma_f32_16x16x32_bf16 v[120:123], v[184:187], v[40:43], v[120:123]
ds_read_b64_tr_b16 v[180:181], v233 offset:24576
v_fma_f32 v249, v249, v243, v243
v_mfma_f32_16x16x32_bf16 v[124:127], v[184:187], v[44:47], v[124:127]
ds_read_b64_tr_b16 v[182:183], v233 offset:26624
v_fma_f32 v250, v250, v243, v243
v_mfma_f32_16x16x32_bf16 v[128:131], v[188:191], v[32:35], v[128:131]
v_fma_f32 v251, v251, v243, v243
v_mul_f32 v244, v80, v236
v_mfma_f32_16x16x32_bf16 v[132:135], v[188:191], v[36:39], v[132:135]
v_rcp_f32 v248, v248
v_mfma_f32_16x16x32_bf16 v[136:139], v[188:191], v[40:43], v[136:139]
v_rcp_f32 v249, v249
v_mfma_f32_16x16x32_bf16 v[140:143], v[188:191], v[44:47], v[140:143]
v_rcp_f32 v250, v250
s_mul_i32 s76, s53, 2359296
s_lshl_b32 s3, s51, 3
s_add_u32 s3, s3, s52
s_lshl_b32 s3, s3, 14
s_add_u32 s76, s76, s3
s_lshl_b32 s3, s54, 10
s_add_u32 s76, s76, s3
v_lshlrev_b32 v11, 4, v1
s_waitcnt lgkmcnt(0)
v_mfma_f32_16x16x32_bf16 v[192:195], v[176:179], a[0:3], 0
ds_read_b64_tr_b16 v[184:185], v230 offset:28672
ds_read_b128 a[64:67], v15 offset:0
v_mfma_f32_16x16x32_bf16 v[196:199], v[176:179], a[4:7], 0
ds_read_b64_tr_b16 v[186:187], v230 offset:30720
ds_read_b128 a[68:71], v15 offset:1024
v_mfma_f32_16x16x32_bf16 v[200:203], v[176:179], a[8:11], 0
ds_read_b64_tr_b16 v[188:189], v233 offset:28672
ds_read_b128 a[72:75], v15 offset:2048
v_mfma_f32_16x16x32_bf16 v[204:207], v[176:179], a[12:15], 0
ds_read_b64_tr_b16 v[190:191], v233 offset:30720
ds_read_b128 a[76:79], v15 offset:3072
v_mfma_f32_16x16x32_bf16 v[208:211], v[180:183], a[0:3], 0
v_add_u32 v226, s60, v224
s_add_u32 m0, s73, 122880
v_mfma_f32_16x16x32_bf16 v[212:215], v[180:183], a[4:7], 0
ds_read_b128 a[80:83], v15 offset:4096
ds_read_b128 a[84:87], v15 offset:5120
v_mfma_f32_16x16x32_bf16 v[216:219], v[180:183], a[8:11], 0
ds_read_b128 a[88:91], v15 offset:6144
ds_read_b128 a[92:95], v15 offset:7168
v_mfma_f32_16x16x32_bf16 v[220:223], v[180:183], a[12:15], 0
ds_read_b128 a[96:99], v15 offset:8192
ds_read_b128 a[100:103], v15 offset:9216
s_waitcnt lgkmcnt(7)
v_mfma_f32_16x16x32_bf16 v[192:195], v[184:187], a[16:19], v[192:195]
ds_read_b64_tr_b16 v[176:177], v230 offset:32768
ds_read_b128 a[104:107], v15 offset:10240
v_mfma_f32_16x16x32_bf16 v[196:199], v[184:187], a[20:23], v[196:199]
ds_read_b64_tr_b16 v[178:179], v230 offset:34816
ds_read_b128 a[108:111], v15 offset:11264
v_mfma_f32_16x16x32_bf16 v[200:203], v[184:187], a[24:27], v[200:203]
ds_read_b64_tr_b16 v[180:181], v233 offset:32768
ds_read_b128 a[112:115], v15 offset:12288
v_mfma_f32_16x16x32_bf16 v[204:207], v[184:187], a[28:31], v[204:207]
ds_read_b64_tr_b16 v[182:183], v233 offset:34816
ds_read_b128 a[116:119], v15 offset:13312
v_mfma_f32_16x16x32_bf16 v[208:211], v[188:191], a[16:19], v[208:211]
global_load_lds_dwordx4 v226, s[42:43]
v_mfma_f32_16x16x32_bf16 v[212:215], v[188:191], a[20:23], v[212:215]
v_add_u32 v227, s61, v224
s_add_u32 m0, s73, 126976
v_mfma_f32_16x16x32_bf16 v[216:219], v[188:191], a[24:27], v[216:219]
ds_read_b128 a[120:123], v15 offset:14336
ds_read_b128 a[124:127], v15 offset:15360
v_mfma_f32_16x16x32_bf16 v[220:223], v[188:191], a[28:31], v[220:223]
v_rcp_f32 v251, v251
s_waitcnt lgkmcnt(3)
v_mfma_f32_16x16x32_bf16 v[192:195], v[176:179], a[32:35], v[192:195]
ds_read_b64_tr_b16 v[184:185], v230 offset:36864
v_mul_f32 v76, v76, v248
v_mfma_f32_16x16x32_bf16 v[196:199], v[176:179], a[36:39], v[196:199]
ds_read_b64_tr_b16 v[186:187], v230 offset:38912
v_mul_f32 v77, v77, v249
v_mfma_f32_16x16x32_bf16 v[200:203], v[176:179], a[40:43], v[200:203]
ds_read_b64_tr_b16 v[188:189], v233 offset:36864
v_mul_f32 v78, v78, v250
v_mfma_f32_16x16x32_bf16 v[204:207], v[176:179], a[44:47], v[204:207]
ds_read_b64_tr_b16 v[190:191], v233 offset:38912
v_mul_f32 v79, v79, v251
v_mfma_f32_16x16x32_bf16 v[208:211], v[180:183], a[32:35], v[208:211]
global_load_lds_dwordx4 v227, s[42:43]
v_mfma_f32_16x16x32_bf16 v[212:215], v[180:183], a[36:39], v[212:215]
s_add_u32 m0, s73, 131072
s_nop 0
buffer_load_dwordx4 v225, s[16:19], s69 offen lds
v_mfma_f32_16x16x32_bf16 v[216:219], v[180:183], a[40:43], v[216:219]
v_cvt_pk_bf16_f32 v150, v76, v77
v_cvt_pk_bf16_f32 v151, v78, v79
v_mfma_f32_16x16x32_bf16 v[220:223], v[180:183], a[44:47], v[220:223]
v_mul_f32 v245, v81, v236
v_mul_f32 v246, v82, v236
s_waitcnt lgkmcnt(0)
v_mfma_f32_16x16x32_bf16 v[192:195], v[184:187], a[48:51], v[192:195]
ds_read_b64_tr_b16 v[176:177], v230 offset:40960
v_mul_f32 v247, v83, v236
v_mfma_f32_16x16x32_bf16 v[196:199], v[184:187], a[52:55], v[196:199]
ds_read_b64_tr_b16 v[178:179], v230 offset:43008
v_mul_f32 v96, v80, v96
v_mfma_f32_16x16x32_bf16 v[200:203], v[184:187], a[56:59], v[200:203]
ds_read_b64_tr_b16 v[180:181], v233 offset:40960
v_mul_f32 v97, v81, v97
v_mfma_f32_16x16x32_bf16 v[204:207], v[184:187], a[60:63], v[204:207]
ds_read_b64_tr_b16 v[182:183], v233 offset:43008
v_mul_f32 v98, v82, v98
v_mfma_f32_16x16x32_bf16 v[208:211], v[188:191], a[48:51], v[208:211]
s_add_u32 m0, s73, 135168
s_nop 0
buffer_load_dwordx4 v225, s[16:19], s70 offen lds
v_mfma_f32_16x16x32_bf16 v[212:215], v[188:191], a[52:55], v[212:215]
v_exp_f32 v244, v244
v_mfma_f32_16x16x32_bf16 v[216:219], v[188:191], a[56:59], v[216:219]
v_exp_f32 v245, v245
v_mfma_f32_16x16x32_bf16 v[220:223], v[188:191], a[60:63], v[220:223]
v_exp_f32 v246, v246
s_waitcnt lgkmcnt(0)
v_mfma_f32_16x16x32_bf16 v[192:195], v[176:179], a[64:67], v[192:195]
ds_read_b64_tr_b16 v[184:185], v230 offset:45056
v_mul_f32 v99, v83, v99
v_mfma_f32_16x16x32_bf16 v[196:199], v[176:179], a[68:71], v[196:199]
ds_read_b64_tr_b16 v[186:187], v230 offset:47104
v_fma_f32 v244, v244, v240, v240
v_mfma_f32_16x16x32_bf16 v[200:203], v[176:179], a[72:75], v[200:203]
ds_read_b64_tr_b16 v[188:189], v233 offset:45056
v_fma_f32 v245, v245, v240, v240
v_mfma_f32_16x16x32_bf16 v[204:207], v[176:179], a[76:79], v[204:207]
ds_read_b64_tr_b16 v[190:191], v233 offset:47104
v_fma_f32 v246, v246, v240, v240
v_mfma_f32_16x16x32_bf16 v[208:211], v[180:183], a[64:67], v[208:211]
v_add_u32 v226, s62, v224
s_add_u32 m0, s73, 139264
v_mfma_f32_16x16x32_bf16 v[212:215], v[180:183], a[68:71], v[212:215]
global_load_lds_dwordx4 v226, s[42:43]
v_mfma_f32_16x16x32_bf16 v[216:219], v[180:183], a[72:75], v[216:219]
v_exp_f32 v247, v247
v_mfma_f32_16x16x32_bf16 v[220:223], v[180:183], a[76:79], v[220:223]
v_fma_f32 v247, v247, v240, v240
v_mul_f32 v248, v84, v237
s_waitcnt lgkmcnt(0)
s_waitcnt vmcnt(5)
s_barrier
v_mfma_f32_16x16x32_bf16 v[192:195], v[184:187], a[80:83], v[192:195]
ds_read_b64_tr_b16 v[176:177], v231 offset:0
v_mul_f32 v249, v85, v237
v_mfma_f32_16x16x32_bf16 v[196:199], v[184:187], a[84:87], v[196:199]
ds_read_b64_tr_b16 v[178:179], v231 offset:2048
v_mul_f32 v250, v86, v237
v_mfma_f32_16x16x32_bf16 v[200:203], v[184:187], a[88:91], v[200:203]
ds_read_b64_tr_b16 v[180:181], v234 offset:0
v_mul_f32 v251, v87, v237
v_mfma_f32_16x16x32_bf16 v[204:207], v[184:187], a[92:95], v[204:207]
ds_read_b64_tr_b16 v[182:183], v234 offset:2048
v_mul_f32 v100, v84, v100
v_mfma_f32_16x16x32_bf16 v[208:211], v[188:191], a[80:83], v[208:211]
v_add_u32 v227, s63, v224
s_add_u32 m0, s73, 143360
v_mfma_f32_16x16x32_bf16 v[212:215], v[188:191], a[84:87], v[212:215]
global_load_lds_dwordx4 v227, s[42:43]
v_mfma_f32_16x16x32_bf16 v[216:219], v[188:191], a[88:91], v[216:219]
v_rcp_f32 v244, v244
v_mfma_f32_16x16x32_bf16 v[220:223], v[188:191], a[92:95], v[220:223]
v_rcp_f32 v245, v245
s_waitcnt lgkmcnt(0)
v_mfma_f32_16x16x32_bf16 v[192:195], v[176:179], a[96:99], v[192:195]
ds_read_b64_tr_b16 v[184:185], v231 offset:4096
v_mul_f32 v96, v96, v244
v_mfma_f32_16x16x32_bf16 v[196:199], v[176:179], a[100:103], v[196:199]
ds_read_b64_tr_b16 v[186:187], v231 offset:6144
v_mul_f32 v97, v97, v245
v_mfma_f32_16x16x32_bf16 v[200:203], v[176:179], a[104:107], v[200:203]
ds_read_b64_tr_b16 v[188:189], v234 offset:4096
v_cvt_pk_bf16_f32 v152, v96, v97
v_mfma_f32_16x16x32_bf16 v[204:207], v[176:179], a[108:111], v[204:207]
ds_read_b64_tr_b16 v[190:191], v234 offset:6144
v_mul_f32 v101, v85, v101
v_mfma_f32_16x16x32_bf16 v[208:211], v[180:183], a[96:99], v[208:211]
v_add_u32 v226, s64, v224
s_add_u32 m0, s73, 24576
v_mfma_f32_16x16x32_bf16 v[212:215], v[180:183], a[100:103], v[212:215]
global_load_lds_dwordx4 v226, s[42:43]
v_mfma_f32_16x16x32_bf16 v[216:219], v[180:183], a[104:107], v[216:219]
v_rcp_f32 v246, v246
v_mfma_f32_16x16x32_bf16 v[220:223], v[180:183], a[108:111], v[220:223]
v_rcp_f32 v247, v247
v_mul_f32 v98, v98, v246
v_mul_f32 v99, v99, v247
v_cvt_pk_bf16_f32 v153, v98, v99
v_exp_f32 v248, v248
v_exp_f32 v249, v249
v_exp_f32 v250, v250
v_mul_f32 v102, v86, v102
v_exp_f32 v251, v251
v_mul_f32 v103, v87, v103
v_fma_f32 v248, v248, v241, v241
v_fma_f32 v249, v249, v241, v241
v_fma_f32 v250, v250, v241, v241
v_fma_f32 v251, v251, v241, v241
v_rcp_f32 v248, v248
v_rcp_f32 v249, v249
v_rcp_f32 v250, v250
v_rcp_f32 v251, v251
v_mul_f32 v100, v100, v248
v_mul_f32 v101, v101, v249
v_mul_f32 v102, v102, v250
v_mul_f32 v103, v103, v251
v_cvt_pk_bf16_f32 v154, v100, v101
v_cvt_pk_bf16_f32 v155, v102, v103
v_mul_f32 v244, v88, v238
v_mul_f32 v245, v89, v238
v_mul_f32 v246, v90, v238
v_mul_f32 v247, v91, v238
v_exp_f32 v244, v244
v_mul_f32 v104, v88, v104
v_exp_f32 v245, v245
v_mul_f32 v105, v89, v105
v_exp_f32 v246, v246
v_mul_f32 v106, v90, v106
v_exp_f32 v247, v247
v_mul_f32 v107, v91, v107
v_fma_f32 v244, v244, v242, v242
v_fma_f32 v245, v245, v242, v242
v_fma_f32 v246, v246, v242, v242
v_fma_f32 v247, v247, v242, v242
v_rcp_f32 v244, v244
v_rcp_f32 v245, v245
v_rcp_f32 v246, v246
v_rcp_f32 v247, v247
v_mul_f32 v104, v104, v244
v_mul_f32 v105, v105, v245
v_mul_f32 v106, v106, v246
v_mul_f32 v107, v107, v247
v_cvt_pk_bf16_f32 v156, v104, v105
v_cvt_pk_bf16_f32 v157, v106, v107
v_mul_f32 v248, v92, v239
v_mul_f32 v249, v93, v239
v_mul_f32 v250, v94, v239
v_mul_f32 v251, v95, v239
v_exp_f32 v248, v248
v_mul_f32 v108, v92, v108
v_exp_f32 v249, v249
v_mul_f32 v109, v93, v109
v_exp_f32 v250, v250
v_mul_f32 v110, v94, v110
v_exp_f32 v251, v251
v_mul_f32 v111, v95, v111
v_fma_f32 v248, v248, v243, v243
v_fma_f32 v249, v249, v243, v243
v_fma_f32 v250, v250, v243, v243
v_fma_f32 v251, v251, v243, v243
v_rcp_f32 v248, v248
v_rcp_f32 v249, v249
v_rcp_f32 v250, v250
v_rcp_f32 v251, v251
v_mul_f32 v108, v108, v248
v_mul_f32 v109, v109, v249
v_mul_f32 v110, v110, v250
v_mul_f32 v111, v111, v251
v_cvt_pk_bf16_f32 v158, v108, v109
v_cvt_pk_bf16_f32 v159, v110, v111
ds_write_b64 v12, v[144:145] offset:16384
ds_write_b64 v12, v[146:147] offset:17408
ds_write_b64 v12, v[148:149] offset:18432
ds_write_b64 v12, v[150:151] offset:19456
ds_write_b64 v12, v[152:153] offset:20480
ds_write_b64 v12, v[154:155] offset:21504
ds_write_b64 v12, v[156:157] offset:22528
ds_write_b64 v12, v[158:159] offset:23552
v_mul_f32 v244, v112, v236
v_mul_f32 v245, v113, v236
v_mul_f32 v246, v114, v236
v_mul_f32 v247, v115, v236
v_exp_f32 v244, v244
v_mul_f32 v128, v112, v128
v_exp_f32 v245, v245
v_mul_f32 v129, v113, v129
v_exp_f32 v246, v246
v_mul_f32 v130, v114, v130
v_exp_f32 v247, v247
v_mul_f32 v131, v115, v131
v_fma_f32 v244, v244, v240, v240
v_fma_f32 v245, v245, v240, v240
v_fma_f32 v246, v246, v240, v240
v_fma_f32 v247, v247, v240, v240
v_rcp_f32 v244, v244
v_rcp_f32 v245, v245
v_rcp_f32 v246, v246
v_rcp_f32 v247, v247
v_mul_f32 v128, v128, v244
v_mul_f32 v129, v129, v245
v_mul_f32 v130, v130, v246
v_mul_f32 v131, v131, v247
v_cvt_pk_bf16_f32 v160, v128, v129
v_cvt_pk_bf16_f32 v161, v130, v131
v_mul_f32 v248, v116, v237
v_mul_f32 v249, v117, v237
v_mul_f32 v250, v118, v237
v_mul_f32 v251, v119, v237
v_exp_f32 v248, v248
v_mul_f32 v132, v116, v132
v_exp_f32 v249, v249
v_mul_f32 v133, v117, v133
v_exp_f32 v250, v250
v_mul_f32 v134, v118, v134
v_exp_f32 v251, v251
v_mul_f32 v135, v119, v135
v_fma_f32 v248, v248, v241, v241
v_fma_f32 v249, v249, v241, v241
v_fma_f32 v250, v250, v241, v241
v_fma_f32 v251, v251, v241, v241
v_rcp_f32 v248, v248
v_rcp_f32 v249, v249
v_rcp_f32 v250, v250
v_rcp_f32 v251, v251
v_mul_f32 v132, v132, v248
v_mul_f32 v133, v133, v249
v_mul_f32 v134, v134, v250
v_mul_f32 v135, v135, v251
v_cvt_pk_bf16_f32 v162, v132, v133
v_cvt_pk_bf16_f32 v163, v134, v135
v_mul_f32 v244, v120, v238
v_mul_f32 v245, v121, v238
v_mul_f32 v246, v122, v238
v_mul_f32 v247, v123, v238
v_exp_f32 v244, v244
v_mul_f32 v136, v120, v136
v_exp_f32 v245, v245
v_mul_f32 v137, v121, v137
v_exp_f32 v246, v246
v_mul_f32 v138, v122, v138
v_exp_f32 v247, v247
v_mul_f32 v139, v123, v139
v_fma_f32 v244, v244, v242, v242
v_fma_f32 v245, v245, v242, v242
v_fma_f32 v246, v246, v242, v242
v_fma_f32 v247, v247, v242, v242
v_rcp_f32 v244, v244
v_rcp_f32 v245, v245
v_rcp_f32 v246, v246
v_rcp_f32 v247, v247
v_mul_f32 v136, v136, v244
v_mul_f32 v137, v137, v245
v_mul_f32 v138, v138, v246
v_mul_f32 v139, v139, v247
v_cvt_pk_bf16_f32 v164, v136, v137
v_cvt_pk_bf16_f32 v165, v138, v139
v_mul_f32 v248, v124, v239
v_mul_f32 v249, v125, v239
v_mul_f32 v250, v126, v239
v_mul_f32 v251, v127, v239
v_exp_f32 v248, v248
v_mul_f32 v140, v124, v140
v_exp_f32 v249, v249
v_mul_f32 v141, v125, v141
v_exp_f32 v250, v250
v_mul_f32 v142, v126, v142
v_exp_f32 v251, v251
v_mul_f32 v143, v127, v143
v_fma_f32 v248, v248, v243, v243
v_fma_f32 v249, v249, v243, v243
v_fma_f32 v250, v250, v243, v243
v_fma_f32 v251, v251, v243, v243
v_rcp_f32 v248, v248
v_rcp_f32 v249, v249
v_rcp_f32 v250, v250
v_rcp_f32 v251, v251
v_mul_f32 v140, v140, v248
v_mul_f32 v141, v141, v249
v_mul_f32 v142, v142, v250
v_mul_f32 v143, v143, v251
v_cvt_pk_bf16_f32 v166, v140, v141
v_cvt_pk_bf16_f32 v167, v142, v143
ds_write_b64 v13, v[160:161] offset:0
ds_write_b64 v13, v[162:163] offset:1024
ds_write_b64 v13, v[164:165] offset:2048
ds_write_b64 v13, v[166:167] offset:3072
s_waitcnt lgkmcnt(0)
s_barrier
v_mfma_f32_16x16x32_bf16 v[192:195], v[184:187], a[112:115], v[192:195]
ds_read_b64_tr_b16 v[176:177], v231 offset:8192
ds_read_b128 a[128:131], v15 offset:16384
v_mfma_f32_16x16x32_bf16 v[196:199], v[184:187], a[116:119], v[196:199]
ds_read_b64_tr_b16 v[178:179], v231 offset:10240
ds_read_b128 a[132:135], v15 offset:17408
v_mfma_f32_16x16x32_bf16 v[200:203], v[184:187], a[120:123], v[200:203]
ds_read_b64_tr_b16 v[180:181], v234 offset:8192
ds_read_b128 a[136:139], v15 offset:18432
v_mfma_f32_16x16x32_bf16 v[204:207], v[184:187], a[124:127], v[204:207]
ds_read_b64_tr_b16 v[182:183], v234 offset:10240
ds_read_b128 a[140:143], v15 offset:19456
v_mfma_f32_16x16x32_bf16 v[208:211], v[188:191], a[112:115], v[208:211]
v_add_u32 v227, s65, v224
s_add_u32 m0, s73, 28672
v_mfma_f32_16x16x32_bf16 v[212:215], v[188:191], a[116:119], v[212:215]
global_load_lds_dwordx4 v227, s[42:43]
v_mfma_f32_16x16x32_bf16 v[216:219], v[188:191], a[120:123], v[216:219]
ds_read_b128 a[144:147], v15 offset:20480
ds_read_b128 a[148:151], v15 offset:21504
v_mfma_f32_16x16x32_bf16 v[220:223], v[188:191], a[124:127], v[220:223]
ds_read_b128 a[152:155], v15 offset:22528
ds_read_b128 a[156:159], v15 offset:23552
ds_read_b128 a[160:163], v7 offset:0
ds_read_b128 a[164:167], v7 offset:1024
ds_read_b128 a[168:171], v7 offset:2048
ds_read_b128 a[172:175], v7 offset:3072
s_waitcnt lgkmcnt(9)
v_mfma_f32_16x16x32_bf16 v[192:195], v[176:179], a[128:131], v[192:195]
ds_read_b64_tr_b16 v[184:185], v231 offset:12288
v_mfma_f32_16x16x32_bf16 v[196:199], v[176:179], a[132:135], v[196:199]
ds_read_b64_tr_b16 v[186:187], v231 offset:14336
v_mfma_f32_16x16x32_bf16 v[200:203], v[176:179], a[136:139], v[200:203]
ds_read_b64_tr_b16 v[188:189], v234 offset:12288
s_waitcnt lgkmcnt(11)
v_mfma_f32_16x16x32_bf16 v[204:207], v[176:179], a[140:143], v[204:207]
ds_read_b64_tr_b16 v[190:191], v234 offset:14336
v_mfma_f32_16x16x32_bf16 v[208:211], v[180:183], a[128:131], v[208:211]
v_add_u32 v226, s66, v224
s_add_u32 m0, s73, 32768
v_mfma_f32_16x16x32_bf16 v[212:215], v[180:183], a[132:135], v[212:215]
global_load_lds_dwordx4 v226, s[42:43]
v_mfma_f32_16x16x32_bf16 v[216:219], v[180:183], a[136:139], v[216:219]
v_add_u32 v227, s67, v224
v_mfma_f32_16x16x32_bf16 v[220:223], v[180:183], a[140:143], v[220:223]
s_waitcnt lgkmcnt(0)
v_mfma_f32_16x16x32_bf16 v[192:195], v[184:187], a[144:147], v[192:195]
ds_read_b64_tr_b16 v[176:177], v231 offset:16384
v_mfma_f32_16x16x32_bf16 v[196:199], v[184:187], a[148:151], v[196:199]
ds_read_b64_tr_b16 v[178:179], v231 offset:18432
v_mfma_f32_16x16x32_bf16 v[200:203], v[184:187], a[152:155], v[200:203]
ds_read_b64_tr_b16 v[180:181], v234 offset:16384
v_mfma_f32_16x16x32_bf16 v[204:207], v[184:187], a[156:159], v[204:207]
ds_read_b64_tr_b16 v[182:183], v234 offset:18432
v_mfma_f32_16x16x32_bf16 v[208:211], v[188:191], a[144:147], v[208:211]
s_add_u32 m0, s73, 36864
s_nop 0
global_load_lds_dwordx4 v227, s[42:43]
v_mfma_f32_16x16x32_bf16 v[212:215], v[188:191], a[148:151], v[212:215]
v_add_u32 v226, s68, v224
v_mfma_f32_16x16x32_bf16 v[216:219], v[188:191], a[152:155], v[216:219]
v_mfma_f32_16x16x32_bf16 v[220:223], v[188:191], a[156:159], v[220:223]
s_waitcnt lgkmcnt(0)
s_waitcnt vmcnt(4)
s_barrier
v_mfma_f32_16x16x32_bf16 v[192:195], v[176:179], a[160:163], v[192:195]
ds_read_b64_tr_b16 v[184:185], v232 offset:24576
v_mfma_f32_16x16x32_bf16 v[196:199], v[176:179], a[164:167], v[196:199]
ds_read_b64_tr_b16 v[186:187], v232 offset:26624
v_mfma_f32_16x16x32_bf16 v[200:203], v[176:179], a[168:171], v[200:203]
ds_read_b64_tr_b16 v[188:189], v235 offset:24576
v_mfma_f32_16x16x32_bf16 v[204:207], v[176:179], a[172:175], v[204:207]
ds_read_b64_tr_b16 v[190:191], v235 offset:26624
v_mfma_f32_16x16x32_bf16 v[208:211], v[180:183], a[160:163], v[208:211]
s_add_u32 m0, s73, 40960
s_nop 0
global_load_lds_dwordx4 v226, s[42:43]
v_mfma_f32_16x16x32_bf16 v[212:215], v[180:183], a[164:167], v[212:215]
v_add_u32 v224, 128, v224
v_add_u32 v225, 128, v225
v_mfma_f32_16x16x32_bf16 v[216:219], v[180:183], a[168:171], v[216:219]
v_mfma_f32_16x16x32_bf16 v[220:223], v[180:183], a[172:175], v[220:223]
s_waitcnt lgkmcnt(0)
v_mfma_f32_16x16x32_bf16 v[48:51], v[184:187], a[0:3], 0
ds_read_b64_tr_b16 v[176:177], v232 offset:28672
v_cvt_pk_bf16_f32 v192, v192, v193
v_mfma_f32_16x16x32_bf16 v[52:55], v[184:187], a[4:7], 0
ds_read_b64_tr_b16 v[178:179], v232 offset:30720
v_cvt_pk_bf16_f32 v193, v194, v195
v_mfma_f32_16x16x32_bf16 v[56:59], v[184:187], a[8:11], 0
ds_read_b64_tr_b16 v[180:181], v235 offset:28672
v_cvt_pk_bf16_f32 v194, v208, v209
v_mfma_f32_16x16x32_bf16 v[60:63], v[184:187], a[12:15], 0
ds_read_b64_tr_b16 v[182:183], v235 offset:30720
v_cvt_pk_bf16_f32 v195, v210, v211
v_mfma_f32_16x16x32_bf16 v[64:67], v[188:191], a[0:3], 0
v_add_u32 v226, s60, v224
s_add_u32 m0, s73, 49152
v_mfma_f32_16x16x32_bf16 v[68:71], v[188:191], a[4:7], 0
global_load_lds_dwordx4 v226, s[42:43]
v_mfma_f32_16x16x32_bf16 v[72:75], v[188:191], a[8:11], 0
v_add_u32 v227, s61, v224
s_add_u32 m0, s73, 53248
v_mfma_f32_16x16x32_bf16 v[76:79], v[188:191], a[12:15], 0
s_add_u32 s77, s76, 0
v_mov_b32 v6, 0x00003f80
s_waitcnt lgkmcnt(0)
v_mfma_f32_16x16x32_bf16 v[48:51], v[176:179], a[16:19], v[48:51]
ds_read_b64_tr_b16 v[184:185], v232 offset:32768
v_mov_b32 v7, 0x3f800000
v_mfma_f32_16x16x32_bf16 v[52:55], v[176:179], a[20:23], v[52:55]
ds_read_b64_tr_b16 v[186:187], v232 offset:34816
v_lshlrev_b32 v8, 2, v2
v_mfma_f32_16x16x32_bf16 v[56:59], v[176:179], a[24:27], v[56:59]
ds_read_b64_tr_b16 v[188:189], v235 offset:32768
v_mov_b32 v9, 0x40000000
v_mfma_f32_16x16x32_bf16 v[60:63], v[176:179], a[28:31], v[60:63]
ds_read_b64_tr_b16 v[190:191], v235 offset:34816
v_mov_b32 v14, 0
v_mfma_f32_16x16x32_bf16 v[64:67], v[180:183], a[16:19], v[64:67]
global_load_lds_dwordx4 v227, s[42:43]
v_mfma_f32_16x16x32_bf16 v[68:71], v[180:183], a[20:23], v[68:71]
s_add_u32 m0, s73, 57344
s_nop 0
buffer_load_dwordx4 v225, s[16:19], s69 offen lds
v_mfma_f32_16x16x32_bf16 v[72:75], v[180:183], a[24:27], v[72:75]
s_add_u32 m0, s73, 61440
s_nop 0
buffer_load_dwordx4 v225, s[16:19], s70 offen lds
v_mfma_f32_16x16x32_bf16 v[76:79], v[180:183], a[28:31], v[76:79]
v_add_u32 v226, s62, v224
v_mov_b32 v10, s36
s_waitcnt lgkmcnt(0)
v_mfma_f32_16x16x32_bf16 v[48:51], v[184:187], a[32:35], v[48:51]
ds_read_b64_tr_b16 v[176:177], v232 offset:36864
s_lshl_b32 s41, s54, 2
v_mfma_f32_16x16x32_bf16 v[52:55], v[184:187], a[36:39], v[52:55]
ds_read_b64_tr_b16 v[178:179], v232 offset:38912
s_add_u32 s41, s41, s37
v_mfma_f32_16x16x32_bf16 v[56:59], v[184:187], a[40:43], v[56:59]
ds_read_b64_tr_b16 v[180:181], v235 offset:36864
s_lshr_b32 s3, s54, 1
v_mfma_f32_16x16x32_bf16 v[60:63], v[184:187], a[44:47], v[60:63]
ds_read_b64_tr_b16 v[182:183], v235 offset:38912
s_lshl_b32 s3, s3, 4
v_mfma_f32_16x16x32_bf16 v[64:67], v[188:191], a[32:35], v[64:67]
s_add_u32 m0, s73, 65536
s_nop 0
global_load_lds_dwordx4 v226, s[42:43]
v_mfma_f32_16x16x32_bf16 v[68:71], v[188:191], a[36:39], v[68:71]
v_add_u32 v227, s63, v224
s_add_u32 m0, s73, 69632
v_mfma_f32_16x16x32_bf16 v[72:75], v[188:191], a[40:43], v[72:75]
global_load_lds_dwordx4 v227, s[42:43]
v_mfma_f32_16x16x32_bf16 v[76:79], v[188:191], a[44:47], v[76:79]
buffer_store_dwordx4 v[192:195], v11, s[28:31], s77 offen sc1
s_waitcnt lgkmcnt(0)
v_mfma_f32_16x16x32_bf16 v[48:51], v[176:179], a[48:51], v[48:51]
ds_read_b64_tr_b16 v[184:185], v232 offset:40960
v_cvt_pk_bf16_f32 v196, v196, v197
v_mfma_f32_16x16x32_bf16 v[52:55], v[176:179], a[52:55], v[52:55]
ds_read_b64_tr_b16 v[186:187], v232 offset:43008
v_cvt_pk_bf16_f32 v197, v198, v199
v_mfma_f32_16x16x32_bf16 v[56:59], v[176:179], a[56:59], v[56:59]
ds_read_b64_tr_b16 v[188:189], v235 offset:40960
v_cvt_pk_bf16_f32 v198, v212, v213
v_mfma_f32_16x16x32_bf16 v[60:63], v[176:179], a[60:63], v[60:63]
ds_read_b64_tr_b16 v[190:191], v235 offset:43008
v_cvt_pk_bf16_f32 v199, v214, v215
v_mfma_f32_16x16x32_bf16 v[64:67], v[180:183], a[48:51], v[64:67]
v_add_u32 v226, s64, v224
s_add_u32 m0, s73, 73728
v_mfma_f32_16x16x32_bf16 v[68:71], v[180:183], a[52:55], v[68:71]
global_load_lds_dwordx4 v226, s[42:43]
v_mfma_f32_16x16x32_bf16 v[72:75], v[180:183], a[56:59], v[72:75]
v_add_u32 v227, s65, v224
s_add_u32 m0, s73, 77824
v_mfma_f32_16x16x32_bf16 v[76:79], v[180:183], a[60:63], v[76:79]
global_load_lds_dwordx4 v227, s[42:43]
s_waitcnt lgkmcnt(0)
v_mfma_f32_16x16x32_bf16 v[48:51], v[184:187], a[64:67], v[48:51]
ds_read_b64_tr_b16 v[176:177], v232 offset:45056
s_add_u32 s77, s76, 32768
v_mfma_f32_16x16x32_bf16 v[52:55], v[184:187], a[68:71], v[52:55]
ds_read_b64_tr_b16 v[178:179], v232 offset:47104
s_add_u32 s3, s3, s55
v_mfma_f32_16x16x32_bf16 v[56:59], v[184:187], a[72:75], v[56:59]
ds_read_b64_tr_b16 v[180:181], v235 offset:45056
v_add_u32 v4, s3, v2
v_mfma_f32_16x16x32_bf16 v[60:63], v[184:187], a[76:79], v[60:63]
ds_read_b64_tr_b16 v[182:183], v235 offset:47104
v_mul_u32_u24 v4, 1152, v4
v_mfma_f32_16x16x32_bf16 v[64:67], v[188:191], a[64:67], v[64:67]
v_add_u32 v226, s66, v224
s_add_u32 m0, s73, 81920
v_mfma_f32_16x16x32_bf16 v[68:71], v[188:191], a[68:71], v[68:71]
global_load_lds_dwordx4 v226, s[42:43]
v_mfma_f32_16x16x32_bf16 v[72:75], v[188:191], a[72:75], v[72:75]
v_add_u32 v227, s67, v224
s_add_u32 m0, s73, 86016
v_mfma_f32_16x16x32_bf16 v[76:79], v[188:191], a[76:79], v[76:79]
buffer_store_dwordx4 v[196:199], v11, s[28:31], s77 offen sc1
s_waitcnt lgkmcnt(0)
s_waitcnt vmcnt(11)
s_barrier
v_mfma_f32_16x16x32_bf16 v[48:51], v[176:179], a[80:83], v[48:51]
ds_read_b64_tr_b16 v[184:185], v230 offset:24576
v_cvt_pk_bf16_f32 v200, v200, v201
v_mfma_f32_16x16x32_bf16 v[52:55], v[176:179], a[84:87], v[52:55]
ds_read_b64_tr_b16 v[186:187], v230 offset:26624
v_cvt_pk_bf16_f32 v201, v202, v203
v_mfma_f32_16x16x32_bf16 v[56:59], v[176:179], a[88:91], v[56:59]
ds_read_b64_tr_b16 v[188:189], v233 offset:24576
v_cvt_pk_bf16_f32 v202, v216, v217
v_mfma_f32_16x16x32_bf16 v[60:63], v[176:179], a[92:95], v[60:63]
ds_read_b64_tr_b16 v[190:191], v233 offset:26624
v_cvt_pk_bf16_f32 v203, v218, v219
v_mfma_f32_16x16x32_bf16 v[64:67], v[180:183], a[80:83], v[64:67]
global_load_lds_dwordx4 v227, s[42:43]
v_mfma_f32_16x16x32_bf16 v[68:71], v[180:183], a[84:87], v[68:71]
v_add_u32 v226, s68, v224
s_add_u32 m0, s73, 90112
v_mfma_f32_16x16x32_bf16 v[72:75], v[180:183], a[88:91], v[72:75]
global_load_lds_dwordx4 v226, s[42:43]
v_mfma_f32_16x16x32_bf16 v[76:79], v[180:183], a[92:95], v[76:79]
v_add_u32 v224, 128, v224
v_add_u32 v225, 128, v225
s_waitcnt lgkmcnt(0)
v_mfma_f32_16x16x32_bf16 v[48:51], v[184:187], a[96:99], v[48:51]
ds_read_b64_tr_b16 v[176:177], v230 offset:28672
s_add_u32 s77, s76, 65536
v_mfma_f32_16x16x32_bf16 v[52:55], v[184:187], a[100:103], v[52:55]
ds_read_b64_tr_b16 v[178:179], v230 offset:30720
s_and_b32 s3, s54, 1
v_mfma_f32_16x16x32_bf16 v[56:59], v[184:187], a[104:107], v[56:59]
ds_read_b64_tr_b16 v[180:181], v233 offset:28672
s_lshl_b32 s3, s3, 6
v_mfma_f32_16x16x32_bf16 v[60:63], v[184:187], a[108:111], v[60:63]
ds_read_b64_tr_b16 v[182:183], v233 offset:30720
v_add_u32 v4, s3, v4
v_mfma_f32_16x16x32_bf16 v[64:67], v[188:191], a[96:99], v[64:67]
v_add_u32 v226, s60, v224
s_add_u32 m0, s73, 98304
v_mfma_f32_16x16x32_bf16 v[68:71], v[188:191], a[100:103], v[68:71]
global_load_lds_dwordx4 v226, s[42:43]
v_mfma_f32_16x16x32_bf16 v[72:75], v[188:191], a[104:107], v[72:75]
v_add_u32 v227, s61, v224
s_add_u32 m0, s73, 102400
v_mfma_f32_16x16x32_bf16 v[76:79], v[188:191], a[108:111], v[76:79]
global_load_lds_dwordx4 v227, s[42:43]
s_waitcnt lgkmcnt(0)
v_mfma_f32_16x16x32_bf16 v[48:51], v[176:179], a[112:115], v[48:51]
ds_read_b64_tr_b16 v[184:185], v230 offset:32768
s_lshl_b32 s3, s50, 3
v_mfma_f32_16x16x32_bf16 v[52:55], v[176:179], a[116:119], v[52:55]
ds_read_b64_tr_b16 v[186:187], v230 offset:34816
v_add_u32 v5, s3, v4
v_mfma_f32_16x16x32_bf16 v[56:59], v[176:179], a[120:123], v[56:59]
ds_read_b64_tr_b16 v[188:189], v233 offset:32768
v_lshl_add_u32 v4, v3, 3, v4
v_mfma_f32_16x16x32_bf16 v[60:63], v[176:179], a[124:127], v[60:63]
ds_read_b64_tr_b16 v[190:191], v233 offset:34816
s_mul_i32 s48, s53, 2359296
v_mfma_f32_16x16x32_bf16 v[64:67], v[180:183], a[112:115], v[64:67]
s_add_u32 m0, s73, 106496
s_nop 0
buffer_load_dwordx4 v225, s[16:19], s69 offen lds
v_mfma_f32_16x16x32_bf16 v[68:71], v[180:183], a[116:119], v[68:71]
s_add_u32 m0, s73, 110592
s_nop 0
buffer_load_dwordx4 v225, s[16:19], s70 offen lds
v_mfma_f32_16x16x32_bf16 v[72:75], v[180:183], a[120:123], v[72:75]
v_add_u32 v226, s62, v224
s_add_u32 m0, s73, 114688
v_mfma_f32_16x16x32_bf16 v[76:79], v[180:183], a[124:127], v[76:79]
global_load_lds_dwordx4 v226, s[42:43]
s_waitcnt lgkmcnt(0)
v_mfma_f32_16x16x32_bf16 v[48:51], v[184:187], a[128:131], v[48:51]
ds_read_b64_tr_b16 v[176:177], v230 offset:36864
s_lshl_b32 s3, s54, 14
v_mfma_f32_16x16x32_bf16 v[52:55], v[184:187], a[132:135], v[52:55]
ds_read_b64_tr_b16 v[178:179], v230 offset:38912
s_add_u32 s48, s48, s3
v_mfma_f32_16x16x32_bf16 v[56:59], v[184:187], a[136:139], v[56:59]
ds_read_b64_tr_b16 v[180:181], v233 offset:36864
v_cmp_eq_u32 vcc, 0, v0
s_nop 1
v_cndmask_b32 v3, v9, v14, vcc
v_mfma_f32_16x16x32_bf16 v[60:63], v[184:187], a[140:143], v[60:63]
ds_read_b64_tr_b16 v[182:183], v233 offset:38912
v_cmp_eq_u32 s[92:93], s54, v2
v_mfma_f32_16x16x32_bf16 v[64:67], v[188:191], a[128:131], v[64:67]
v_add_u32 v227, s63, v224
s_add_u32 m0, s73, 118784
v_mfma_f32_16x16x32_bf16 v[68:71], v[188:191], a[132:135], v[68:71]
global_load_lds_dwordx4 v227, s[42:43]
v_mfma_f32_16x16x32_bf16 v[72:75], v[188:191], a[136:139], v[72:75]
v_add_u32 v226, s64, v224
s_add_u32 m0, s73, 0
v_mfma_f32_16x16x32_bf16 v[76:79], v[188:191], a[140:143], v[76:79]
global_load_lds_dwordx4 v226, s[42:43]
s_waitcnt lgkmcnt(0)
v_mfma_f32_16x16x32_bf16 v[48:51], v[176:179], a[144:147], v[48:51]
ds_read_b64_tr_b16 v[184:185], v230 offset:40960
v_mfma_f32_16x16x32_bf16 v[52:55], v[176:179], a[148:151], v[52:55]
ds_read_b64_tr_b16 v[186:187], v230 offset:43008
v_mfma_f32_16x16x32_bf16 v[56:59], v[176:179], a[152:155], v[56:59]
ds_read_b64_tr_b16 v[188:189], v233 offset:40960
v_mfma_f32_16x16x32_bf16 v[60:63], v[176:179], a[156:159], v[60:63]
ds_read_b64_tr_b16 v[190:191], v233 offset:43008
v_mfma_f32_16x16x32_bf16 v[64:67], v[180:183], a[144:147], v[64:67]
v_add_u32 v227, s65, v224
s_add_u32 m0, s73, 4096
v_mfma_f32_16x16x32_bf16 v[68:71], v[180:183], a[148:151], v[68:71]
global_load_lds_dwordx4 v227, s[42:43]
v_mfma_f32_16x16x32_bf16 v[72:75], v[180:183], a[152:155], v[72:75]
v_add_u32 v226, s66, v224
s_add_u32 m0, s73, 8192
v_mfma_f32_16x16x32_bf16 v[76:79], v[180:183], a[156:159], v[76:79]
global_load_lds_dwordx4 v226, s[42:43]
s_waitcnt lgkmcnt(0)
s_waitcnt vmcnt(16)
s_barrier
v_mfma_f32_16x16x32_bf16 v[48:51], v[184:187], a[160:163], v[48:51]
ds_read_b64_tr_b16 v[176:177], v231 offset:0
v_mfma_f32_16x16x32_bf16 v[52:55], v[184:187], a[164:167], v[52:55]
ds_read_b64_tr_b16 v[178:179], v231 offset:2048
v_mfma_f32_16x16x32_bf16 v[56:59], v[184:187], a[168:171], v[56:59]
ds_read_b64_tr_b16 v[180:181], v234 offset:0
v_mfma_f32_16x16x32_bf16 v[60:63], v[184:187], a[172:175], v[60:63]
ds_read_b64_tr_b16 v[182:183], v234 offset:2048
v_mfma_f32_16x16x32_bf16 v[64:67], v[188:191], a[160:163], v[64:67]
v_add_u32 v227, s67, v224
s_add_u32 m0, s73, 12288
v_mfma_f32_16x16x32_bf16 v[68:71], v[188:191], a[164:167], v[68:71]
global_load_lds_dwordx4 v227, s[42:43]
v_mfma_f32_16x16x32_bf16 v[72:75], v[188:191], a[168:171], v[72:75]
v_add_u32 v226, s68, v224
s_add_u32 m0, s73, 16384
v_mfma_f32_16x16x32_bf16 v[76:79], v[188:191], a[172:175], v[76:79]
global_load_lds_dwordx4 v226, s[42:43]
v_add_u32 v224, 128, v224
v_add_u32 v225, 128, v225
buffer_store_dwordx4 v[200:203], v11, s[28:31], s77 offen sc1
v_cvt_pk_bf16_f32 v204, v204, v205
v_cvt_pk_bf16_f32 v205, v206, v207
v_cvt_pk_bf16_f32 v206, v220, v221
v_cvt_pk_bf16_f32 v207, v222, v223
s_add_u32 s77, s76, 98304
buffer_store_dwordx4 v[204:207], v11, s[28:31], s77 offen sc1
s_waitcnt lgkmcnt(0)
v_mfma_f32_16x16x32_bf16 v[112:115], v[176:179], a[0:3], 0
ds_read_b64_tr_b16 v[184:185], v231 offset:4096
v_cvt_pk_bf16_f32 v48, v48, v49
v_mfma_f32_16x16x32_bf16 v[116:119], v[176:179], a[4:7], 0
ds_read_b64_tr_b16 v[186:187], v231 offset:6144
v_cvt_pk_bf16_f32 v49, v50, v51
v_mfma_f32_16x16x32_bf16 v[120:123], v[176:179], a[8:11], 0
ds_read_b64_tr_b16 v[188:189], v234 offset:4096
v_cvt_pk_bf16_f32 v50, v64, v65
v_mfma_f32_16x16x32_bf16 v[124:127], v[176:179], a[12:15], 0
ds_read_b64_tr_b16 v[190:191], v234 offset:6144
v_cvt_pk_bf16_f32 v51, v66, v67
v_mfma_f32_16x16x32_bf16 v[128:131], v[180:183], a[0:3], 0
v_add_u32 v226, s60, v224
s_add_u32 m0, s73, 122880
v_mfma_f32_16x16x32_bf16 v[132:135], v[180:183], a[4:7], 0
s_add_u32 s77, s76, 262144
v_mfma_f32_16x16x32_bf16 v[136:139], v[180:183], a[8:11], 0
buffer_store_dwordx4 v[48:51], v11, s[28:31], s77 offen sc1
v_mfma_f32_16x16x32_bf16 v[140:143], v[180:183], a[12:15], 0
v_cvt_pk_bf16_f32 v52, v52, v53
v_cvt_pk_bf16_f32 v53, v54, v55
s_waitcnt lgkmcnt(0)
v_mfma_f32_16x16x32_bf16 v[112:115], v[184:187], a[16:19], v[112:115]
ds_read_b64_tr_b16 v[176:177], v231 offset:8192
v_cvt_pk_bf16_f32 v54, v68, v69
v_mfma_f32_16x16x32_bf16 v[116:119], v[184:187], a[20:23], v[116:119]
ds_read_b64_tr_b16 v[178:179], v231 offset:10240
v_cvt_pk_bf16_f32 v55, v70, v71
v_mfma_f32_16x16x32_bf16 v[120:123], v[184:187], a[24:27], v[120:123]
ds_read_b64_tr_b16 v[180:181], v234 offset:8192
s_add_u32 s77, s76, 294912
v_mfma_f32_16x16x32_bf16 v[124:127], v[184:187], a[28:31], v[124:127]
ds_read_b64_tr_b16 v[182:183], v234 offset:10240
v_mfma_f32_16x16x32_bf16 v[128:131], v[188:191], a[16:19], v[128:131]
global_load_lds_dwordx4 v226, s[42:43]
v_mfma_f32_16x16x32_bf16 v[132:135], v[188:191], a[20:23], v[132:135]
v_add_u32 v227, s61, v224
s_add_u32 m0, s73, 126976
v_mfma_f32_16x16x32_bf16 v[136:139], v[188:191], a[24:27], v[136:139]
buffer_store_dwordx4 v[52:55], v11, s[28:31], s77 offen sc1
v_mfma_f32_16x16x32_bf16 v[140:143], v[188:191], a[28:31], v[140:143]
v_cvt_pk_bf16_f32 v56, v56, v57
v_cvt_pk_bf16_f32 v57, v58, v59
s_waitcnt lgkmcnt(0)
v_mfma_f32_16x16x32_bf16 v[112:115], v[176:179], a[32:35], v[112:115]
ds_read_b64_tr_b16 v[184:185], v231 offset:12288
v_cvt_pk_bf16_f32 v58, v72, v73
v_mfma_f32_16x16x32_bf16 v[116:119], v[176:179], a[36:39], v[116:119]
ds_read_b64_tr_b16 v[186:187], v231 offset:14336
v_cvt_pk_bf16_f32 v59, v74, v75
v_mfma_f32_16x16x32_bf16 v[120:123], v[176:179], a[40:43], v[120:123]
ds_read_b64_tr_b16 v[188:189], v234 offset:12288
s_add_u32 s77, s76, 327680
v_mfma_f32_16x16x32_bf16 v[124:127], v[176:179], a[44:47], v[124:127]
ds_read_b64_tr_b16 v[190:191], v234 offset:14336
v_mfma_f32_16x16x32_bf16 v[128:131], v[180:183], a[32:35], v[128:131]
global_load_lds_dwordx4 v227, s[42:43]
v_mfma_f32_16x16x32_bf16 v[132:135], v[180:183], a[36:39], v[132:135]
s_add_u32 m0, s73, 131072
s_nop 0
buffer_load_dwordx4 v225, s[16:19], s69 offen lds
v_mfma_f32_16x16x32_bf16 v[136:139], v[180:183], a[40:43], v[136:139]
buffer_store_dwordx4 v[56:59], v11, s[28:31], s77 offen sc1
v_mfma_f32_16x16x32_bf16 v[140:143], v[180:183], a[44:47], v[140:143]
v_cvt_pk_bf16_f32 v60, v60, v61
v_cvt_pk_bf16_f32 v61, v62, v63
s_waitcnt lgkmcnt(0)
v_mfma_f32_16x16x32_bf16 v[112:115], v[184:187], a[48:51], v[112:115]
ds_read_b64_tr_b16 v[176:177], v231 offset:16384
v_cvt_pk_bf16_f32 v62, v76, v77
v_mfma_f32_16x16x32_bf16 v[116:119], v[184:187], a[52:55], v[116:119]
ds_read_b64_tr_b16 v[178:179], v231 offset:18432
v_cvt_pk_bf16_f32 v63, v78, v79
v_mfma_f32_16x16x32_bf16 v[120:123], v[184:187], a[56:59], v[120:123]
ds_read_b64_tr_b16 v[180:181], v234 offset:16384
s_add_u32 s77, s76, 360448
v_mfma_f32_16x16x32_bf16 v[124:127], v[184:187], a[60:63], v[124:127]
ds_read_b64_tr_b16 v[182:183], v234 offset:18432
v_mfma_f32_16x16x32_bf16 v[128:131], v[188:191], a[48:51], v[128:131]
s_add_u32 m0, s73, 135168
s_nop 0
buffer_load_dwordx4 v225, s[16:19], s70 offen lds
v_mfma_f32_16x16x32_bf16 v[132:135], v[188:191], a[52:55], v[132:135]
buffer_store_dwordx4 v[60:63], v11, s[28:31], s77 offen sc1
v_mfma_f32_16x16x32_bf16 v[136:139], v[188:191], a[56:59], v[136:139]
v_mfma_f32_16x16x32_bf16 v[140:143], v[188:191], a[60:63], v[140:143]
s_waitcnt lgkmcnt(0)
v_mfma_f32_16x16x32_bf16 v[112:115], v[176:179], a[64:67], v[112:115]
ds_read_b64_tr_b16 v[184:185], v231 offset:20480
v_mfma_f32_16x16x32_bf16 v[116:119], v[176:179], a[68:71], v[116:119]
ds_read_b64_tr_b16 v[186:187], v231 offset:22528
v_mfma_f32_16x16x32_bf16 v[120:123], v[176:179], a[72:75], v[120:123]
ds_read_b64_tr_b16 v[188:189], v234 offset:20480
v_mfma_f32_16x16x32_bf16 v[124:127], v[176:179], a[76:79], v[124:127]
ds_read_b64_tr_b16 v[190:191], v234 offset:22528
v_mfma_f32_16x16x32_bf16 v[128:131], v[180:183], a[64:67], v[128:131]
v_add_u32 v226, s62, v224
s_add_u32 m0, s73, 139264
v_mfma_f32_16x16x32_bf16 v[132:135], v[180:183], a[68:71], v[132:135]
global_load_lds_dwordx4 v226, s[42:43]
v_mfma_f32_16x16x32_bf16 v[136:139], v[180:183], a[72:75], v[136:139]
v_mfma_f32_16x16x32_bf16 v[140:143], v[180:183], a[76:79], v[140:143]
s_waitcnt lgkmcnt(0)
s_waitcnt vmcnt(22)
s_barrier
v_mfma_f32_16x16x32_bf16 v[112:115], v[184:187], a[80:83], v[112:115]
ds_read_b64_tr_b16 v[176:177], v231 offset:24576
v_mfma_f32_16x16x32_bf16 v[116:119], v[184:187], a[84:87], v[116:119]
ds_read_b64_tr_b16 v[178:179], v231 offset:26624
v_mfma_f32_16x16x32_bf16 v[120:123], v[184:187], a[88:91], v[120:123]
ds_read_b64_tr_b16 v[180:181], v234 offset:24576
v_mfma_f32_16x16x32_bf16 v[124:127], v[184:187], a[92:95], v[124:127]
ds_read_b64_tr_b16 v[182:183], v234 offset:26624
v_mfma_f32_16x16x32_bf16 v[128:131], v[188:191], a[80:83], v[128:131]
v_add_u32 v227, s63, v224
s_add_u32 m0, s73, 143360
v_mfma_f32_16x16x32_bf16 v[132:135], v[188:191], a[84:87], v[132:135]
global_load_lds_dwordx4 v227, s[42:43]
v_mfma_f32_16x16x32_bf16 v[136:139], v[188:191], a[88:91], v[136:139]
v_mfma_f32_16x16x32_bf16 v[140:143], v[188:191], a[92:95], v[140:143]
s_waitcnt lgkmcnt(0)
v_mfma_f32_16x16x32_bf16 v[112:115], v[176:179], a[96:99], v[112:115]
ds_read_b64_tr_b16 v[184:185], v231 offset:28672
v_mfma_f32_16x16x32_bf16 v[116:119], v[176:179], a[100:103], v[116:119]
ds_read_b64_tr_b16 v[186:187], v231 offset:30720
v_mfma_f32_16x16x32_bf16 v[120:123], v[176:179], a[104:107], v[120:123]
ds_read_b64_tr_b16 v[188:189], v234 offset:28672
v_mfma_f32_16x16x32_bf16 v[124:127], v[176:179], a[108:111], v[124:127]
ds_read_b64_tr_b16 v[190:191], v234 offset:30720
v_mfma_f32_16x16x32_bf16 v[128:131], v[180:183], a[96:99], v[128:131]
v_add_u32 v226, s64, v224
s_add_u32 m0, s73, 24576
v_mfma_f32_16x16x32_bf16 v[132:135], v[180:183], a[100:103], v[132:135]
global_load_lds_dwordx4 v226, s[42:43]
v_mfma_f32_16x16x32_bf16 v[136:139], v[180:183], a[104:107], v[136:139]
v_mfma_f32_16x16x32_bf16 v[140:143], v[180:183], a[108:111], v[140:143]
s_waitcnt lgkmcnt(0)
v_mfma_f32_16x16x32_bf16 v[112:115], v[184:187], a[112:115], v[112:115]
ds_read_b64_tr_b16 v[176:177], v231 offset:32768
v_mfma_f32_16x16x32_bf16 v[116:119], v[184:187], a[116:119], v[116:119]
ds_read_b64_tr_b16 v[178:179], v231 offset:34816
v_mfma_f32_16x16x32_bf16 v[120:123], v[184:187], a[120:123], v[120:123]
ds_read_b64_tr_b16 v[180:181], v234 offset:32768
v_mfma_f32_16x16x32_bf16 v[124:127], v[184:187], a[124:127], v[124:127]
ds_read_b64_tr_b16 v[182:183], v234 offset:34816
v_mfma_f32_16x16x32_bf16 v[128:131], v[188:191], a[112:115], v[128:131]
v_add_u32 v227, s65, v224
s_add_u32 m0, s73, 28672
v_mfma_f32_16x16x32_bf16 v[132:135], v[188:191], a[116:119], v[132:135]
global_load_lds_dwordx4 v227, s[42:43]
v_mfma_f32_16x16x32_bf16 v[136:139], v[188:191], a[120:123], v[136:139]
v_mfma_f32_16x16x32_bf16 v[140:143], v[188:191], a[124:127], v[140:143]
s_waitcnt lgkmcnt(0)
v_mfma_f32_16x16x32_bf16 v[112:115], v[176:179], a[128:131], v[112:115]
ds_read_b64_tr_b16 v[184:185], v231 offset:36864
v_mfma_f32_16x16x32_bf16 v[116:119], v[176:179], a[132:135], v[116:119]
ds_read_b64_tr_b16 v[186:187], v231 offset:38912
v_mfma_f32_16x16x32_bf16 v[120:123], v[176:179], a[136:139], v[120:123]
ds_read_b64_tr_b16 v[188:189], v234 offset:36864
v_mfma_f32_16x16x32_bf16 v[124:127], v[176:179], a[140:143], v[124:127]
ds_read_b64_tr_b16 v[190:191], v234 offset:38912
v_mfma_f32_16x16x32_bf16 v[128:131], v[180:183], a[128:131], v[128:131]
v_add_u32 v226, s66, v224
s_add_u32 m0, s73, 32768
v_mfma_f32_16x16x32_bf16 v[132:135], v[180:183], a[132:135], v[132:135]
global_load_lds_dwordx4 v226, s[42:43]
v_mfma_f32_16x16x32_bf16 v[136:139], v[180:183], a[136:139], v[136:139]
v_add_u32 v227, s67, v224
v_mfma_f32_16x16x32_bf16 v[140:143], v[180:183], a[140:143], v[140:143]
s_waitcnt lgkmcnt(0)
v_mfma_f32_16x16x32_bf16 v[112:115], v[184:187], a[144:147], v[112:115]
ds_read_b64_tr_b16 v[176:177], v231 offset:40960
v_mfma_f32_16x16x32_bf16 v[116:119], v[184:187], a[148:151], v[116:119]
ds_read_b64_tr_b16 v[178:179], v231 offset:43008
v_mfma_f32_16x16x32_bf16 v[120:123], v[184:187], a[152:155], v[120:123]
ds_read_b64_tr_b16 v[180:181], v234 offset:40960
v_mfma_f32_16x16x32_bf16 v[124:127], v[184:187], a[156:159], v[124:127]
ds_read_b64_tr_b16 v[182:183], v234 offset:43008
v_mfma_f32_16x16x32_bf16 v[128:131], v[188:191], a[144:147], v[128:131]
s_add_u32 m0, s73, 36864
s_nop 0
global_load_lds_dwordx4 v227, s[42:43]
v_mfma_f32_16x16x32_bf16 v[132:135], v[188:191], a[148:151], v[132:135]
v_add_u32 v226, s68, v224
v_mfma_f32_16x16x32_bf16 v[136:139], v[188:191], a[152:155], v[136:139]
v_mfma_f32_16x16x32_bf16 v[140:143], v[188:191], a[156:159], v[140:143]
s_waitcnt lgkmcnt(0)
s_waitcnt vmcnt(21)
s_barrier
v_mfma_f32_16x16x32_bf16 v[112:115], v[176:179], a[160:163], v[112:115]
ds_read_b64_tr_b16 v[184:185], v232 offset:0
v_mfma_f32_16x16x32_bf16 v[116:119], v[176:179], a[164:167], v[116:119]
ds_read_b64_tr_b16 v[186:187], v232 offset:2048
v_mfma_f32_16x16x32_bf16 v[120:123], v[176:179], a[168:171], v[120:123]
ds_read_b64_tr_b16 v[188:189], v235 offset:0
v_mfma_f32_16x16x32_bf16 v[124:127], v[176:179], a[172:175], v[124:127]
ds_read_b64_tr_b16 v[190:191], v235 offset:2048
v_mfma_f32_16x16x32_bf16 v[128:131], v[180:183], a[160:163], v[128:131]
s_add_u32 m0, s73, 40960
s_nop 0
global_load_lds_dwordx4 v226, s[42:43]
v_mfma_f32_16x16x32_bf16 v[132:135], v[180:183], a[164:167], v[132:135]
v_add_u32 v224, 128, v224
v_add_u32 v225, 128, v225
v_mfma_f32_16x16x32_bf16 v[136:139], v[180:183], a[168:171], v[136:139]
v_mfma_f32_16x16x32_bf16 v[140:143], v[180:183], a[172:175], v[140:143]
s_waitcnt lgkmcnt(0)
v_mfma_f32_16x16x32_bf16 v[48:51], v[184:187], a[0:3], 0
ds_read_b64_tr_b16 v[176:177], v232 offset:4096
v_cvt_pk_bf16_f32 v112, v112, v113
v_mfma_f32_16x16x32_bf16 v[52:55], v[184:187], a[4:7], 0
ds_read_b64_tr_b16 v[178:179], v232 offset:6144
v_cvt_pk_bf16_f32 v113, v114, v115
v_mfma_f32_16x16x32_bf16 v[56:59], v[184:187], a[8:11], 0
ds_read_b64_tr_b16 v[180:181], v235 offset:4096
v_cvt_pk_bf16_f32 v114, v128, v129
v_mfma_f32_16x16x32_bf16 v[60:63], v[184:187], a[12:15], 0
ds_read_b64_tr_b16 v[182:183], v235 offset:6144
v_cvt_pk_bf16_f32 v115, v130, v131
v_mfma_f32_16x16x32_bf16 v[64:67], v[188:191], a[0:3], 0
v_add_u32 v226, s60, v224
s_add_u32 m0, s73, 49152
v_mfma_f32_16x16x32_bf16 v[68:71], v[188:191], a[4:7], 0
s_add_u32 s77, s76, 524288
v_mfma_f32_16x16x32_bf16 v[72:75], v[188:191], a[8:11], 0
buffer_store_dwordx4 v[112:115], v11, s[28:31], s77 offen sc1
v_mfma_f32_16x16x32_bf16 v[76:79], v[188:191], a[12:15], 0
v_cvt_pk_bf16_f32 v116, v116, v117
v_cvt_pk_bf16_f32 v117, v118, v119
s_waitcnt lgkmcnt(0)
v_mfma_f32_16x16x32_bf16 v[48:51], v[176:179], a[16:19], v[48:51]
ds_read_b64_tr_b16 v[184:185], v232 offset:8192
v_cvt_pk_bf16_f32 v118, v132, v133
v_mfma_f32_16x16x32_bf16 v[52:55], v[176:179], a[20:23], v[52:55]
ds_read_b64_tr_b16 v[186:187], v232 offset:10240
v_cvt_pk_bf16_f32 v119, v134, v135
v_mfma_f32_16x16x32_bf16 v[56:59], v[176:179], a[24:27], v[56:59]
ds_read_b64_tr_b16 v[188:189], v235 offset:8192
s_add_u32 s77, s76, 557056
v_mfma_f32_16x16x32_bf16 v[60:63], v[176:179], a[28:31], v[60:63]
ds_read_b64_tr_b16 v[190:191], v235 offset:10240
v_mfma_f32_16x16x32_bf16 v[64:67], v[180:183], a[16:19], v[64:67]
global_load_lds_dwordx4 v226, s[42:43]
v_mfma_f32_16x16x32_bf16 v[68:71], v[180:183], a[20:23], v[68:71]
v_add_u32 v227, s61, v224
s_add_u32 m0, s73, 53248
v_mfma_f32_16x16x32_bf16 v[72:75], v[180:183], a[24:27], v[72:75]
buffer_store_dwordx4 v[116:119], v11, s[28:31], s77 offen sc1
v_mfma_f32_16x16x32_bf16 v[76:79], v[180:183], a[28:31], v[76:79]
v_cvt_pk_bf16_f32 v120, v120, v121
v_cvt_pk_bf16_f32 v121, v122, v123
s_waitcnt lgkmcnt(0)
v_mfma_f32_16x16x32_bf16 v[48:51], v[184:187], a[32:35], v[48:51]
ds_read_b64_tr_b16 v[176:177], v232 offset:12288
v_cvt_pk_bf16_f32 v122, v136, v137
v_mfma_f32_16x16x32_bf16 v[52:55], v[184:187], a[36:39], v[52:55]
ds_read_b64_tr_b16 v[178:179], v232 offset:14336
v_cvt_pk_bf16_f32 v123, v138, v139
v_mfma_f32_16x16x32_bf16 v[56:59], v[184:187], a[40:43], v[56:59]
ds_read_b64_tr_b16 v[180:181], v235 offset:12288
s_add_u32 s77, s76, 589824
v_mfma_f32_16x16x32_bf16 v[60:63], v[184:187], a[44:47], v[60:63]
ds_read_b64_tr_b16 v[182:183], v235 offset:14336
v_mfma_f32_16x16x32_bf16 v[64:67], v[188:191], a[32:35], v[64:67]
global_load_lds_dwordx4 v227, s[42:43]
v_mfma_f32_16x16x32_bf16 v[68:71], v[188:191], a[36:39], v[68:71]
s_add_u32 m0, s73, 57344
s_nop 0
buffer_load_dwordx4 v225, s[16:19], s69 offen lds
v_mfma_f32_16x16x32_bf16 v[72:75], v[188:191], a[40:43], v[72:75]
buffer_store_dwordx4 v[120:123], v11, s[28:31], s77 offen sc1
v_mfma_f32_16x16x32_bf16 v[76:79], v[188:191], a[44:47], v[76:79]
v_cvt_pk_bf16_f32 v124, v124, v125
v_cvt_pk_bf16_f32 v125, v126, v127
s_waitcnt lgkmcnt(0)
v_mfma_f32_16x16x32_bf16 v[48:51], v[176:179], a[48:51], v[48:51]
ds_read_b64_tr_b16 v[184:185], v232 offset:16384
v_cvt_pk_bf16_f32 v126, v140, v141
v_mfma_f32_16x16x32_bf16 v[52:55], v[176:179], a[52:55], v[52:55]
ds_read_b64_tr_b16 v[186:187], v232 offset:18432
v_cvt_pk_bf16_f32 v127, v142, v143
v_mfma_f32_16x16x32_bf16 v[56:59], v[176:179], a[56:59], v[56:59]
ds_read_b64_tr_b16 v[188:189], v235 offset:16384
s_add_u32 s77, s76, 622592
v_mfma_f32_16x16x32_bf16 v[60:63], v[176:179], a[60:63], v[60:63]
ds_read_b64_tr_b16 v[190:191], v235 offset:18432
v_mfma_f32_16x16x32_bf16 v[64:67], v[180:183], a[48:51], v[64:67]
s_add_u32 m0, s73, 61440
s_nop 0
buffer_load_dwordx4 v225, s[16:19], s70 offen lds
v_mfma_f32_16x16x32_bf16 v[68:71], v[180:183], a[52:55], v[68:71]
buffer_store_dwordx4 v[124:127], v11, s[28:31], s77 offen sc1
v_mfma_f32_16x16x32_bf16 v[72:75], v[180:183], a[56:59], v[72:75]
v_mfma_f32_16x16x32_bf16 v[76:79], v[180:183], a[60:63], v[76:79]
s_waitcnt lgkmcnt(0)
v_mfma_f32_16x16x32_bf16 v[48:51], v[184:187], a[64:67], v[48:51]
ds_read_b64_tr_b16 v[176:177], v232 offset:20480
v_mfma_f32_16x16x32_bf16 v[52:55], v[184:187], a[68:71], v[52:55]
ds_read_b64_tr_b16 v[178:179], v232 offset:22528
v_mfma_f32_16x16x32_bf16 v[56:59], v[184:187], a[72:75], v[56:59]
ds_read_b64_tr_b16 v[180:181], v235 offset:20480
v_mfma_f32_16x16x32_bf16 v[60:63], v[184:187], a[76:79], v[60:63]
ds_read_b64_tr_b16 v[182:183], v235 offset:22528
v_mfma_f32_16x16x32_bf16 v[64:67], v[188:191], a[64:67], v[64:67]
v_add_u32 v226, s62, v224
s_add_u32 m0, s73, 65536
v_mfma_f32_16x16x32_bf16 v[68:71], v[188:191], a[68:71], v[68:71]
global_load_lds_dwordx4 v226, s[42:43]
v_mfma_f32_16x16x32_bf16 v[72:75], v[188:191], a[72:75], v[72:75]
v_mfma_f32_16x16x32_bf16 v[76:79], v[188:191], a[76:79], v[76:79]
s_waitcnt lgkmcnt(0)
s_waitcnt vmcnt(26)
s_waitcnt vmcnt(24)
s_barrier
s_add_u32 s40, s41, 0
buffer_store_dword v10, v3, s[28:31], s40 offen sc1
v_mfma_f32_16x16x32_bf16 v[48:51], v[176:179], a[80:83], v[48:51]
ds_read_b64_tr_b16 v[184:185], v230 offset:0
v_mfma_f32_16x16x32_bf16 v[52:55], v[176:179], a[84:87], v[52:55]
ds_read_b64_tr_b16 v[186:187], v230 offset:2048
v_mfma_f32_16x16x32_bf16 v[56:59], v[176:179], a[88:91], v[56:59]
ds_read_b64_tr_b16 v[188:189], v233 offset:0
v_mfma_f32_16x16x32_bf16 v[60:63], v[176:179], a[92:95], v[60:63]
ds_read_b64_tr_b16 v[190:191], v233 offset:2048
v_mfma_f32_16x16x32_bf16 v[64:67], v[180:183], a[80:83], v[64:67]
v_add_u32 v227, s63, v224
s_add_u32 m0, s73, 69632
v_mfma_f32_16x16x32_bf16 v[68:71], v[180:183], a[84:87], v[68:71]
global_load_lds_dwordx4 v227, s[42:43]
v_mfma_f32_16x16x32_bf16 v[72:75], v[180:183], a[88:91], v[72:75]
v_mfma_f32_16x16x32_bf16 v[76:79], v[180:183], a[92:95], v[76:79]
s_waitcnt lgkmcnt(0)
v_mfma_f32_16x16x32_bf16 v[48:51], v[184:187], a[96:99], v[48:51]
ds_read_b64_tr_b16 v[176:177], v230 offset:4096
v_mfma_f32_16x16x32_bf16 v[52:55], v[184:187], a[100:103], v[52:55]
ds_read_b64_tr_b16 v[178:179], v230 offset:6144
v_mfma_f32_16x16x32_bf16 v[56:59], v[184:187], a[104:107], v[56:59]
ds_read_b64_tr_b16 v[180:181], v233 offset:4096
v_mfma_f32_16x16x32_bf16 v[60:63], v[184:187], a[108:111], v[60:63]
ds_read_b64_tr_b16 v[182:183], v233 offset:6144
v_mfma_f32_16x16x32_bf16 v[64:67], v[188:191], a[96:99], v[64:67]
v_add_u32 v226, s64, v224
s_add_u32 m0, s73, 73728
v_mfma_f32_16x16x32_bf16 v[68:71], v[188:191], a[100:103], v[68:71]
global_load_lds_dwordx4 v226, s[42:43]
v_mfma_f32_16x16x32_bf16 v[72:75], v[188:191], a[104:107], v[72:75]
v_mfma_f32_16x16x32_bf16 v[76:79], v[188:191], a[108:111], v[76:79]
s_waitcnt lgkmcnt(0)
v_mfma_f32_16x16x32_bf16 v[48:51], v[176:179], a[112:115], v[48:51]
ds_read_b64_tr_b16 v[184:185], v230 offset:8192
v_mfma_f32_16x16x32_bf16 v[52:55], v[176:179], a[116:119], v[52:55]
ds_read_b64_tr_b16 v[186:187], v230 offset:10240
v_mfma_f32_16x16x32_bf16 v[56:59], v[176:179], a[120:123], v[56:59]
ds_read_b64_tr_b16 v[188:189], v233 offset:8192
v_mfma_f32_16x16x32_bf16 v[60:63], v[176:179], a[124:127], v[60:63]
ds_read_b64_tr_b16 v[190:191], v233 offset:10240
v_mfma_f32_16x16x32_bf16 v[64:67], v[180:183], a[112:115], v[64:67]
v_add_u32 v227, s65, v224
s_add_u32 m0, s73, 77824
v_mfma_f32_16x16x32_bf16 v[68:71], v[180:183], a[116:119], v[68:71]
global_load_lds_dwordx4 v227, s[42:43]
v_mfma_f32_16x16x32_bf16 v[72:75], v[180:183], a[120:123], v[72:75]
v_mfma_f32_16x16x32_bf16 v[76:79], v[180:183], a[124:127], v[76:79]
s_waitcnt lgkmcnt(0)
v_mfma_f32_16x16x32_bf16 v[48:51], v[184:187], a[128:131], v[48:51]
ds_read_b64_tr_b16 v[176:177], v230 offset:12288
v_mfma_f32_16x16x32_bf16 v[52:55], v[184:187], a[132:135], v[52:55]
ds_read_b64_tr_b16 v[178:179], v230 offset:14336
v_mfma_f32_16x16x32_bf16 v[56:59], v[184:187], a[136:139], v[56:59]
ds_read_b64_tr_b16 v[180:181], v233 offset:12288
v_mfma_f32_16x16x32_bf16 v[60:63], v[184:187], a[140:143], v[60:63]
ds_read_b64_tr_b16 v[182:183], v233 offset:14336
v_mfma_f32_16x16x32_bf16 v[64:67], v[188:191], a[128:131], v[64:67]
v_add_u32 v226, s66, v224
s_add_u32 m0, s73, 81920
v_mfma_f32_16x16x32_bf16 v[68:71], v[188:191], a[132:135], v[68:71]
global_load_lds_dwordx4 v226, s[42:43]
v_mfma_f32_16x16x32_bf16 v[72:75], v[188:191], a[136:139], v[72:75]
v_add_u32 v227, s67, v224
v_mfma_f32_16x16x32_bf16 v[76:79], v[188:191], a[140:143], v[76:79]
s_waitcnt lgkmcnt(0)
v_mfma_f32_16x16x32_bf16 v[48:51], v[176:179], a[144:147], v[48:51]
ds_read_b64_tr_b16 v[184:185], v230 offset:16384
v_mfma_f32_16x16x32_bf16 v[52:55], v[176:179], a[148:151], v[52:55]
ds_read_b64_tr_b16 v[186:187], v230 offset:18432
v_mfma_f32_16x16x32_bf16 v[56:59], v[176:179], a[152:155], v[56:59]
ds_read_b64_tr_b16 v[188:189], v233 offset:16384
v_mfma_f32_16x16x32_bf16 v[60:63], v[176:179], a[156:159], v[60:63]
ds_read_b64_tr_b16 v[190:191], v233 offset:18432
v_mfma_f32_16x16x32_bf16 v[64:67], v[180:183], a[144:147], v[64:67]
s_add_u32 m0, s73, 86016
s_nop 0
global_load_lds_dwordx4 v227, s[42:43]
v_mfma_f32_16x16x32_bf16 v[68:71], v[180:183], a[148:151], v[68:71]
v_add_u32 v226, s68, v224
v_mfma_f32_16x16x32_bf16 v[72:75], v[180:183], a[152:155], v[72:75]
v_mfma_f32_16x16x32_bf16 v[76:79], v[180:183], a[156:159], v[76:79]
s_waitcnt lgkmcnt(0)
s_waitcnt vmcnt(20)
s_barrier
v_mfma_f32_16x16x32_bf16 v[48:51], v[184:187], a[160:163], v[48:51]
ds_read_b64_tr_b16 v[176:177], v232 offset:24576
v_mfma_f32_16x16x32_bf16 v[52:55], v[184:187], a[164:167], v[52:55]
ds_read_b64_tr_b16 v[178:179], v232 offset:26624
v_mfma_f32_16x16x32_bf16 v[56:59], v[184:187], a[168:171], v[56:59]
ds_read_b64_tr_b16 v[180:181], v235 offset:24576
v_mfma_f32_16x16x32_bf16 v[60:63], v[184:187], a[172:175], v[60:63]
ds_read_b64_tr_b16 v[182:183], v235 offset:26624
v_mfma_f32_16x16x32_bf16 v[64:67], v[188:191], a[160:163], v[64:67]
s_add_u32 m0, s73, 90112
s_nop 0
global_load_lds_dwordx4 v226, s[42:43]
v_mfma_f32_16x16x32_bf16 v[68:71], v[188:191], a[164:167], v[68:71]
v_add_u32 v224, 128, v224
v_add_u32 v225, 128, v225
v_mfma_f32_16x16x32_bf16 v[72:75], v[188:191], a[168:171], v[72:75]
v_mfma_f32_16x16x32_bf16 v[76:79], v[188:191], a[172:175], v[76:79]
s_waitcnt lgkmcnt(0)
v_mfma_f32_16x16x32_bf16 v[112:115], v[176:179], a[0:3], 0
ds_read_b64_tr_b16 v[184:185], v232 offset:28672
v_cvt_pk_bf16_f32 v48, v48, v49
v_mfma_f32_16x16x32_bf16 v[116:119], v[176:179], a[4:7], 0
ds_read_b64_tr_b16 v[186:187], v232 offset:30720
v_cvt_pk_bf16_f32 v49, v50, v51
v_mfma_f32_16x16x32_bf16 v[120:123], v[176:179], a[8:11], 0
ds_read_b64_tr_b16 v[188:189], v235 offset:28672
v_cvt_pk_bf16_f32 v50, v64, v65
v_mfma_f32_16x16x32_bf16 v[124:127], v[176:179], a[12:15], 0
ds_read_b64_tr_b16 v[190:191], v235 offset:30720
v_cvt_pk_bf16_f32 v51, v66, v67
v_mfma_f32_16x16x32_bf16 v[128:131], v[180:183], a[0:3], 0
v_add_u32 v226, s60, v224
s_add_u32 m0, s73, 98304
v_mfma_f32_16x16x32_bf16 v[132:135], v[180:183], a[4:7], 0
s_add_u32 s77, s76, 786432
v_mfma_f32_16x16x32_bf16 v[136:139], v[180:183], a[8:11], 0
buffer_store_dwordx4 v[48:51], v11, s[28:31], s77 offen sc1
v_mfma_f32_16x16x32_bf16 v[140:143], v[180:183], a[12:15], 0
v_cvt_pk_bf16_f32 v52, v52, v53
v_cvt_pk_bf16_f32 v53, v54, v55
s_waitcnt lgkmcnt(0)
v_mfma_f32_16x16x32_bf16 v[112:115], v[184:187], a[16:19], v[112:115]
ds_read_b64_tr_b16 v[176:177], v232 offset:32768
v_cvt_pk_bf16_f32 v54, v68, v69
v_mfma_f32_16x16x32_bf16 v[116:119], v[184:187], a[20:23], v[116:119]
ds_read_b64_tr_b16 v[178:179], v232 offset:34816
v_cvt_pk_bf16_f32 v55, v70, v71
v_mfma_f32_16x16x32_bf16 v[120:123], v[184:187], a[24:27], v[120:123]
ds_read_b64_tr_b16 v[180:181], v235 offset:32768
s_add_u32 s77, s76, 819200
v_mfma_f32_16x16x32_bf16 v[124:127], v[184:187], a[28:31], v[124:127]
ds_read_b64_tr_b16 v[182:183], v235 offset:34816
v_mfma_f32_16x16x32_bf16 v[128:131], v[188:191], a[16:19], v[128:131]
global_load_lds_dwordx4 v226, s[42:43]
v_mfma_f32_16x16x32_bf16 v[132:135], v[188:191], a[20:23], v[132:135]
v_add_u32 v227, s61, v224
s_add_u32 m0, s73, 102400
v_mfma_f32_16x16x32_bf16 v[136:139], v[188:191], a[24:27], v[136:139]
buffer_store_dwordx4 v[52:55], v11, s[28:31], s77 offen sc1
v_mfma_f32_16x16x32_bf16 v[140:143], v[188:191], a[28:31], v[140:143]
v_cvt_pk_bf16_f32 v56, v56, v57
v_cvt_pk_bf16_f32 v57, v58, v59
s_waitcnt lgkmcnt(0)
v_mfma_f32_16x16x32_bf16 v[112:115], v[176:179], a[32:35], v[112:115]
ds_read_b64_tr_b16 v[184:185], v232 offset:36864
v_cvt_pk_bf16_f32 v58, v72, v73
v_mfma_f32_16x16x32_bf16 v[116:119], v[176:179], a[36:39], v[116:119]
ds_read_b64_tr_b16 v[186:187], v232 offset:38912
v_cvt_pk_bf16_f32 v59, v74, v75
v_mfma_f32_16x16x32_bf16 v[120:123], v[176:179], a[40:43], v[120:123]
ds_read_b64_tr_b16 v[188:189], v235 offset:36864
s_add_u32 s77, s76, 851968
v_mfma_f32_16x16x32_bf16 v[124:127], v[176:179], a[44:47], v[124:127]
ds_read_b64_tr_b16 v[190:191], v235 offset:38912
v_mfma_f32_16x16x32_bf16 v[128:131], v[180:183], a[32:35], v[128:131]
global_load_lds_dwordx4 v227, s[42:43]
v_mfma_f32_16x16x32_bf16 v[132:135], v[180:183], a[36:39], v[132:135]
s_add_u32 m0, s73, 106496
s_nop 0
buffer_load_dwordx4 v225, s[16:19], s69 offen lds
v_mfma_f32_16x16x32_bf16 v[136:139], v[180:183], a[40:43], v[136:139]
buffer_store_dwordx4 v[56:59], v11, s[28:31], s77 offen sc1
v_mfma_f32_16x16x32_bf16 v[140:143], v[180:183], a[44:47], v[140:143]
v_cvt_pk_bf16_f32 v60, v60, v61
v_cvt_pk_bf16_f32 v61, v62, v63
s_waitcnt lgkmcnt(0)
v_mfma_f32_16x16x32_bf16 v[112:115], v[184:187], a[48:51], v[112:115]
ds_read_b64_tr_b16 v[176:177], v232 offset:40960
v_cvt_pk_bf16_f32 v62, v76, v77
v_mfma_f32_16x16x32_bf16 v[116:119], v[184:187], a[52:55], v[116:119]
ds_read_b64_tr_b16 v[178:179], v232 offset:43008
v_cvt_pk_bf16_f32 v63, v78, v79
v_mfma_f32_16x16x32_bf16 v[120:123], v[184:187], a[56:59], v[120:123]
ds_read_b64_tr_b16 v[180:181], v235 offset:40960
s_add_u32 s77, s76, 884736
v_mfma_f32_16x16x32_bf16 v[124:127], v[184:187], a[60:63], v[124:127]
ds_read_b64_tr_b16 v[182:183], v235 offset:43008
v_mfma_f32_16x16x32_bf16 v[128:131], v[188:191], a[48:51], v[128:131]
s_add_u32 m0, s73, 110592
s_nop 0
buffer_load_dwordx4 v225, s[16:19], s70 offen lds
v_mfma_f32_16x16x32_bf16 v[132:135], v[188:191], a[52:55], v[132:135]
buffer_store_dwordx4 v[60:63], v11, s[28:31], s77 offen sc1
v_mfma_f32_16x16x32_bf16 v[136:139], v[188:191], a[56:59], v[136:139]
v_mfma_f32_16x16x32_bf16 v[140:143], v[188:191], a[60:63], v[140:143]
s_waitcnt lgkmcnt(0)
v_mfma_f32_16x16x32_bf16 v[112:115], v[176:179], a[64:67], v[112:115]
ds_read_b64_tr_b16 v[184:185], v232 offset:45056
v_mfma_f32_16x16x32_bf16 v[116:119], v[176:179], a[68:71], v[116:119]
ds_read_b64_tr_b16 v[186:187], v232 offset:47104
v_mfma_f32_16x16x32_bf16 v[120:123], v[176:179], a[72:75], v[120:123]
ds_read_b64_tr_b16 v[188:189], v235 offset:45056
v_mfma_f32_16x16x32_bf16 v[124:127], v[176:179], a[76:79], v[124:127]
ds_read_b64_tr_b16 v[190:191], v235 offset:47104
v_mfma_f32_16x16x32_bf16 v[128:131], v[180:183], a[64:67], v[128:131]
v_add_u32 v226, s62, v224
s_add_u32 m0, s73, 114688
v_mfma_f32_16x16x32_bf16 v[132:135], v[180:183], a[68:71], v[132:135]
global_load_lds_dwordx4 v226, s[42:43]
v_mfma_f32_16x16x32_bf16 v[136:139], v[180:183], a[72:75], v[136:139]
v_mfma_f32_16x16x32_bf16 v[140:143], v[180:183], a[76:79], v[140:143]
s_waitcnt lgkmcnt(0)
s_waitcnt vmcnt(25)
s_barrier
s_add_u32 s40, s41, 128
buffer_store_dword v10, v3, s[28:31], s40 offen sc1
v_mfma_f32_16x16x32_bf16 v[112:115], v[184:187], a[80:83], v[112:115]
ds_read_b64_tr_b16 v[176:177], v230 offset:24576
v_mfma_f32_16x16x32_bf16 v[116:119], v[184:187], a[84:87], v[116:119]
ds_read_b64_tr_b16 v[178:179], v230 offset:26624
v_mfma_f32_16x16x32_bf16 v[120:123], v[184:187], a[88:91], v[120:123]
ds_read_b64_tr_b16 v[180:181], v233 offset:24576
v_mfma_f32_16x16x32_bf16 v[124:127], v[184:187], a[92:95], v[124:127]
ds_read_b64_tr_b16 v[182:183], v233 offset:26624
v_mfma_f32_16x16x32_bf16 v[128:131], v[188:191], a[80:83], v[128:131]
v_add_u32 v227, s63, v224
s_add_u32 m0, s73, 118784
v_mfma_f32_16x16x32_bf16 v[132:135], v[188:191], a[84:87], v[132:135]
global_load_lds_dwordx4 v227, s[42:43]
v_mfma_f32_16x16x32_bf16 v[136:139], v[188:191], a[88:91], v[136:139]
v_mfma_f32_16x16x32_bf16 v[140:143], v[188:191], a[92:95], v[140:143]
s_waitcnt lgkmcnt(0)
v_mfma_f32_16x16x32_bf16 v[112:115], v[176:179], a[96:99], v[112:115]
ds_read_b64_tr_b16 v[184:185], v230 offset:28672
v_mfma_f32_16x16x32_bf16 v[116:119], v[176:179], a[100:103], v[116:119]
ds_read_b64_tr_b16 v[186:187], v230 offset:30720
v_mfma_f32_16x16x32_bf16 v[120:123], v[176:179], a[104:107], v[120:123]
ds_read_b64_tr_b16 v[188:189], v233 offset:28672
v_mfma_f32_16x16x32_bf16 v[124:127], v[176:179], a[108:111], v[124:127]
ds_read_b64_tr_b16 v[190:191], v233 offset:30720
v_mfma_f32_16x16x32_bf16 v[128:131], v[180:183], a[96:99], v[128:131]
v_add_u32 v226, s64, v224
s_add_u32 m0, s73, 0
v_mfma_f32_16x16x32_bf16 v[132:135], v[180:183], a[100:103], v[132:135]
global_load_lds_dwordx4 v226, s[42:43]
v_mfma_f32_16x16x32_bf16 v[136:139], v[180:183], a[104:107], v[136:139]
v_mfma_f32_16x16x32_bf16 v[140:143], v[180:183], a[108:111], v[140:143]
s_waitcnt lgkmcnt(0)
v_mfma_f32_16x16x32_bf16 v[112:115], v[184:187], a[112:115], v[112:115]
ds_read_b64_tr_b16 v[176:177], v230 offset:32768
v_mfma_f32_16x16x32_bf16 v[116:119], v[184:187], a[116:119], v[116:119]
ds_read_b64_tr_b16 v[178:179], v230 offset:34816
v_mfma_f32_16x16x32_bf16 v[120:123], v[184:187], a[120:123], v[120:123]
ds_read_b64_tr_b16 v[180:181], v233 offset:32768
v_mfma_f32_16x16x32_bf16 v[124:127], v[184:187], a[124:127], v[124:127]
ds_read_b64_tr_b16 v[182:183], v233 offset:34816
v_mfma_f32_16x16x32_bf16 v[128:131], v[188:191], a[112:115], v[128:131]
v_add_u32 v227, s65, v224
s_add_u32 m0, s73, 4096
v_mfma_f32_16x16x32_bf16 v[132:135], v[188:191], a[116:119], v[132:135]
global_load_lds_dwordx4 v227, s[42:43]
v_mfma_f32_16x16x32_bf16 v[136:139], v[188:191], a[120:123], v[136:139]
v_mfma_f32_16x16x32_bf16 v[140:143], v[188:191], a[124:127], v[140:143]
s_waitcnt lgkmcnt(0)
v_mfma_f32_16x16x32_bf16 v[112:115], v[176:179], a[128:131], v[112:115]
ds_read_b64_tr_b16 v[184:185], v230 offset:36864
v_mfma_f32_16x16x32_bf16 v[116:119], v[176:179], a[132:135], v[116:119]
ds_read_b64_tr_b16 v[186:187], v230 offset:38912
v_mfma_f32_16x16x32_bf16 v[120:123], v[176:179], a[136:139], v[120:123]
ds_read_b64_tr_b16 v[188:189], v233 offset:36864
v_mfma_f32_16x16x32_bf16 v[124:127], v[176:179], a[140:143], v[124:127]
ds_read_b64_tr_b16 v[190:191], v233 offset:38912
v_mfma_f32_16x16x32_bf16 v[128:131], v[180:183], a[128:131], v[128:131]
v_add_u32 v226, s66, v224
s_add_u32 m0, s73, 8192
v_mfma_f32_16x16x32_bf16 v[132:135], v[180:183], a[132:135], v[132:135]
global_load_lds_dwordx4 v226, s[42:43]
v_mfma_f32_16x16x32_bf16 v[136:139], v[180:183], a[136:139], v[136:139]
v_add_u32 v227, s67, v224
v_mfma_f32_16x16x32_bf16 v[140:143], v[180:183], a[140:143], v[140:143]
s_waitcnt lgkmcnt(0)
v_mfma_f32_16x16x32_bf16 v[112:115], v[184:187], a[144:147], v[112:115]
ds_read_b64_tr_b16 v[176:177], v230 offset:40960
v_mfma_f32_16x16x32_bf16 v[116:119], v[184:187], a[148:151], v[116:119]
ds_read_b64_tr_b16 v[178:179], v230 offset:43008
v_mfma_f32_16x16x32_bf16 v[120:123], v[184:187], a[152:155], v[120:123]
ds_read_b64_tr_b16 v[180:181], v233 offset:40960
v_mfma_f32_16x16x32_bf16 v[124:127], v[184:187], a[156:159], v[124:127]
ds_read_b64_tr_b16 v[182:183], v233 offset:43008
v_mfma_f32_16x16x32_bf16 v[128:131], v[188:191], a[144:147], v[128:131]
s_add_u32 m0, s73, 12288
s_nop 0
global_load_lds_dwordx4 v227, s[42:43]
v_mfma_f32_16x16x32_bf16 v[132:135], v[188:191], a[148:151], v[132:135]
v_add_u32 v226, s68, v224
v_mfma_f32_16x16x32_bf16 v[136:139], v[188:191], a[152:155], v[136:139]
v_mfma_f32_16x16x32_bf16 v[140:143], v[188:191], a[156:159], v[140:143]
s_waitcnt lgkmcnt(0)
s_waitcnt vmcnt(20)
s_barrier
v_mfma_f32_16x16x32_bf16 v[112:115], v[176:179], a[160:163], v[112:115]
ds_read_b64_tr_b16 v[184:185], v231 offset:0
v_mfma_f32_16x16x32_bf16 v[116:119], v[176:179], a[164:167], v[116:119]
ds_read_b64_tr_b16 v[186:187], v231 offset:2048
v_mfma_f32_16x16x32_bf16 v[120:123], v[176:179], a[168:171], v[120:123]
ds_read_b64_tr_b16 v[188:189], v234 offset:0
v_mfma_f32_16x16x32_bf16 v[124:127], v[176:179], a[172:175], v[124:127]
ds_read_b64_tr_b16 v[190:191], v234 offset:2048
v_mfma_f32_16x16x32_bf16 v[128:131], v[180:183], a[160:163], v[128:131]
s_add_u32 m0, s73, 16384
s_nop 0
global_load_lds_dwordx4 v226, s[42:43]
v_mfma_f32_16x16x32_bf16 v[132:135], v[180:183], a[164:167], v[132:135]
v_add_u32 v224, 128, v224
v_add_u32 v225, 128, v225
v_mfma_f32_16x16x32_bf16 v[136:139], v[180:183], a[168:171], v[136:139]
v_mfma_f32_16x16x32_bf16 v[140:143], v[180:183], a[172:175], v[140:143]
s_waitcnt lgkmcnt(0)
v_mfma_f32_16x16x32_bf16 v[48:51], v[184:187], a[0:3], 0
ds_read_b64_tr_b16 v[176:177], v231 offset:4096
v_cvt_pk_bf16_f32 v112, v112, v113
v_mfma_f32_16x16x32_bf16 v[52:55], v[184:187], a[4:7], 0
ds_read_b64_tr_b16 v[178:179], v231 offset:6144
v_cvt_pk_bf16_f32 v113, v114, v115
v_mfma_f32_16x16x32_bf16 v[56:59], v[184:187], a[8:11], 0
ds_read_b64_tr_b16 v[180:181], v234 offset:4096
v_cvt_pk_bf16_f32 v114, v128, v129
v_mfma_f32_16x16x32_bf16 v[60:63], v[184:187], a[12:15], 0
ds_read_b64_tr_b16 v[182:183], v234 offset:6144
v_cvt_pk_bf16_f32 v115, v130, v131
v_mfma_f32_16x16x32_bf16 v[64:67], v[188:191], a[0:3], 0
v_add_u32 v226, s60, v224
s_add_u32 m0, s73, 122880
v_mfma_f32_16x16x32_bf16 v[68:71], v[188:191], a[4:7], 0
s_add_u32 s77, s76, 1048576
v_mfma_f32_16x16x32_bf16 v[72:75], v[188:191], a[8:11], 0
buffer_store_dwordx4 v[112:115], v11, s[28:31], s77 offen sc1
v_mfma_f32_16x16x32_bf16 v[76:79], v[188:191], a[12:15], 0
v_cvt_pk_bf16_f32 v116, v116, v117
v_cvt_pk_bf16_f32 v117, v118, v119
s_waitcnt lgkmcnt(0)
v_mfma_f32_16x16x32_bf16 v[48:51], v[176:179], a[16:19], v[48:51]
ds_read_b64_tr_b16 v[184:185], v231 offset:8192
v_cvt_pk_bf16_f32 v118, v132, v133
v_mfma_f32_16x16x32_bf16 v[52:55], v[176:179], a[20:23], v[52:55]
ds_read_b64_tr_b16 v[186:187], v231 offset:10240
v_cvt_pk_bf16_f32 v119, v134, v135
v_mfma_f32_16x16x32_bf16 v[56:59], v[176:179], a[24:27], v[56:59]
ds_read_b64_tr_b16 v[188:189], v234 offset:8192
s_add_u32 s77, s76, 1081344
v_mfma_f32_16x16x32_bf16 v[60:63], v[176:179], a[28:31], v[60:63]
ds_read_b64_tr_b16 v[190:191], v234 offset:10240
v_mfma_f32_16x16x32_bf16 v[64:67], v[180:183], a[16:19], v[64:67]
global_load_lds_dwordx4 v226, s[42:43]
v_mfma_f32_16x16x32_bf16 v[68:71], v[180:183], a[20:23], v[68:71]
v_add_u32 v227, s61, v224
s_add_u32 m0, s73, 126976
v_mfma_f32_16x16x32_bf16 v[72:75], v[180:183], a[24:27], v[72:75]
buffer_store_dwordx4 v[116:119], v11, s[28:31], s77 offen sc1
v_mfma_f32_16x16x32_bf16 v[76:79], v[180:183], a[28:31], v[76:79]
v_cvt_pk_bf16_f32 v120, v120, v121
v_cvt_pk_bf16_f32 v121, v122, v123
s_waitcnt lgkmcnt(0)
v_mfma_f32_16x16x32_bf16 v[48:51], v[184:187], a[32:35], v[48:51]
ds_read_b64_tr_b16 v[176:177], v231 offset:12288
v_cvt_pk_bf16_f32 v122, v136, v137
v_mfma_f32_16x16x32_bf16 v[52:55], v[184:187], a[36:39], v[52:55]
ds_read_b64_tr_b16 v[178:179], v231 offset:14336
v_cvt_pk_bf16_f32 v123, v138, v139
v_mfma_f32_16x16x32_bf16 v[56:59], v[184:187], a[40:43], v[56:59]
ds_read_b64_tr_b16 v[180:181], v234 offset:12288
s_add_u32 s77, s76, 1114112
v_mfma_f32_16x16x32_bf16 v[60:63], v[184:187], a[44:47], v[60:63]
ds_read_b64_tr_b16 v[182:183], v234 offset:14336
v_mfma_f32_16x16x32_bf16 v[64:67], v[188:191], a[32:35], v[64:67]
global_load_lds_dwordx4 v227, s[42:43]
v_mfma_f32_16x16x32_bf16 v[68:71], v[188:191], a[36:39], v[68:71]
s_add_u32 m0, s73, 131072
s_nop 0
buffer_load_dwordx4 v225, s[16:19], s69 offen lds
v_mfma_f32_16x16x32_bf16 v[72:75], v[188:191], a[40:43], v[72:75]
buffer_store_dwordx4 v[120:123], v11, s[28:31], s77 offen sc1
v_mfma_f32_16x16x32_bf16 v[76:79], v[188:191], a[44:47], v[76:79]
v_cvt_pk_bf16_f32 v124, v124, v125
v_cvt_pk_bf16_f32 v125, v126, v127
s_waitcnt lgkmcnt(0)
v_mfma_f32_16x16x32_bf16 v[48:51], v[176:179], a[48:51], v[48:51]
ds_read_b64_tr_b16 v[184:185], v231 offset:16384
v_cvt_pk_bf16_f32 v126, v140, v141
v_mfma_f32_16x16x32_bf16 v[52:55], v[176:179], a[52:55], v[52:55]
ds_read_b64_tr_b16 v[186:187], v231 offset:18432
v_cvt_pk_bf16_f32 v127, v142, v143
v_mfma_f32_16x16x32_bf16 v[56:59], v[176:179], a[56:59], v[56:59]
ds_read_b64_tr_b16 v[188:189], v234 offset:16384
s_add_u32 s77, s76, 1146880
v_mfma_f32_16x16x32_bf16 v[60:63], v[176:179], a[60:63], v[60:63]
ds_read_b64_tr_b16 v[190:191], v234 offset:18432
v_mfma_f32_16x16x32_bf16 v[64:67], v[180:183], a[48:51], v[64:67]
s_add_u32 m0, s73, 135168
s_nop 0
buffer_load_dwordx4 v225, s[16:19], s70 offen lds
v_mfma_f32_16x16x32_bf16 v[68:71], v[180:183], a[52:55], v[68:71]
buffer_store_dwordx4 v[124:127], v11, s[28:31], s77 offen sc1
v_mfma_f32_16x16x32_bf16 v[72:75], v[180:183], a[56:59], v[72:75]
v_mfma_f32_16x16x32_bf16 v[76:79], v[180:183], a[60:63], v[76:79]
s_waitcnt lgkmcnt(0)
v_mfma_f32_16x16x32_bf16 v[48:51], v[184:187], a[64:67], v[48:51]
ds_read_b64_tr_b16 v[176:177], v231 offset:20480
v_mfma_f32_16x16x32_bf16 v[52:55], v[184:187], a[68:71], v[52:55]
ds_read_b64_tr_b16 v[178:179], v231 offset:22528
v_mfma_f32_16x16x32_bf16 v[56:59], v[184:187], a[72:75], v[56:59]
ds_read_b64_tr_b16 v[180:181], v234 offset:20480
v_mfma_f32_16x16x32_bf16 v[60:63], v[184:187], a[76:79], v[60:63]
ds_read_b64_tr_b16 v[182:183], v234 offset:22528
v_mfma_f32_16x16x32_bf16 v[64:67], v[188:191], a[64:67], v[64:67]
v_add_u32 v226, s62, v224
s_add_u32 m0, s73, 139264
v_mfma_f32_16x16x32_bf16 v[68:71], v[188:191], a[68:71], v[68:71]
global_load_lds_dwordx4 v226, s[42:43]
v_mfma_f32_16x16x32_bf16 v[72:75], v[188:191], a[72:75], v[72:75]
v_mfma_f32_16x16x32_bf16 v[76:79], v[188:191], a[76:79], v[76:79]
s_waitcnt lgkmcnt(0)
s_waitcnt vmcnt(25)
s_barrier
s_add_u32 s40, s41, 256
buffer_store_dword v10, v3, s[28:31], s40 offen sc1
v_mfma_f32_16x16x32_bf16 v[48:51], v[176:179], a[80:83], v[48:51]
ds_read_b64_tr_b16 v[184:185], v231 offset:24576
v_mfma_f32_16x16x32_bf16 v[52:55], v[176:179], a[84:87], v[52:55]
ds_read_b64_tr_b16 v[186:187], v231 offset:26624
v_mfma_f32_16x16x32_bf16 v[56:59], v[176:179], a[88:91], v[56:59]
ds_read_b64_tr_b16 v[188:189], v234 offset:24576
v_mfma_f32_16x16x32_bf16 v[60:63], v[176:179], a[92:95], v[60:63]
ds_read_b64_tr_b16 v[190:191], v234 offset:26624
v_mfma_f32_16x16x32_bf16 v[64:67], v[180:183], a[80:83], v[64:67]
v_add_u32 v227, s63, v224
s_add_u32 m0, s73, 143360
v_mfma_f32_16x16x32_bf16 v[68:71], v[180:183], a[84:87], v[68:71]
global_load_lds_dwordx4 v227, s[42:43]
v_mfma_f32_16x16x32_bf16 v[72:75], v[180:183], a[88:91], v[72:75]
v_mfma_f32_16x16x32_bf16 v[76:79], v[180:183], a[92:95], v[76:79]
s_waitcnt lgkmcnt(0)
v_mfma_f32_16x16x32_bf16 v[48:51], v[184:187], a[96:99], v[48:51]
ds_read_b64_tr_b16 v[176:177], v231 offset:28672
v_mfma_f32_16x16x32_bf16 v[52:55], v[184:187], a[100:103], v[52:55]
ds_read_b64_tr_b16 v[178:179], v231 offset:30720
v_mfma_f32_16x16x32_bf16 v[56:59], v[184:187], a[104:107], v[56:59]
ds_read_b64_tr_b16 v[180:181], v234 offset:28672
v_mfma_f32_16x16x32_bf16 v[60:63], v[184:187], a[108:111], v[60:63]
ds_read_b64_tr_b16 v[182:183], v234 offset:30720
v_mfma_f32_16x16x32_bf16 v[64:67], v[188:191], a[96:99], v[64:67]
v_add_u32 v226, s64, v224
s_add_u32 m0, s73, 24576
v_mfma_f32_16x16x32_bf16 v[68:71], v[188:191], a[100:103], v[68:71]
global_load_lds_dwordx4 v226, s[42:43]
v_mfma_f32_16x16x32_bf16 v[72:75], v[188:191], a[104:107], v[72:75]
v_mfma_f32_16x16x32_bf16 v[76:79], v[188:191], a[108:111], v[76:79]
s_waitcnt lgkmcnt(0)
v_mfma_f32_16x16x32_bf16 v[48:51], v[176:179], a[112:115], v[48:51]
ds_read_b64_tr_b16 v[184:185], v231 offset:32768
v_mfma_f32_16x16x32_bf16 v[52:55], v[176:179], a[116:119], v[52:55]
ds_read_b64_tr_b16 v[186:187], v231 offset:34816
v_mfma_f32_16x16x32_bf16 v[56:59], v[176:179], a[120:123], v[56:59]
ds_read_b64_tr_b16 v[188:189], v234 offset:32768
v_mfma_f32_16x16x32_bf16 v[60:63], v[176:179], a[124:127], v[60:63]
ds_read_b64_tr_b16 v[190:191], v234 offset:34816
v_mfma_f32_16x16x32_bf16 v[64:67], v[180:183], a[112:115], v[64:67]
v_add_u32 v227, s65, v224
s_add_u32 m0, s73, 28672
v_mfma_f32_16x16x32_bf16 v[68:71], v[180:183], a[116:119], v[68:71]
global_load_lds_dwordx4 v227, s[42:43]
v_mfma_f32_16x16x32_bf16 v[72:75], v[180:183], a[120:123], v[72:75]
v_mfma_f32_16x16x32_bf16 v[76:79], v[180:183], a[124:127], v[76:79]
s_waitcnt lgkmcnt(0)
v_mfma_f32_16x16x32_bf16 v[48:51], v[184:187], a[128:131], v[48:51]
ds_read_b64_tr_b16 v[176:177], v231 offset:36864
v_mfma_f32_16x16x32_bf16 v[52:55], v[184:187], a[132:135], v[52:55]
ds_read_b64_tr_b16 v[178:179], v231 offset:38912
v_mfma_f32_16x16x32_bf16 v[56:59], v[184:187], a[136:139], v[56:59]
ds_read_b64_tr_b16 v[180:181], v234 offset:36864
v_mfma_f32_16x16x32_bf16 v[60:63], v[184:187], a[140:143], v[60:63]
ds_read_b64_tr_b16 v[182:183], v234 offset:38912
v_mfma_f32_16x16x32_bf16 v[64:67], v[188:191], a[128:131], v[64:67]
v_add_u32 v226, s66, v224
s_add_u32 m0, s73, 32768
v_mfma_f32_16x16x32_bf16 v[68:71], v[188:191], a[132:135], v[68:71]
global_load_lds_dwordx4 v226, s[42:43]
v_mfma_f32_16x16x32_bf16 v[72:75], v[188:191], a[136:139], v[72:75]
v_add_u32 v227, s67, v224
v_mfma_f32_16x16x32_bf16 v[76:79], v[188:191], a[140:143], v[76:79]
s_waitcnt lgkmcnt(0)
v_mfma_f32_16x16x32_bf16 v[48:51], v[176:179], a[144:147], v[48:51]
ds_read_b64_tr_b16 v[184:185], v231 offset:40960
v_mfma_f32_16x16x32_bf16 v[52:55], v[176:179], a[148:151], v[52:55]
ds_read_b64_tr_b16 v[186:187], v231 offset:43008
v_mfma_f32_16x16x32_bf16 v[56:59], v[176:179], a[152:155], v[56:59]
ds_read_b64_tr_b16 v[188:189], v234 offset:40960
v_mfma_f32_16x16x32_bf16 v[60:63], v[176:179], a[156:159], v[60:63]
ds_read_b64_tr_b16 v[190:191], v234 offset:43008
v_mfma_f32_16x16x32_bf16 v[64:67], v[180:183], a[144:147], v[64:67]
s_add_u32 m0, s73, 36864
s_nop 0
global_load_lds_dwordx4 v227, s[42:43]
v_mfma_f32_16x16x32_bf16 v[68:71], v[180:183], a[148:151], v[68:71]
v_add_u32 v226, s68, v224
v_mfma_f32_16x16x32_bf16 v[72:75], v[180:183], a[152:155], v[72:75]
v_mfma_f32_16x16x32_bf16 v[76:79], v[180:183], a[156:159], v[76:79]
s_waitcnt lgkmcnt(0)
s_waitcnt vmcnt(20)
s_barrier
v_mfma_f32_16x16x32_bf16 v[48:51], v[184:187], a[160:163], v[48:51]
ds_read_b64_tr_b16 v[176:177], v232 offset:0
v_mfma_f32_16x16x32_bf16 v[52:55], v[184:187], a[164:167], v[52:55]
ds_read_b64_tr_b16 v[178:179], v232 offset:2048
v_mfma_f32_16x16x32_bf16 v[56:59], v[184:187], a[168:171], v[56:59]
ds_read_b64_tr_b16 v[180:181], v235 offset:0
v_mfma_f32_16x16x32_bf16 v[60:63], v[184:187], a[172:175], v[60:63]
ds_read_b64_tr_b16 v[182:183], v235 offset:2048
v_mfma_f32_16x16x32_bf16 v[64:67], v[188:191], a[160:163], v[64:67]
s_add_u32 m0, s73, 40960
s_nop 0
global_load_lds_dwordx4 v226, s[42:43]
v_mfma_f32_16x16x32_bf16 v[68:71], v[188:191], a[164:167], v[68:71]
v_add_u32 v224, 128, v224
v_add_u32 v225, 128, v225
v_mfma_f32_16x16x32_bf16 v[72:75], v[188:191], a[168:171], v[72:75]
v_mfma_f32_16x16x32_bf16 v[76:79], v[188:191], a[172:175], v[76:79]
s_waitcnt lgkmcnt(0)
v_mfma_f32_16x16x32_bf16 v[112:115], v[176:179], a[0:3], 0
ds_read_b64_tr_b16 v[184:185], v232 offset:4096
v_cvt_pk_bf16_f32 v48, v48, v49
v_mfma_f32_16x16x32_bf16 v[116:119], v[176:179], a[4:7], 0
ds_read_b64_tr_b16 v[186:187], v232 offset:6144
v_cvt_pk_bf16_f32 v49, v50, v51
v_mfma_f32_16x16x32_bf16 v[120:123], v[176:179], a[8:11], 0
ds_read_b64_tr_b16 v[188:189], v235 offset:4096
v_cvt_pk_bf16_f32 v50, v64, v65
v_mfma_f32_16x16x32_bf16 v[124:127], v[176:179], a[12:15], 0
ds_read_b64_tr_b16 v[190:191], v235 offset:6144
v_cvt_pk_bf16_f32 v51, v66, v67
v_mfma_f32_16x16x32_bf16 v[128:131], v[180:183], a[0:3], 0
v_add_u32 v226, s60, v224
s_add_u32 m0, s73, 49152
v_mfma_f32_16x16x32_bf16 v[132:135], v[180:183], a[4:7], 0
s_add_u32 s77, s76, 1310720
v_mfma_f32_16x16x32_bf16 v[136:139], v[180:183], a[8:11], 0
buffer_store_dwordx4 v[48:51], v11, s[28:31], s77 offen sc1
v_mfma_f32_16x16x32_bf16 v[140:143], v[180:183], a[12:15], 0
v_cvt_pk_bf16_f32 v52, v52, v53
v_cvt_pk_bf16_f32 v53, v54, v55
s_waitcnt lgkmcnt(0)
v_mfma_f32_16x16x32_bf16 v[112:115], v[184:187], a[16:19], v[112:115]
ds_read_b64_tr_b16 v[176:177], v232 offset:8192
v_cvt_pk_bf16_f32 v54, v68, v69
v_mfma_f32_16x16x32_bf16 v[116:119], v[184:187], a[20:23], v[116:119]
ds_read_b64_tr_b16 v[178:179], v232 offset:10240
v_cvt_pk_bf16_f32 v55, v70, v71
v_mfma_f32_16x16x32_bf16 v[120:123], v[184:187], a[24:27], v[120:123]
ds_read_b64_tr_b16 v[180:181], v235 offset:8192
s_add_u32 s77, s76, 1343488
v_mfma_f32_16x16x32_bf16 v[124:127], v[184:187], a[28:31], v[124:127]
ds_read_b64_tr_b16 v[182:183], v235 offset:10240
v_mfma_f32_16x16x32_bf16 v[128:131], v[188:191], a[16:19], v[128:131]
global_load_lds_dwordx4 v226, s[42:43]
v_mfma_f32_16x16x32_bf16 v[132:135], v[188:191], a[20:23], v[132:135]
v_add_u32 v227, s61, v224
s_add_u32 m0, s73, 53248
v_mfma_f32_16x16x32_bf16 v[136:139], v[188:191], a[24:27], v[136:139]
buffer_store_dwordx4 v[52:55], v11, s[28:31], s77 offen sc1
v_mfma_f32_16x16x32_bf16 v[140:143], v[188:191], a[28:31], v[140:143]
v_cvt_pk_bf16_f32 v56, v56, v57
v_cvt_pk_bf16_f32 v57, v58, v59
s_waitcnt lgkmcnt(0)
v_mfma_f32_16x16x32_bf16 v[112:115], v[176:179], a[32:35], v[112:115]
ds_read_b64_tr_b16 v[184:185], v232 offset:12288
v_cvt_pk_bf16_f32 v58, v72, v73
v_mfma_f32_16x16x32_bf16 v[116:119], v[176:179], a[36:39], v[116:119]
ds_read_b64_tr_b16 v[186:187], v232 offset:14336
v_cvt_pk_bf16_f32 v59, v74, v75
v_mfma_f32_16x16x32_bf16 v[120:123], v[176:179], a[40:43], v[120:123]
ds_read_b64_tr_b16 v[188:189], v235 offset:12288
s_add_u32 s77, s76, 1376256
v_mfma_f32_16x16x32_bf16 v[124:127], v[176:179], a[44:47], v[124:127]
ds_read_b64_tr_b16 v[190:191], v235 offset:14336
v_mfma_f32_16x16x32_bf16 v[128:131], v[180:183], a[32:35], v[128:131]
global_load_lds_dwordx4 v227, s[42:43]
v_mfma_f32_16x16x32_bf16 v[132:135], v[180:183], a[36:39], v[132:135]
s_add_u32 m0, s73, 57344
s_nop 0
buffer_load_dwordx4 v225, s[16:19], s69 offen lds
v_mfma_f32_16x16x32_bf16 v[136:139], v[180:183], a[40:43], v[136:139]
buffer_store_dwordx4 v[56:59], v11, s[28:31], s77 offen sc1
v_mfma_f32_16x16x32_bf16 v[140:143], v[180:183], a[44:47], v[140:143]
v_cvt_pk_bf16_f32 v60, v60, v61
v_cvt_pk_bf16_f32 v61, v62, v63
s_waitcnt lgkmcnt(0)
v_mfma_f32_16x16x32_bf16 v[112:115], v[184:187], a[48:51], v[112:115]
ds_read_b64_tr_b16 v[176:177], v232 offset:16384
v_cvt_pk_bf16_f32 v62, v76, v77
v_mfma_f32_16x16x32_bf16 v[116:119], v[184:187], a[52:55], v[116:119]
ds_read_b64_tr_b16 v[178:179], v232 offset:18432
v_cvt_pk_bf16_f32 v63, v78, v79
v_mfma_f32_16x16x32_bf16 v[120:123], v[184:187], a[56:59], v[120:123]
ds_read_b64_tr_b16 v[180:181], v235 offset:16384
s_add_u32 s77, s76, 1409024
v_mfma_f32_16x16x32_bf16 v[124:127], v[184:187], a[60:63], v[124:127]
ds_read_b64_tr_b16 v[182:183], v235 offset:18432
v_mfma_f32_16x16x32_bf16 v[128:131], v[188:191], a[48:51], v[128:131]
s_add_u32 m0, s73, 61440
s_nop 0
buffer_load_dwordx4 v225, s[16:19], s70 offen lds
v_mfma_f32_16x16x32_bf16 v[132:135], v[188:191], a[52:55], v[132:135]
buffer_store_dwordx4 v[60:63], v11, s[28:31], s77 offen sc1
v_mfma_f32_16x16x32_bf16 v[136:139], v[188:191], a[56:59], v[136:139]
v_mfma_f32_16x16x32_bf16 v[140:143], v[188:191], a[60:63], v[140:143]
s_waitcnt lgkmcnt(0)
v_mfma_f32_16x16x32_bf16 v[112:115], v[176:179], a[64:67], v[112:115]
ds_read_b64_tr_b16 v[184:185], v232 offset:20480
v_mfma_f32_16x16x32_bf16 v[116:119], v[176:179], a[68:71], v[116:119]
ds_read_b64_tr_b16 v[186:187], v232 offset:22528
v_mfma_f32_16x16x32_bf16 v[120:123], v[176:179], a[72:75], v[120:123]
ds_read_b64_tr_b16 v[188:189], v235 offset:20480
v_mfma_f32_16x16x32_bf16 v[124:127], v[176:179], a[76:79], v[124:127]
ds_read_b64_tr_b16 v[190:191], v235 offset:22528
v_mfma_f32_16x16x32_bf16 v[128:131], v[180:183], a[64:67], v[128:131]
v_add_u32 v226, s62, v224
s_add_u32 m0, s73, 65536
v_mfma_f32_16x16x32_bf16 v[132:135], v[180:183], a[68:71], v[132:135]
global_load_lds_dwordx4 v226, s[42:43]
v_mfma_f32_16x16x32_bf16 v[136:139], v[180:183], a[72:75], v[136:139]
v_mfma_f32_16x16x32_bf16 v[140:143], v[180:183], a[76:79], v[140:143]
s_waitcnt lgkmcnt(0)
s_waitcnt vmcnt(25)
s_barrier
s_add_u32 s40, s41, 384
buffer_store_dword v10, v3, s[28:31], s40 offen sc1
v_mfma_f32_16x16x32_bf16 v[112:115], v[184:187], a[80:83], v[112:115]
ds_read_b64_tr_b16 v[176:177], v230 offset:0
v_mfma_f32_16x16x32_bf16 v[116:119], v[184:187], a[84:87], v[116:119]
ds_read_b64_tr_b16 v[178:179], v230 offset:2048
v_mfma_f32_16x16x32_bf16 v[120:123], v[184:187], a[88:91], v[120:123]
ds_read_b64_tr_b16 v[180:181], v233 offset:0
v_mfma_f32_16x16x32_bf16 v[124:127], v[184:187], a[92:95], v[124:127]
ds_read_b64_tr_b16 v[182:183], v233 offset:2048
v_mfma_f32_16x16x32_bf16 v[128:131], v[188:191], a[80:83], v[128:131]
v_add_u32 v227, s63, v224
s_add_u32 m0, s73, 69632
v_mfma_f32_16x16x32_bf16 v[132:135], v[188:191], a[84:87], v[132:135]
global_load_lds_dwordx4 v227, s[42:43]
v_mfma_f32_16x16x32_bf16 v[136:139], v[188:191], a[88:91], v[136:139]
v_mfma_f32_16x16x32_bf16 v[140:143], v[188:191], a[92:95], v[140:143]
s_waitcnt lgkmcnt(0)
v_mfma_f32_16x16x32_bf16 v[112:115], v[176:179], a[96:99], v[112:115]
ds_read_b64_tr_b16 v[184:185], v230 offset:4096
v_mfma_f32_16x16x32_bf16 v[116:119], v[176:179], a[100:103], v[116:119]
ds_read_b64_tr_b16 v[186:187], v230 offset:6144
v_mfma_f32_16x16x32_bf16 v[120:123], v[176:179], a[104:107], v[120:123]
ds_read_b64_tr_b16 v[188:189], v233 offset:4096
v_mfma_f32_16x16x32_bf16 v[124:127], v[176:179], a[108:111], v[124:127]
ds_read_b64_tr_b16 v[190:191], v233 offset:6144
v_mfma_f32_16x16x32_bf16 v[128:131], v[180:183], a[96:99], v[128:131]
v_add_u32 v226, s64, v224
s_add_u32 m0, s73, 73728
v_mfma_f32_16x16x32_bf16 v[132:135], v[180:183], a[100:103], v[132:135]
global_load_lds_dwordx4 v226, s[42:43]
v_mfma_f32_16x16x32_bf16 v[136:139], v[180:183], a[104:107], v[136:139]
v_mfma_f32_16x16x32_bf16 v[140:143], v[180:183], a[108:111], v[140:143]
s_waitcnt lgkmcnt(0)
v_mfma_f32_16x16x32_bf16 v[112:115], v[184:187], a[112:115], v[112:115]
ds_read_b64_tr_b16 v[176:177], v230 offset:8192
v_mfma_f32_16x16x32_bf16 v[116:119], v[184:187], a[116:119], v[116:119]
ds_read_b64_tr_b16 v[178:179], v230 offset:10240
v_mfma_f32_16x16x32_bf16 v[120:123], v[184:187], a[120:123], v[120:123]
ds_read_b64_tr_b16 v[180:181], v233 offset:8192
v_mfma_f32_16x16x32_bf16 v[124:127], v[184:187], a[124:127], v[124:127]
ds_read_b64_tr_b16 v[182:183], v233 offset:10240
v_mfma_f32_16x16x32_bf16 v[128:131], v[188:191], a[112:115], v[128:131]
v_add_u32 v227, s65, v224
s_add_u32 m0, s73, 77824
v_mfma_f32_16x16x32_bf16 v[132:135], v[188:191], a[116:119], v[132:135]
global_load_lds_dwordx4 v227, s[42:43]
v_mfma_f32_16x16x32_bf16 v[136:139], v[188:191], a[120:123], v[136:139]
v_mfma_f32_16x16x32_bf16 v[140:143], v[188:191], a[124:127], v[140:143]
s_waitcnt lgkmcnt(0)
v_mfma_f32_16x16x32_bf16 v[112:115], v[176:179], a[128:131], v[112:115]
ds_read_b64_tr_b16 v[184:185], v230 offset:12288
v_mfma_f32_16x16x32_bf16 v[116:119], v[176:179], a[132:135], v[116:119]
ds_read_b64_tr_b16 v[186:187], v230 offset:14336
v_mfma_f32_16x16x32_bf16 v[120:123], v[176:179], a[136:139], v[120:123]
ds_read_b64_tr_b16 v[188:189], v233 offset:12288
v_mfma_f32_16x16x32_bf16 v[124:127], v[176:179], a[140:143], v[124:127]
ds_read_b64_tr_b16 v[190:191], v233 offset:14336
v_mfma_f32_16x16x32_bf16 v[128:131], v[180:183], a[128:131], v[128:131]
v_add_u32 v226, s66, v224
s_add_u32 m0, s73, 81920
v_mfma_f32_16x16x32_bf16 v[132:135], v[180:183], a[132:135], v[132:135]
global_load_lds_dwordx4 v226, s[42:43]
v_mfma_f32_16x16x32_bf16 v[136:139], v[180:183], a[136:139], v[136:139]
v_add_u32 v227, s67, v224
v_mfma_f32_16x16x32_bf16 v[140:143], v[180:183], a[140:143], v[140:143]
s_waitcnt lgkmcnt(0)
v_mfma_f32_16x16x32_bf16 v[112:115], v[184:187], a[144:147], v[112:115]
ds_read_b64_tr_b16 v[176:177], v230 offset:16384
v_mfma_f32_16x16x32_bf16 v[116:119], v[184:187], a[148:151], v[116:119]
ds_read_b64_tr_b16 v[178:179], v230 offset:18432
v_mfma_f32_16x16x32_bf16 v[120:123], v[184:187], a[152:155], v[120:123]
ds_read_b64_tr_b16 v[180:181], v233 offset:16384
v_mfma_f32_16x16x32_bf16 v[124:127], v[184:187], a[156:159], v[124:127]
ds_read_b64_tr_b16 v[182:183], v233 offset:18432
v_mfma_f32_16x16x32_bf16 v[128:131], v[188:191], a[144:147], v[128:131]
s_add_u32 m0, s73, 86016
s_nop 0
global_load_lds_dwordx4 v227, s[42:43]
v_mfma_f32_16x16x32_bf16 v[132:135], v[188:191], a[148:151], v[132:135]
v_add_u32 v226, s68, v224
v_mfma_f32_16x16x32_bf16 v[136:139], v[188:191], a[152:155], v[136:139]
v_mfma_f32_16x16x32_bf16 v[140:143], v[188:191], a[156:159], v[140:143]
s_waitcnt lgkmcnt(0)
s_waitcnt vmcnt(20)
s_barrier
v_mfma_f32_16x16x32_bf16 v[112:115], v[176:179], a[160:163], v[112:115]
ds_read_b64_tr_b16 v[184:185], v232 offset:24576
v_mfma_f32_16x16x32_bf16 v[116:119], v[176:179], a[164:167], v[116:119]
ds_read_b64_tr_b16 v[186:187], v232 offset:26624
v_mfma_f32_16x16x32_bf16 v[120:123], v[176:179], a[168:171], v[120:123]
ds_read_b64_tr_b16 v[188:189], v235 offset:24576
v_mfma_f32_16x16x32_bf16 v[124:127], v[176:179], a[172:175], v[124:127]
ds_read_b64_tr_b16 v[190:191], v235 offset:26624
v_mfma_f32_16x16x32_bf16 v[128:131], v[180:183], a[160:163], v[128:131]
s_add_u32 m0, s73, 90112
s_nop 0
global_load_lds_dwordx4 v226, s[42:43]
v_mfma_f32_16x16x32_bf16 v[132:135], v[180:183], a[164:167], v[132:135]
v_add_u32 v224, 128, v224
v_add_u32 v225, 128, v225
v_mfma_f32_16x16x32_bf16 v[136:139], v[180:183], a[168:171], v[136:139]
v_mfma_f32_16x16x32_bf16 v[140:143], v[180:183], a[172:175], v[140:143]
s_waitcnt lgkmcnt(0)
v_mfma_f32_16x16x32_bf16 v[48:51], v[184:187], a[0:3], 0
ds_read_b64_tr_b16 v[176:177], v232 offset:28672
v_cvt_pk_bf16_f32 v112, v112, v113
v_mfma_f32_16x16x32_bf16 v[52:55], v[184:187], a[4:7], 0
ds_read_b64_tr_b16 v[178:179], v232 offset:30720
v_cvt_pk_bf16_f32 v113, v114, v115
v_mfma_f32_16x16x32_bf16 v[56:59], v[184:187], a[8:11], 0
ds_read_b64_tr_b16 v[180:181], v235 offset:28672
v_cvt_pk_bf16_f32 v114, v128, v129
v_mfma_f32_16x16x32_bf16 v[60:63], v[184:187], a[12:15], 0
ds_read_b64_tr_b16 v[182:183], v235 offset:30720
v_cvt_pk_bf16_f32 v115, v130, v131
v_mfma_f32_16x16x32_bf16 v[64:67], v[188:191], a[0:3], 0
s_add_u32 s77, s76, 1572864
v_mfma_f32_16x16x32_bf16 v[68:71], v[188:191], a[4:7], 0
buffer_store_dwordx4 v[112:115], v11, s[28:31], s77 offen sc1
v_mfma_f32_16x16x32_bf16 v[72:75], v[188:191], a[8:11], 0
v_cvt_pk_bf16_f32 v116, v116, v117
v_cvt_pk_bf16_f32 v117, v118, v119
v_mfma_f32_16x16x32_bf16 v[76:79], v[188:191], a[12:15], 0
v_cvt_pk_bf16_f32 v118, v132, v133
v_cvt_pk_bf16_f32 v119, v134, v135
s_waitcnt lgkmcnt(0)
v_mfma_f32_16x16x32_bf16 v[48:51], v[176:179], a[16:19], v[48:51]
ds_read_b64_tr_b16 v[184:185], v232 offset:32768
s_add_u32 s77, s76, 1605632
v_mfma_f32_16x16x32_bf16 v[52:55], v[176:179], a[20:23], v[52:55]
ds_read_b64_tr_b16 v[186:187], v232 offset:34816
v_mfma_f32_16x16x32_bf16 v[56:59], v[176:179], a[24:27], v[56:59]
ds_read_b64_tr_b16 v[188:189], v235 offset:32768
v_mfma_f32_16x16x32_bf16 v[60:63], v[176:179], a[28:31], v[60:63]
ds_read_b64_tr_b16 v[190:191], v235 offset:34816
v_mfma_f32_16x16x32_bf16 v[64:67], v[180:183], a[16:19], v[64:67]
buffer_store_dwordx4 v[116:119], v11, s[28:31], s77 offen sc1
v_mfma_f32_16x16x32_bf16 v[68:71], v[180:183], a[20:23], v[68:71]
v_cvt_pk_bf16_f32 v120, v120, v121
v_cvt_pk_bf16_f32 v121, v122, v123
v_mfma_f32_16x16x32_bf16 v[72:75], v[180:183], a[24:27], v[72:75]
v_cvt_pk_bf16_f32 v122, v136, v137
v_cvt_pk_bf16_f32 v123, v138, v139
v_mfma_f32_16x16x32_bf16 v[76:79], v[180:183], a[28:31], v[76:79]
s_add_u32 s77, s76, 1638400
s_waitcnt lgkmcnt(0)
v_mfma_f32_16x16x32_bf16 v[48:51], v[184:187], a[32:35], v[48:51]
ds_read_b64_tr_b16 v[176:177], v232 offset:36864
v_mfma_f32_16x16x32_bf16 v[52:55], v[184:187], a[36:39], v[52:55]
ds_read_b64_tr_b16 v[178:179], v232 offset:38912
v_mfma_f32_16x16x32_bf16 v[56:59], v[184:187], a[40:43], v[56:59]
ds_read_b64_tr_b16 v[180:181], v235 offset:36864
v_mfma_f32_16x16x32_bf16 v[60:63], v[184:187], a[44:47], v[60:63]
ds_read_b64_tr_b16 v[182:183], v235 offset:38912
v_mfma_f32_16x16x32_bf16 v[64:67], v[188:191], a[32:35], v[64:67]
buffer_store_dwordx4 v[120:123], v11, s[28:31], s77 offen sc1
v_mfma_f32_16x16x32_bf16 v[68:71], v[188:191], a[36:39], v[68:71]
v_cvt_pk_bf16_f32 v124, v124, v125
v_cvt_pk_bf16_f32 v125, v126, v127
v_mfma_f32_16x16x32_bf16 v[72:75], v[188:191], a[40:43], v[72:75]
v_cvt_pk_bf16_f32 v126, v140, v141
v_cvt_pk_bf16_f32 v127, v142, v143
v_mfma_f32_16x16x32_bf16 v[76:79], v[188:191], a[44:47], v[76:79]
s_add_u32 s77, s76, 1671168
s_waitcnt lgkmcnt(0)
v_mfma_f32_16x16x32_bf16 v[48:51], v[176:179], a[48:51], v[48:51]
ds_read_b64_tr_b16 v[184:185], v232 offset:40960
v_mfma_f32_16x16x32_bf16 v[52:55], v[176:179], a[52:55], v[52:55]
ds_read_b64_tr_b16 v[186:187], v232 offset:43008
v_mfma_f32_16x16x32_bf16 v[56:59], v[176:179], a[56:59], v[56:59]
ds_read_b64_tr_b16 v[188:189], v235 offset:40960
v_mfma_f32_16x16x32_bf16 v[60:63], v[176:179], a[60:63], v[60:63]
ds_read_b64_tr_b16 v[190:191], v235 offset:43008
v_mfma_f32_16x16x32_bf16 v[64:67], v[180:183], a[48:51], v[64:67]
buffer_store_dwordx4 v[124:127], v11, s[28:31], s77 offen sc1
v_mfma_f32_16x16x32_bf16 v[68:71], v[180:183], a[52:55], v[68:71]
v_mfma_f32_16x16x32_bf16 v[72:75], v[180:183], a[56:59], v[72:75]
v_mfma_f32_16x16x32_bf16 v[76:79], v[180:183], a[60:63], v[76:79]
s_waitcnt lgkmcnt(0)
v_mfma_f32_16x16x32_bf16 v[48:51], v[184:187], a[64:67], v[48:51]
ds_read_b64_tr_b16 v[176:177], v232 offset:45056
v_mfma_f32_16x16x32_bf16 v[52:55], v[184:187], a[68:71], v[52:55]
ds_read_b64_tr_b16 v[178:179], v232 offset:47104
v_mfma_f32_16x16x32_bf16 v[56:59], v[184:187], a[72:75], v[56:59]
ds_read_b64_tr_b16 v[180:181], v235 offset:45056
v_mfma_f32_16x16x32_bf16 v[60:63], v[184:187], a[76:79], v[60:63]
ds_read_b64_tr_b16 v[182:183], v235 offset:47104
v_mfma_f32_16x16x32_bf16 v[64:67], v[188:191], a[64:67], v[64:67]
v_mfma_f32_16x16x32_bf16 v[68:71], v[188:191], a[68:71], v[68:71]
v_mfma_f32_16x16x32_bf16 v[72:75], v[188:191], a[72:75], v[72:75]
v_mfma_f32_16x16x32_bf16 v[76:79], v[188:191], a[76:79], v[76:79]
s_waitcnt lgkmcnt(0)
s_waitcnt vmcnt(20)
s_barrier
s_add_u32 s40, s41, 512
buffer_store_dword v10, v3, s[28:31], s40 offen sc1
v_mfma_f32_16x16x32_bf16 v[48:51], v[176:179], a[80:83], v[48:51]
ds_read_b64_tr_b16 v[184:185], v230 offset:24576
v_mfma_f32_16x16x32_bf16 v[52:55], v[176:179], a[84:87], v[52:55]
ds_read_b64_tr_b16 v[186:187], v230 offset:26624
v_mfma_f32_16x16x32_bf16 v[56:59], v[176:179], a[88:91], v[56:59]
ds_read_b64_tr_b16 v[188:189], v233 offset:24576
v_mfma_f32_16x16x32_bf16 v[60:63], v[176:179], a[92:95], v[60:63]
ds_read_b64_tr_b16 v[190:191], v233 offset:26624
v_mfma_f32_16x16x32_bf16 v[64:67], v[180:183], a[80:83], v[64:67]
v_mfma_f32_16x16x32_bf16 v[68:71], v[180:183], a[84:87], v[68:71]
v_mfma_f32_16x16x32_bf16 v[72:75], v[180:183], a[88:91], v[72:75]
v_mfma_f32_16x16x32_bf16 v[76:79], v[180:183], a[92:95], v[76:79]
s_waitcnt lgkmcnt(0)
v_mfma_f32_16x16x32_bf16 v[48:51], v[184:187], a[96:99], v[48:51]
ds_read_b64_tr_b16 v[176:177], v230 offset:28672
v_mfma_f32_16x16x32_bf16 v[52:55], v[184:187], a[100:103], v[52:55]
ds_read_b64_tr_b16 v[178:179], v230 offset:30720
v_mfma_f32_16x16x32_bf16 v[56:59], v[184:187], a[104:107], v[56:59]
ds_read_b64_tr_b16 v[180:181], v233 offset:28672
v_mfma_f32_16x16x32_bf16 v[60:63], v[184:187], a[108:111], v[60:63]
ds_read_b64_tr_b16 v[182:183], v233 offset:30720
v_mfma_f32_16x16x32_bf16 v[64:67], v[188:191], a[96:99], v[64:67]
v_mfma_f32_16x16x32_bf16 v[68:71], v[188:191], a[100:103], v[68:71]
v_mfma_f32_16x16x32_bf16 v[72:75], v[188:191], a[104:107], v[72:75]
v_mfma_f32_16x16x32_bf16 v[76:79], v[188:191], a[108:111], v[76:79]
s_waitcnt lgkmcnt(0)
v_mfma_f32_16x16x32_bf16 v[48:51], v[176:179], a[112:115], v[48:51]
ds_read_b64_tr_b16 v[184:185], v230 offset:32768
v_mfma_f32_16x16x32_bf16 v[52:55], v[176:179], a[116:119], v[52:55]
ds_read_b64_tr_b16 v[186:187], v230 offset:34816
v_mfma_f32_16x16x32_bf16 v[56:59], v[176:179], a[120:123], v[56:59]
ds_read_b64_tr_b16 v[188:189], v233 offset:32768
v_mfma_f32_16x16x32_bf16 v[60:63], v[176:179], a[124:127], v[60:63]
ds_read_b64_tr_b16 v[190:191], v233 offset:34816
v_mfma_f32_16x16x32_bf16 v[64:67], v[180:183], a[112:115], v[64:67]
v_mfma_f32_16x16x32_bf16 v[68:71], v[180:183], a[116:119], v[68:71]
v_mfma_f32_16x16x32_bf16 v[72:75], v[180:183], a[120:123], v[72:75]
v_mfma_f32_16x16x32_bf16 v[76:79], v[180:183], a[124:127], v[76:79]
s_waitcnt lgkmcnt(0)
v_mfma_f32_16x16x32_bf16 v[48:51], v[184:187], a[128:131], v[48:51]
ds_read_b64_tr_b16 v[176:177], v230 offset:36864
v_mfma_f32_16x16x32_bf16 v[52:55], v[184:187], a[132:135], v[52:55]
ds_read_b64_tr_b16 v[178:179], v230 offset:38912
v_mfma_f32_16x16x32_bf16 v[56:59], v[184:187], a[136:139], v[56:59]
ds_read_b64_tr_b16 v[180:181], v233 offset:36864
v_mfma_f32_16x16x32_bf16 v[60:63], v[184:187], a[140:143], v[60:63]
ds_read_b64_tr_b16 v[182:183], v233 offset:38912
v_mfma_f32_16x16x32_bf16 v[64:67], v[188:191], a[128:131], v[64:67]
v_mfma_f32_16x16x32_bf16 v[68:71], v[188:191], a[132:135], v[68:71]
v_mfma_f32_16x16x32_bf16 v[72:75], v[188:191], a[136:139], v[72:75]
v_mfma_f32_16x16x32_bf16 v[76:79], v[188:191], a[140:143], v[76:79]
s_waitcnt lgkmcnt(0)
v_mfma_f32_16x16x32_bf16 v[48:51], v[176:179], a[144:147], v[48:51]
ds_read_b64_tr_b16 v[184:185], v230 offset:40960
v_mfma_f32_16x16x32_bf16 v[52:55], v[176:179], a[148:151], v[52:55]
ds_read_b64_tr_b16 v[186:187], v230 offset:43008
v_mfma_f32_16x16x32_bf16 v[56:59], v[176:179], a[152:155], v[56:59]
ds_read_b64_tr_b16 v[188:189], v233 offset:40960
v_mfma_f32_16x16x32_bf16 v[60:63], v[176:179], a[156:159], v[60:63]
ds_read_b64_tr_b16 v[190:191], v233 offset:43008
v_mfma_f32_16x16x32_bf16 v[64:67], v[180:183], a[144:147], v[64:67]
v_mfma_f32_16x16x32_bf16 v[68:71], v[180:183], a[148:151], v[68:71]
v_mfma_f32_16x16x32_bf16 v[72:75], v[180:183], a[152:155], v[72:75]
v_mfma_f32_16x16x32_bf16 v[76:79], v[180:183], a[156:159], v[76:79]
s_waitcnt lgkmcnt(0)
s_waitcnt vmcnt(10)
s_barrier
v_mfma_f32_16x16x32_bf16 v[48:51], v[184:187], a[160:163], v[48:51]
ds_read_b64_tr_b16 v[176:177], v231 offset:0
v_mfma_f32_16x16x32_bf16 v[52:55], v[184:187], a[164:167], v[52:55]
ds_read_b64_tr_b16 v[178:179], v231 offset:2048
v_mfma_f32_16x16x32_bf16 v[56:59], v[184:187], a[168:171], v[56:59]
ds_read_b64_tr_b16 v[180:181], v234 offset:0
v_mfma_f32_16x16x32_bf16 v[60:63], v[184:187], a[172:175], v[60:63]
ds_read_b64_tr_b16 v[182:183], v234 offset:2048
v_mfma_f32_16x16x32_bf16 v[64:67], v[188:191], a[160:163], v[64:67]
v_mfma_f32_16x16x32_bf16 v[68:71], v[188:191], a[164:167], v[68:71]
v_mfma_f32_16x16x32_bf16 v[72:75], v[188:191], a[168:171], v[72:75]
v_mfma_f32_16x16x32_bf16 v[76:79], v[188:191], a[172:175], v[76:79]
s_waitcnt lgkmcnt(0)
v_mfma_f32_16x16x32_bf16 v[112:115], v[176:179], a[0:3], 0
ds_read_b64_tr_b16 v[184:185], v231 offset:4096
v_cvt_pk_bf16_f32 v48, v48, v49
v_mfma_f32_16x16x32_bf16 v[116:119], v[176:179], a[4:7], 0
ds_read_b64_tr_b16 v[186:187], v231 offset:6144
v_cvt_pk_bf16_f32 v49, v50, v51
v_mfma_f32_16x16x32_bf16 v[120:123], v[176:179], a[8:11], 0
ds_read_b64_tr_b16 v[188:189], v234 offset:4096
v_cvt_pk_bf16_f32 v50, v64, v65
v_mfma_f32_16x16x32_bf16 v[124:127], v[176:179], a[12:15], 0
ds_read_b64_tr_b16 v[190:191], v234 offset:6144
v_cvt_pk_bf16_f32 v51, v66, v67
v_mfma_f32_16x16x32_bf16 v[128:131], v[180:183], a[0:3], 0
s_add_u32 s77, s76, 1835008
v_mfma_f32_16x16x32_bf16 v[132:135], v[180:183], a[4:7], 0
buffer_store_dwordx4 v[48:51], v11, s[28:31], s77 offen sc1
v_mfma_f32_16x16x32_bf16 v[136:139], v[180:183], a[8:11], 0
v_cvt_pk_bf16_f32 v52, v52, v53
v_cvt_pk_bf16_f32 v53, v54, v55
v_mfma_f32_16x16x32_bf16 v[140:143], v[180:183], a[12:15], 0
v_cvt_pk_bf16_f32 v54, v68, v69
v_cvt_pk_bf16_f32 v55, v70, v71
s_waitcnt lgkmcnt(0)
v_mfma_f32_16x16x32_bf16 v[112:115], v[184:187], a[16:19], v[112:115]
ds_read_b64_tr_b16 v[176:177], v231 offset:8192
s_add_u32 s77, s76, 1867776
v_mfma_f32_16x16x32_bf16 v[116:119], v[184:187], a[20:23], v[116:119]
ds_read_b64_tr_b16 v[178:179], v231 offset:10240
v_mfma_f32_16x16x32_bf16 v[120:123], v[184:187], a[24:27], v[120:123]
ds_read_b64_tr_b16 v[180:181], v234 offset:8192
v_mfma_f32_16x16x32_bf16 v[124:127], v[184:187], a[28:31], v[124:127]
ds_read_b64_tr_b16 v[182:183], v234 offset:10240
v_mfma_f32_16x16x32_bf16 v[128:131], v[188:191], a[16:19], v[128:131]
buffer_store_dwordx4 v[52:55], v11, s[28:31], s77 offen sc1
v_mfma_f32_16x16x32_bf16 v[132:135], v[188:191], a[20:23], v[132:135]
v_cvt_pk_bf16_f32 v56, v56, v57
v_cvt_pk_bf16_f32 v57, v58, v59
v_mfma_f32_16x16x32_bf16 v[136:139], v[188:191], a[24:27], v[136:139]
v_cvt_pk_bf16_f32 v58, v72, v73
v_cvt_pk_bf16_f32 v59, v74, v75
v_mfma_f32_16x16x32_bf16 v[140:143], v[188:191], a[28:31], v[140:143]
s_add_u32 s77, s76, 1900544
s_waitcnt lgkmcnt(0)
v_mfma_f32_16x16x32_bf16 v[112:115], v[176:179], a[32:35], v[112:115]
ds_read_b64_tr_b16 v[184:185], v231 offset:12288
v_mfma_f32_16x16x32_bf16 v[116:119], v[176:179], a[36:39], v[116:119]
ds_read_b64_tr_b16 v[186:187], v231 offset:14336
v_mfma_f32_16x16x32_bf16 v[120:123], v[176:179], a[40:43], v[120:123]
ds_read_b64_tr_b16 v[188:189], v234 offset:12288
v_mfma_f32_16x16x32_bf16 v[124:127], v[176:179], a[44:47], v[124:127]
ds_read_b64_tr_b16 v[190:191], v234 offset:14336
v_mfma_f32_16x16x32_bf16 v[128:131], v[180:183], a[32:35], v[128:131]
buffer_store_dwordx4 v[56:59], v11, s[28:31], s77 offen sc1
v_mfma_f32_16x16x32_bf16 v[132:135], v[180:183], a[36:39], v[132:135]
v_cvt_pk_bf16_f32 v60, v60, v61
v_cvt_pk_bf16_f32 v61, v62, v63
v_mfma_f32_16x16x32_bf16 v[136:139], v[180:183], a[40:43], v[136:139]
v_cvt_pk_bf16_f32 v62, v76, v77
v_cvt_pk_bf16_f32 v63, v78, v79
v_mfma_f32_16x16x32_bf16 v[140:143], v[180:183], a[44:47], v[140:143]
s_add_u32 s77, s76, 1933312
s_waitcnt lgkmcnt(0)
v_mfma_f32_16x16x32_bf16 v[112:115], v[184:187], a[48:51], v[112:115]
ds_read_b64_tr_b16 v[176:177], v231 offset:16384
v_mfma_f32_16x16x32_bf16 v[116:119], v[184:187], a[52:55], v[116:119]
ds_read_b64_tr_b16 v[178:179], v231 offset:18432
v_mfma_f32_16x16x32_bf16 v[120:123], v[184:187], a[56:59], v[120:123]
ds_read_b64_tr_b16 v[180:181], v234 offset:16384
v_mfma_f32_16x16x32_bf16 v[124:127], v[184:187], a[60:63], v[124:127]
ds_read_b64_tr_b16 v[182:183], v234 offset:18432
v_mfma_f32_16x16x32_bf16 v[128:131], v[188:191], a[48:51], v[128:131]
buffer_store_dwordx4 v[60:63], v11, s[28:31], s77 offen sc1
v_mfma_f32_16x16x32_bf16 v[132:135], v[188:191], a[52:55], v[132:135]
v_mfma_f32_16x16x32_bf16 v[136:139], v[188:191], a[56:59], v[136:139]
v_mfma_f32_16x16x32_bf16 v[140:143], v[188:191], a[60:63], v[140:143]
s_lshl_b32 s40, s50, 7
s_add_u32 s40, s40, s37
buffer_load_dword v12, v8, s[28:31], s40 offen sc1
s_waitcnt lgkmcnt(0)
v_mfma_f32_16x16x32_bf16 v[112:115], v[176:179], a[64:67], v[112:115]
ds_read_b64_tr_b16 v[184:185], v231 offset:20480
v_mfma_f32_16x16x32_bf16 v[116:119], v[176:179], a[68:71], v[116:119]
ds_read_b64_tr_b16 v[186:187], v231 offset:22528
v_mfma_f32_16x16x32_bf16 v[120:123], v[176:179], a[72:75], v[120:123]
ds_read_b64_tr_b16 v[188:189], v234 offset:20480
v_mfma_f32_16x16x32_bf16 v[124:127], v[176:179], a[76:79], v[124:127]
ds_read_b64_tr_b16 v[190:191], v234 offset:22528
v_mfma_f32_16x16x32_bf16 v[128:131], v[180:183], a[64:67], v[128:131]
v_mfma_f32_16x16x32_bf16 v[132:135], v[180:183], a[68:71], v[132:135]
v_mfma_f32_16x16x32_bf16 v[136:139], v[180:183], a[72:75], v[136:139]
v_mfma_f32_16x16x32_bf16 v[140:143], v[180:183], a[76:79], v[140:143]
s_waitcnt lgkmcnt(0)
s_waitcnt vmcnt(10)
s_barrier
s_add_u32 s40, s41, 640
buffer_store_dword v10, v3, s[28:31], s40 offen sc1
v_mfma_f32_16x16x32_bf16 v[112:115], v[184:187], a[80:83], v[112:115]
ds_read_b64_tr_b16 v[176:177], v231 offset:24576
v_mfma_f32_16x16x32_bf16 v[116:119], v[184:187], a[84:87], v[116:119]
ds_read_b64_tr_b16 v[178:179], v231 offset:26624
v_mfma_f32_16x16x32_bf16 v[120:123], v[184:187], a[88:91], v[120:123]
ds_read_b64_tr_b16 v[180:181], v234 offset:24576
v_mfma_f32_16x16x32_bf16 v[124:127], v[184:187], a[92:95], v[124:127]
ds_read_b64_tr_b16 v[182:183], v234 offset:26624
v_mfma_f32_16x16x32_bf16 v[128:131], v[188:191], a[80:83], v[128:131]
v_mfma_f32_16x16x32_bf16 v[132:135], v[188:191], a[84:87], v[132:135]
v_mfma_f32_16x16x32_bf16 v[136:139], v[188:191], a[88:91], v[136:139]
v_mfma_f32_16x16x32_bf16 v[140:143], v[188:191], a[92:95], v[140:143]
s_waitcnt lgkmcnt(0)
v_mfma_f32_16x16x32_bf16 v[112:115], v[176:179], a[96:99], v[112:115]
ds_read_b64_tr_b16 v[184:185], v231 offset:28672
v_mfma_f32_16x16x32_bf16 v[116:119], v[176:179], a[100:103], v[116:119]
ds_read_b64_tr_b16 v[186:187], v231 offset:30720
v_mfma_f32_16x16x32_bf16 v[120:123], v[176:179], a[104:107], v[120:123]
ds_read_b64_tr_b16 v[188:189], v234 offset:28672
v_mfma_f32_16x16x32_bf16 v[124:127], v[176:179], a[108:111], v[124:127]
ds_read_b64_tr_b16 v[190:191], v234 offset:30720
v_mfma_f32_16x16x32_bf16 v[128:131], v[180:183], a[96:99], v[128:131]
v_mfma_f32_16x16x32_bf16 v[132:135], v[180:183], a[100:103], v[132:135]
v_mfma_f32_16x16x32_bf16 v[136:139], v[180:183], a[104:107], v[136:139]
v_mfma_f32_16x16x32_bf16 v[140:143], v[180:183], a[108:111], v[140:143]
s_waitcnt lgkmcnt(0)
v_mfma_f32_16x16x32_bf16 v[112:115], v[184:187], a[112:115], v[112:115]
ds_read_b64_tr_b16 v[176:177], v231 offset:32768
v_mfma_f32_16x16x32_bf16 v[116:119], v[184:187], a[116:119], v[116:119]
ds_read_b64_tr_b16 v[178:179], v231 offset:34816
v_mfma_f32_16x16x32_bf16 v[120:123], v[184:187], a[120:123], v[120:123]
ds_read_b64_tr_b16 v[180:181], v234 offset:32768
v_mfma_f32_16x16x32_bf16 v[124:127], v[184:187], a[124:127], v[124:127]
ds_read_b64_tr_b16 v[182:183], v234 offset:34816
v_mfma_f32_16x16x32_bf16 v[128:131], v[188:191], a[112:115], v[128:131]
v_mfma_f32_16x16x32_bf16 v[132:135], v[188:191], a[116:119], v[132:135]
v_mfma_f32_16x16x32_bf16 v[136:139], v[188:191], a[120:123], v[136:139]
v_mfma_f32_16x16x32_bf16 v[140:143], v[188:191], a[124:127], v[140:143]
s_waitcnt lgkmcnt(0)
v_mfma_f32_16x16x32_bf16 v[112:115], v[176:179], a[128:131], v[112:115]
ds_read_b64_tr_b16 v[184:185], v231 offset:36864
v_mfma_f32_16x16x32_bf16 v[116:119], v[176:179], a[132:135], v[116:119]
ds_read_b64_tr_b16 v[186:187], v231 offset:38912
v_mfma_f32_16x16x32_bf16 v[120:123], v[176:179], a[136:139], v[120:123]
ds_read_b64_tr_b16 v[188:189], v234 offset:36864
v_mfma_f32_16x16x32_bf16 v[124:127], v[176:179], a[140:143], v[124:127]
ds_read_b64_tr_b16 v[190:191], v234 offset:38912
v_mfma_f32_16x16x32_bf16 v[128:131], v[180:183], a[128:131], v[128:131]
v_mfma_f32_16x16x32_bf16 v[132:135], v[180:183], a[132:135], v[132:135]
v_mfma_f32_16x16x32_bf16 v[136:139], v[180:183], a[136:139], v[136:139]
v_mfma_f32_16x16x32_bf16 v[140:143], v[180:183], a[140:143], v[140:143]
s_waitcnt lgkmcnt(0)
v_mfma_f32_16x16x32_bf16 v[112:115], v[184:187], a[144:147], v[112:115]
ds_read_b64_tr_b16 v[176:177], v231 offset:40960
v_mfma_f32_16x16x32_bf16 v[116:119], v[184:187], a[148:151], v[116:119]
ds_read_b64_tr_b16 v[178:179], v231 offset:43008
v_mfma_f32_16x16x32_bf16 v[120:123], v[184:187], a[152:155], v[120:123]
ds_read_b64_tr_b16 v[180:181], v234 offset:40960
v_mfma_f32_16x16x32_bf16 v[124:127], v[184:187], a[156:159], v[124:127]
ds_read_b64_tr_b16 v[182:183], v234 offset:43008
v_mfma_f32_16x16x32_bf16 v[128:131], v[188:191], a[144:147], v[128:131]
v_mfma_f32_16x16x32_bf16 v[132:135], v[188:191], a[148:151], v[132:135]
v_mfma_f32_16x16x32_bf16 v[136:139], v[188:191], a[152:155], v[136:139]
v_mfma_f32_16x16x32_bf16 v[140:143], v[188:191], a[156:159], v[140:143]
s_waitcnt lgkmcnt(0)
s_barrier
v_mfma_f32_16x16x32_bf16 v[112:115], v[176:179], a[160:163], v[112:115]
v_mfma_f32_16x16x32_bf16 v[116:119], v[176:179], a[164:167], v[116:119]
v_mfma_f32_16x16x32_bf16 v[120:123], v[176:179], a[168:171], v[120:123]
v_mfma_f32_16x16x32_bf16 v[124:127], v[176:179], a[172:175], v[124:127]
v_mfma_f32_16x16x32_bf16 v[128:131], v[180:183], a[160:163], v[128:131]
v_mfma_f32_16x16x32_bf16 v[132:135], v[180:183], a[164:167], v[132:135]
v_mfma_f32_16x16x32_bf16 v[136:139], v[180:183], a[168:171], v[136:139]
v_mfma_f32_16x16x32_bf16 v[140:143], v[180:183], a[172:175], v[140:143]
s_nop 0
v_cvt_pk_bf16_f32 v112, v112, v113
v_cvt_pk_bf16_f32 v113, v114, v115
s_nop 1
v_cvt_pk_bf16_f32 v114, v128, v129
v_cvt_pk_bf16_f32 v115, v130, v131
s_add_u32 s77, s76, 2097152
buffer_store_dwordx4 v[112:115], v11, s[28:31], s77 offen sc1
v_cvt_pk_bf16_f32 v116, v116, v117
v_cvt_pk_bf16_f32 v117, v118, v119
v_cvt_pk_bf16_f32 v118, v132, v133
v_cvt_pk_bf16_f32 v119, v134, v135
s_add_u32 s77, s76, 2129920
buffer_store_dwordx4 v[116:119], v11, s[28:31], s77 offen sc1
v_cvt_pk_bf16_f32 v120, v120, v121
v_cvt_pk_bf16_f32 v121, v122, v123
v_cvt_pk_bf16_f32 v122, v136, v137
v_cvt_pk_bf16_f32 v123, v138, v139
s_add_u32 s77, s76, 2162688
buffer_store_dwordx4 v[120:123], v11, s[28:31], s77 offen sc1
v_cvt_pk_bf16_f32 v124, v124, v125
v_cvt_pk_bf16_f32 v125, v126, v127
v_cvt_pk_bf16_f32 v126, v140, v141
v_cvt_pk_bf16_f32 v127, v142, v143
s_add_u32 s77, s76, 2195456
buffer_store_dwordx4 v[124:127], v11, s[28:31], s77 offen sc1
s_lshl_b32 s40, s50, 7
s_add_u32 s40, s40, s37
s_waitcnt vmcnt(5)
v_cmp_ne_u32 vcc, s36, v12
s_nop 4
s_cmp_eq_u64 vcc, 0
s_cbranch_scc1 L_ok_A
s_mov_b32 s3, 0
L_spin_A:
s_sleep 2
buffer_load_dword v12, v8, s[28:31], s40 offen sc1
s_waitcnt vmcnt(0)
v_cmp_ne_u32 vcc, s36, v12
s_add_u32 s3, s3, 1
s_nop 3
s_cmp_eq_u64 vcc, 0
s_cbranch_scc1 L_ok_A
s_cmp_lt_u32 s3, 0x40000
s_cbranch_scc1 L_spin_A
L_ok_A:
s_mul_i32 s38, s50, 262144
s_add_u32 s38, s38, s48
s_lshl_b32 s3, s50, 7
v_add_u32 v13, s3, v4
s_add_u32 s49, s38, 0
buffer_load_dwordx4 v[80:83], v11, s[28:31], s49 offen offset:0 sc1
buffer_load_dwordx4 v[84:87], v11, s[28:31], s49 offen offset:1024 sc1
buffer_load_dwordx4 v[88:91], v11, s[28:31], s49 offen offset:2048 sc1
buffer_load_dwordx4 v[92:95], v11, s[28:31], s49 offen offset:3072 sc1
s_add_u32 s49, s38, 4096
buffer_load_dwordx4 v[96:99], v11, s[28:31], s49 offen offset:0 sc1
buffer_load_dwordx4 v[100:103], v11, s[28:31], s49 offen offset:1024 sc1
buffer_load_dwordx4 v[104:107], v11, s[28:31], s49 offen offset:2048 sc1
buffer_load_dwordx4 v[108:111], v11, s[28:31], s49 offen offset:3072 sc1
s_add_u32 s49, s38, 8192
buffer_load_dwordx4 v[144:147], v11, s[28:31], s49 offen offset:0 sc1
buffer_load_dwordx4 v[148:151], v11, s[28:31], s49 offen offset:1024 sc1
buffer_load_dwordx4 v[152:155], v11, s[28:31], s49 offen offset:2048 sc1
buffer_load_dwordx4 v[156:159], v11, s[28:31], s49 offen offset:3072 sc1
s_add_u32 s49, s38, 12288
buffer_load_dwordx4 v[160:163], v11, s[28:31], s49 offen offset:0 sc1
buffer_load_dwordx4 v[164:167], v11, s[28:31], s49 offen offset:1024 sc1
buffer_load_dwordx4 v[168:171], v11, s[28:31], s49 offen offset:2048 sc1
buffer_load_dwordx4 v[172:175], v11, s[28:31], s49 offen offset:3072 sc1
buffer_load_dwordx2 v[252:253], v13, s[8:11], 0 offen
buffer_load_dwordx2 v[254:255], v13, s[8:11], 0 offen offset:32
s_lshl_b32 s40, s50, 7
s_add_u32 s40, s40, s37
s_add_u32 s40, s40, 512
s_add_u32 s39, s37, 1024
buffer_load_dword v14, v8, s[28:31], s40 offen sc1
buffer_load_dword v15, v8, s[28:31], s39 offen sc1
s_waitcnt vmcnt(20)
s_barrier
s_add_u32 s49, s41, 768
buffer_store_dword v10, v3, s[28:31], s49 offen sc1
s_add_u32 s49, s41, 896
buffer_store_dword v10, v3, s[28:31], s49 offen sc1
s_add_u32 s49, s41, 1024
buffer_store_dword v10, v3, s[28:31], s49 offen sc1
s_mul_i32 s38, s50, 262144
s_add_u32 s38, s38, s48
s_add_u32 s38, s38, 1048576
s_lshl_b32 s3, s50, 8
v_lshl_add_u32 v12, v2, 4, s3
v_add_u32 v5, 1024, v5
v_mov_b32 v9, 0x40000000
v_cmp_gt_u32 vcc, 16, v1
s_nop 1
v_cndmask_b32 v9, v9, v5, vcc
s_waitcnt vmcnt(4)
v_cmp_ne_u32 vcc, s36, v14
s_nop 4
s_andn2_b64 vcc, vcc, s[92:93]
s_cmp_eq_u64 vcc, 0
s_cbranch_scc1 L_ok_B
s_mov_b32 s3, 0
L_spin_B:
s_sleep 2
buffer_load_dword v14, v8, s[28:31], s40 offen sc1
s_waitcnt vmcnt(0)
v_cmp_ne_u32 vcc, s36, v14
s_add_u32 s3, s3, 1
s_nop 3
s_andn2_b64 vcc, vcc, s[92:93]
s_cmp_eq_u64 vcc, 0
s_cbranch_scc1 L_ok_B
s_cmp_lt_u32 s3, 0x40000
s_cbranch_scc1 L_spin_B
L_ok_B:
s_add_u32 s49, s38, 0
buffer_load_dwordx4 v[16:19], v11, s[28:31], s49 offen offset:0 sc1
buffer_load_dwordx4 v[20:23], v11, s[28:31], s49 offen offset:1024 sc1
buffer_load_dwordx4 v[24:27], v11, s[28:31], s49 offen offset:2048 sc1
buffer_load_dwordx4 v[28:31], v11, s[28:31], s49 offen offset:3072 sc1
s_add_u32 s49, s38, 4096
buffer_load_dwordx4 v[32:35], v11, s[28:31], s49 offen offset:0 sc1
buffer_load_dwordx4 v[36:39], v11, s[28:31], s49 offen offset:1024 sc1
buffer_load_dwordx4 v[40:43], v11, s[28:31], s49 offen offset:2048 sc1
buffer_load_dwordx4 v[44:47], v11, s[28:31], s49 offen offset:3072 sc1
s_add_u32 s49, s38, 8192
buffer_load_dwordx4 v[192:195], v11, s[28:31], s49 offen offset:0 sc1
buffer_load_dwordx4 v[196:199], v11, s[28:31], s49 offen offset:1024 sc1
buffer_load_dwordx4 v[200:203], v11, s[28:31], s49 offen offset:2048 sc1
buffer_load_dwordx4 v[204:207], v11, s[28:31], s49 offen offset:3072 sc1
s_add_u32 s49, s38, 12288
buffer_load_dwordx4 v[208:211], v11, s[28:31], s49 offen offset:0 sc1
buffer_load_dwordx4 v[212:215], v11, s[28:31], s49 offen offset:1024 sc1
buffer_load_dwordx4 v[216:219], v11, s[28:31], s49 offen offset:2048 sc1
buffer_load_dwordx4 v[220:223], v11, s[28:31], s49 offen offset:3072 sc1
s_waitcnt vmcnt(19)
v_cmp_ne_u32 vcc, s36, v15
s_nop 4
s_andn2_b64 vcc, vcc, s[92:93]
s_cmp_eq_u64 vcc, 0
s_cbranch_scc1 L_ok_C
s_mov_b32 s3, 0
L_spin_C:
s_sleep 2
buffer_load_dword v15, v8, s[28:31], s39 offen sc1
s_waitcnt vmcnt(0)
v_cmp_ne_u32 vcc, s36, v15
s_add_u32 s3, s3, 1
s_nop 3
s_andn2_b64 vcc, vcc, s[92:93]
s_cmp_eq_u64 vcc, 0
s_cbranch_scc1 L_ok_C
s_cmp_lt_u32 s3, 0x40000
s_cbranch_scc1 L_spin_C
L_ok_C:
s_lshl_b32 s3, s50, 7
s_add_u32 s3, s3, 512
v_add_u32 v14, s3, v4
s_add_u32 s38, s48, 2097152
s_add_u32 s49, s38, 0
buffer_load_dwordx4 v[48:51], v12, s[28:31], s49 offen offset:0 sc1
buffer_load_dwordx4 v[52:55], v12, s[28:31], s49 offen offset:1024 sc1
buffer_load_dwordx4 v[56:59], v12, s[28:31], s49 offen offset:2048 sc1
buffer_load_dwordx4 v[60:63], v12, s[28:31], s49 offen offset:3072 sc1
s_add_u32 s49, s38, 4096
buffer_load_dwordx4 v[64:67], v12, s[28:31], s49 offen offset:0 sc1
buffer_load_dwordx4 v[68:71], v12, s[28:31], s49 offen offset:1024 sc1
buffer_load_dwordx4 v[72:75], v12, s[28:31], s49 offen offset:2048 sc1
buffer_load_dwordx4 v[76:79], v12, s[28:31], s49 offen offset:3072 sc1
s_add_u32 s49, s38, 8192
buffer_load_dwordx4 v[112:115], v12, s[28:31], s49 offen offset:0 sc1
buffer_load_dwordx4 v[116:119], v12, s[28:31], s49 offen offset:1024 sc1
buffer_load_dwordx4 v[120:123], v12, s[28:31], s49 offen offset:2048 sc1
buffer_load_dwordx4 v[124:127], v12, s[28:31], s49 offen offset:3072 sc1
s_add_u32 s49, s38, 12288
buffer_load_dwordx4 v[128:131], v12, s[28:31], s49 offen offset:0 sc1
buffer_load_dwordx4 v[132:135], v12, s[28:31], s49 offen offset:1024 sc1
buffer_load_dwordx4 v[136:139], v12, s[28:31], s49 offen offset:2048 sc1
buffer_load_dwordx4 v[140:143], v12, s[28:31], s49 offen offset:3072 sc1
buffer_load_dwordx2 v[248:249], v14, s[8:11], 0 offen
buffer_load_dwordx2 v[250:251], v14, s[8:11], 0 offen offset:32
buffer_load_dwordx2 v[244:245], v5, s[8:11], 0 offen
buffer_load_dwordx2 v[246:247], v5, s[8:11], 0 offen offset:32
v_lshlrev_b32 v236, 16, v252
v_and_b32 v237, 0xffff0000, v252
v_lshlrev_b32 v238, 16, v253
v_and_b32 v239, 0xffff0000, v253
v_lshlrev_b32 v240, 16, v254
v_and_b32 v241, 0xffff0000, v254
v_lshlrev_b32 v242, 16, v255
v_and_b32 v243, 0xffff0000, v255
v_dot2c_f32_bf16 v236, v80, v6
v_dot2c_f32_bf16 v237, v80, v7
v_dot2c_f32_bf16 v238, v81, v6
v_dot2c_f32_bf16 v239, v81, v7
v_dot2c_f32_bf16 v240, v82, v6
v_dot2c_f32_bf16 v241, v82, v7
v_dot2c_f32_bf16 v242, v83, v6
v_dot2c_f32_bf16 v243, v83, v7
v_dot2c_f32_bf16 v236, v84, v6
v_dot2c_f32_bf16 v237, v84, v7
v_dot2c_f32_bf16 v238, v85, v6
v_dot2c_f32_bf16 v239, v85, v7
v_dot2c_f32_bf16 v240, v86, v6
v_dot2c_f32_bf16 v241, v86, v7
v_dot2c_f32_bf16 v242, v87, v6
v_dot2c_f32_bf16 v243, v87, v7
v_dot2c_f32_bf16 v236, v88, v6
v_dot2c_f32_bf16 v237, v88, v7
v_dot2c_f32_bf16 v238, v89, v6
v_dot2c_f32_bf16 v239, v89, v7
v_dot2c_f32_bf16 v240, v90, v6
v_dot2c_f32_bf16 v241, v90, v7
v_dot2c_f32_bf16 v242, v91, v6
v_dot2c_f32_bf16 v243, v91, v7
v_dot2c_f32_bf16 v236, v92, v6
v_dot2c_f32_bf16 v237, v92, v7
v_dot2c_f32_bf16 v238, v93, v6
v_dot2c_f32_bf16 v239, v93, v7
v_dot2c_f32_bf16 v240, v94, v6
v_dot2c_f32_bf16 v241, v94, v7
v_dot2c_f32_bf16 v242, v95, v6
v_dot2c_f32_bf16 v243, v95, v7
v_dot2c_f32_bf16 v236, v96, v6
v_dot2c_f32_bf16 v237, v96, v7
v_dot2c_f32_bf16 v238, v97, v6
v_dot2c_f32_bf16 v239, v97, v7
v_dot2c_f32_bf16 v240, v98, v6
v_dot2c_f32_bf16 v241, v98, v7
v_dot2c_f32_bf16 v242, v99, v6
v_dot2c_f32_bf16 v243, v99, v7
v_dot2c_f32_bf16 v236, v100, v6
v_dot2c_f32_bf16 v237, v100, v7
v_dot2c_f32_bf16 v238, v101, v6
v_dot2c_f32_bf16 v239, v101, v7
v_dot2c_f32_bf16 v240, v102, v6
v_dot2c_f32_bf16 v241, v102, v7
v_dot2c_f32_bf16 v242, v103, v6
v_dot2c_f32_bf16 v243, v103, v7
v_dot2c_f32_bf16 v236, v104, v6
v_dot2c_f32_bf16 v237, v104, v7
v_dot2c_f32_bf16 v238, v105, v6
v_dot2c_f32_bf16 v239, v105, v7
v_dot2c_f32_bf16 v240, v106, v6
v_dot2c_f32_bf16 v241, v106, v7
v_dot2c_f32_bf16 v242, v107, v6
v_dot2c_f32_bf16 v243, v107, v7
v_dot2c_f32_bf16 v236, v108, v6
v_dot2c_f32_bf16 v237, v108, v7
v_dot2c_f32_bf16 v238, v109, v6
v_dot2c_f32_bf16 v239, v109, v7
v_dot2c_f32_bf16 v240, v110, v6
v_dot2c_f32_bf16 v241, v110, v7
v_dot2c_f32_bf16 v242, v111, v6
v_dot2c_f32_bf16 v243, v111, v7
v_dot2c_f32_bf16 v236, v144, v6
v_dot2c_f32_bf16 v237, v144, v7
v_dot2c_f32_bf16 v238, v145, v6
v_dot2c_f32_bf16 v239, v145, v7
v_dot2c_f32_bf16 v240, v146, v6
v_dot2c_f32_bf16 v241, v146, v7
v_dot2c_f32_bf16 v242, v147, v6
v_dot2c_f32_bf16 v243, v147, v7
v_dot2c_f32_bf16 v236, v148, v6
v_dot2c_f32_bf16 v237, v148, v7
v_dot2c_f32_bf16 v238, v149, v6
v_dot2c_f32_bf16 v239, v149, v7
v_dot2c_f32_bf16 v240, v150, v6
v_dot2c_f32_bf16 v241, v150, v7
v_dot2c_f32_bf16 v242, v151, v6
v_dot2c_f32_bf16 v243, v151, v7
v_dot2c_f32_bf16 v236, v152, v6
v_dot2c_f32_bf16 v237, v152, v7
v_dot2c_f32_bf16 v238, v153, v6
v_dot2c_f32_bf16 v239, v153, v7
v_dot2c_f32_bf16 v240, v154, v6
v_dot2c_f32_bf16 v241, v154, v7
v_dot2c_f32_bf16 v242, v155, v6
v_dot2c_f32_bf16 v243, v155, v7
v_dot2c_f32_bf16 v236, v156, v6
v_dot2c_f32_bf16 v237, v156, v7
v_dot2c_f32_bf16 v238, v157, v6
v_dot2c_f32_bf16 v239, v157, v7
v_dot2c_f32_bf16 v240, v158, v6
v_dot2c_f32_bf16 v241, v158, v7
v_dot2c_f32_bf16 v242, v159, v6
v_dot2c_f32_bf16 v243, v159, v7
v_dot2c_f32_bf16 v236, v160, v6
v_dot2c_f32_bf16 v237, v160, v7
v_dot2c_f32_bf16 v238, v161, v6
v_dot2c_f32_bf16 v239, v161, v7
v_dot2c_f32_bf16 v240, v162, v6
v_dot2c_f32_bf16 v241, v162, v7
v_dot2c_f32_bf16 v242, v163, v6
v_dot2c_f32_bf16 v243, v163, v7
v_dot2c_f32_bf16 v236, v164, v6
v_dot2c_f32_bf16 v237, v164, v7
v_dot2c_f32_bf16 v238, v165, v6
v_dot2c_f32_bf16 v239, v165, v7
v_dot2c_f32_bf16 v240, v166, v6
v_dot2c_f32_bf16 v241, v166, v7
v_dot2c_f32_bf16 v242, v167, v6
v_dot2c_f32_bf16 v243, v167, v7
v_dot2c_f32_bf16 v236, v168, v6
v_dot2c_f32_bf16 v237, v168, v7
v_dot2c_f32_bf16 v238, v169, v6
v_dot2c_f32_bf16 v239, v169, v7
v_dot2c_f32_bf16 v240, v170, v6
v_dot2c_f32_bf16 v241, v170, v7
v_dot2c_f32_bf16 v242, v171, v6
v_dot2c_f32_bf16 v243, v171, v7
v_dot2c_f32_bf16 v236, v172, v6
v_dot2c_f32_bf16 v237, v172, v7
v_dot2c_f32_bf16 v238, v173, v6
v_dot2c_f32_bf16 v239, v173, v7
v_dot2c_f32_bf16 v240, v174, v6
v_dot2c_f32_bf16 v241, v174, v7
v_dot2c_f32_bf16 v242, v175, v6
v_dot2c_f32_bf16 v243, v175, v7
v_cvt_pk_bf16_f32 v252, v236, v237
v_cvt_pk_bf16_f32 v253, v238, v239
v_cvt_pk_bf16_f32 v254, v240, v241
v_cvt_pk_bf16_f32 v255, v242, v243
buffer_store_dwordx2 v[252:253], v13, s[44:47], 0 offen
buffer_store_dwordx2 v[254:255], v13, s[44:47], 0 offen offset:32
s_waitcnt vmcnt(5)
v_lshlrev_b32 v224, 16, v248
v_and_b32 v225, 0xffff0000, v248
v_lshlrev_b32 v226, 16, v249
v_and_b32 v227, 0xffff0000, v249
s_waitcnt vmcnt(4)
v_lshlrev_b32 v228, 16, v250
v_and_b32 v229, 0xffff0000, v250
v_lshlrev_b32 v230, 16, v251
v_and_b32 v231, 0xffff0000, v251
v_dot2c_f32_bf16 v224, v16, v6
v_dot2c_f32_bf16 v225, v16, v7
v_dot2c_f32_bf16 v226, v17, v6
v_dot2c_f32_bf16 v227, v17, v7
v_dot2c_f32_bf16 v228, v18, v6
v_dot2c_f32_bf16 v229, v18, v7
v_dot2c_f32_bf16 v230, v19, v6
v_dot2c_f32_bf16 v231, v19, v7
v_dot2c_f32_bf16 v224, v20, v6
v_dot2c_f32_bf16 v225, v20, v7
v_dot2c_f32_bf16 v226, v21, v6
v_dot2c_f32_bf16 v227, v21, v7
v_dot2c_f32_bf16 v228, v22, v6
v_dot2c_f32_bf16 v229, v22, v7
v_dot2c_f32_bf16 v230, v23, v6
v_dot2c_f32_bf16 v231, v23, v7
v_dot2c_f32_bf16 v224, v24, v6
v_dot2c_f32_bf16 v225, v24, v7
v_dot2c_f32_bf16 v226, v25, v6
v_dot2c_f32_bf16 v227, v25, v7
v_dot2c_f32_bf16 v228, v26, v6
v_dot2c_f32_bf16 v229, v26, v7
v_dot2c_f32_bf16 v230, v27, v6
v_dot2c_f32_bf16 v231, v27, v7
v_dot2c_f32_bf16 v224, v28, v6
v_dot2c_f32_bf16 v225, v28, v7
v_dot2c_f32_bf16 v226, v29, v6
v_dot2c_f32_bf16 v227, v29, v7
v_dot2c_f32_bf16 v228, v30, v6
v_dot2c_f32_bf16 v229, v30, v7
v_dot2c_f32_bf16 v230, v31, v6
v_dot2c_f32_bf16 v231, v31, v7
v_dot2c_f32_bf16 v224, v32, v6
v_dot2c_f32_bf16 v225, v32, v7
v_dot2c_f32_bf16 v226, v33, v6
v_dot2c_f32_bf16 v227, v33, v7
v_dot2c_f32_bf16 v228, v34, v6
v_dot2c_f32_bf16 v229, v34, v7
v_dot2c_f32_bf16 v230, v35, v6
v_dot2c_f32_bf16 v231, v35, v7
v_dot2c_f32_bf16 v224, v36, v6
v_dot2c_f32_bf16 v225, v36, v7
v_dot2c_f32_bf16 v226, v37, v6
v_dot2c_f32_bf16 v227, v37, v7
v_dot2c_f32_bf16 v228, v38, v6
v_dot2c_f32_bf16 v229, v38, v7
v_dot2c_f32_bf16 v230, v39, v6
v_dot2c_f32_bf16 v231, v39, v7
v_dot2c_f32_bf16 v224, v40, v6
v_dot2c_f32_bf16 v225, v40, v7
v_dot2c_f32_bf16 v226, v41, v6
v_dot2c_f32_bf16 v227, v41, v7
v_dot2c_f32_bf16 v228, v42, v6
v_dot2c_f32_bf16 v229, v42, v7
v_dot2c_f32_bf16 v230, v43, v6
v_dot2c_f32_bf16 v231, v43, v7
v_dot2c_f32_bf16 v224, v44, v6
v_dot2c_f32_bf16 v225, v44, v7
v_dot2c_f32_bf16 v226, v45, v6
v_dot2c_f32_bf16 v227, v45, v7
v_dot2c_f32_bf16 v228, v46, v6
v_dot2c_f32_bf16 v229, v46, v7
v_dot2c_f32_bf16 v230, v47, v6
v_dot2c_f32_bf16 v231, v47, v7
v_dot2c_f32_bf16 v224, v192, v6
v_dot2c_f32_bf16 v225, v192, v7
v_dot2c_f32_bf16 v226, v193, v6
v_dot2c_f32_bf16 v227, v193, v7
v_dot2c_f32_bf16 v228, v194, v6
v_dot2c_f32_bf16 v229, v194, v7
v_dot2c_f32_bf16 v230, v195, v6
v_dot2c_f32_bf16 v231, v195, v7
v_dot2c_f32_bf16 v224, v196, v6
v_dot2c_f32_bf16 v225, v196, v7
v_dot2c_f32_bf16 v226, v197, v6
v_dot2c_f32_bf16 v227, v197, v7
v_dot2c_f32_bf16 v228, v198, v6
v_dot2c_f32_bf16 v229, v198, v7
v_dot2c_f32_bf16 v230, v199, v6
v_dot2c_f32_bf16 v231, v199, v7
v_dot2c_f32_bf16 v224, v200, v6
v_dot2c_f32_bf16 v225, v200, v7
v_dot2c_f32_bf16 v226, v201, v6
v_dot2c_f32_bf16 v227, v201, v7
v_dot2c_f32_bf16 v228, v202, v6
v_dot2c_f32_bf16 v229, v202, v7
v_dot2c_f32_bf16 v230, v203, v6
v_dot2c_f32_bf16 v231, v203, v7
v_dot2c_f32_bf16 v224, v204, v6
v_dot2c_f32_bf16 v225, v204, v7
v_dot2c_f32_bf16 v226, v205, v6
v_dot2c_f32_bf16 v227, v205, v7
v_dot2c_f32_bf16 v228, v206, v6
v_dot2c_f32_bf16 v229, v206, v7
v_dot2c_f32_bf16 v230, v207, v6
v_dot2c_f32_bf16 v231, v207, v7
v_dot2c_f32_bf16 v224, v208, v6
v_dot2c_f32_bf16 v225, v208, v7
v_dot2c_f32_bf16 v226, v209, v6
v_dot2c_f32_bf16 v227, v209, v7
v_dot2c_f32_bf16 v228, v210, v6
v_dot2c_f32_bf16 v229, v210, v7
v_dot2c_f32_bf16 v230, v211, v6
v_dot2c_f32_bf16 v231, v211, v7
v_dot2c_f32_bf16 v224, v212, v6
v_dot2c_f32_bf16 v225, v212, v7
v_dot2c_f32_bf16 v226, v213, v6
v_dot2c_f32_bf16 v227, v213, v7
v_dot2c_f32_bf16 v228, v214, v6
v_dot2c_f32_bf16 v229, v214, v7
v_dot2c_f32_bf16 v230, v215, v6
v_dot2c_f32_bf16 v231, v215, v7
v_dot2c_f32_bf16 v224, v216, v6
v_dot2c_f32_bf16 v225, v216, v7
v_dot2c_f32_bf16 v226, v217, v6
v_dot2c_f32_bf16 v227, v217, v7
v_dot2c_f32_bf16 v228, v218, v6
v_dot2c_f32_bf16 v229, v218, v7
v_dot2c_f32_bf16 v230, v219, v6
v_dot2c_f32_bf16 v231, v219, v7
v_dot2c_f32_bf16 v224, v220, v6
v_dot2c_f32_bf16 v225, v220, v7
v_dot2c_f32_bf16 v226, v221, v6
v_dot2c_f32_bf16 v227, v221, v7
v_dot2c_f32_bf16 v228, v222, v6
v_dot2c_f32_bf16 v229, v222, v7
v_dot2c_f32_bf16 v230, v223, v6
v_dot2c_f32_bf16 v231, v223, v7
v_cvt_pk_bf16_f32 v248, v224, v225
v_cvt_pk_bf16_f32 v249, v226, v227
v_cvt_pk_bf16_f32 v250, v228, v229
v_cvt_pk_bf16_f32 v251, v230, v231
buffer_store_dwordx2 v[248:249], v14, s[44:47], 0 offen
buffer_store_dwordx2 v[250:251], v14, s[44:47], 0 offen offset:32
s_waitcnt vmcnt(5)
v_lshlrev_b32 v16, 16, v244
v_and_b32 v17, 0xffff0000, v244
v_lshlrev_b32 v18, 16, v245
v_and_b32 v19, 0xffff0000, v245
s_waitcnt vmcnt(4)
v_lshlrev_b32 v20, 16, v246
v_and_b32 v21, 0xffff0000, v246
v_lshlrev_b32 v22, 16, v247
v_and_b32 v23, 0xffff0000, v247
v_dot2c_f32_bf16 v16, v48, v6
v_dot2c_f32_bf16 v17, v48, v7
v_dot2c_f32_bf16 v18, v49, v6
v_dot2c_f32_bf16 v19, v49, v7
v_dot2c_f32_bf16 v20, v50, v6
v_dot2c_f32_bf16 v21, v50, v7
v_dot2c_f32_bf16 v22, v51, v6
v_dot2c_f32_bf16 v23, v51, v7
v_dot2c_f32_bf16 v16, v52, v6
v_dot2c_f32_bf16 v17, v52, v7
v_dot2c_f32_bf16 v18, v53, v6
v_dot2c_f32_bf16 v19, v53, v7
v_dot2c_f32_bf16 v20, v54, v6
v_dot2c_f32_bf16 v21, v54, v7
v_dot2c_f32_bf16 v22, v55, v6
v_dot2c_f32_bf16 v23, v55, v7
v_dot2c_f32_bf16 v16, v56, v6
v_dot2c_f32_bf16 v17, v56, v7
v_dot2c_f32_bf16 v18, v57, v6
v_dot2c_f32_bf16 v19, v57, v7
v_dot2c_f32_bf16 v20, v58, v6
v_dot2c_f32_bf16 v21, v58, v7
v_dot2c_f32_bf16 v22, v59, v6
v_dot2c_f32_bf16 v23, v59, v7
v_dot2c_f32_bf16 v16, v60, v6
v_dot2c_f32_bf16 v17, v60, v7
v_dot2c_f32_bf16 v18, v61, v6
v_dot2c_f32_bf16 v19, v61, v7
v_dot2c_f32_bf16 v20, v62, v6
v_dot2c_f32_bf16 v21, v62, v7
v_dot2c_f32_bf16 v22, v63, v6
v_dot2c_f32_bf16 v23, v63, v7
v_dot2c_f32_bf16 v16, v64, v6
v_dot2c_f32_bf16 v17, v64, v7
v_dot2c_f32_bf16 v18, v65, v6
v_dot2c_f32_bf16 v19, v65, v7
v_dot2c_f32_bf16 v20, v66, v6
v_dot2c_f32_bf16 v21, v66, v7
v_dot2c_f32_bf16 v22, v67, v6
v_dot2c_f32_bf16 v23, v67, v7
v_dot2c_f32_bf16 v16, v68, v6
v_dot2c_f32_bf16 v17, v68, v7
v_dot2c_f32_bf16 v18, v69, v6
v_dot2c_f32_bf16 v19, v69, v7
v_dot2c_f32_bf16 v20, v70, v6
v_dot2c_f32_bf16 v21, v70, v7
v_dot2c_f32_bf16 v22, v71, v6
v_dot2c_f32_bf16 v23, v71, v7
v_dot2c_f32_bf16 v16, v72, v6
v_dot2c_f32_bf16 v17, v72, v7
v_dot2c_f32_bf16 v18, v73, v6
v_dot2c_f32_bf16 v19, v73, v7
v_dot2c_f32_bf16 v20, v74, v6
v_dot2c_f32_bf16 v21, v74, v7
v_dot2c_f32_bf16 v22, v75, v6
v_dot2c_f32_bf16 v23, v75, v7
v_dot2c_f32_bf16 v16, v76, v6
v_dot2c_f32_bf16 v17, v76, v7
v_dot2c_f32_bf16 v18, v77, v6
v_dot2c_f32_bf16 v19, v77, v7
v_dot2c_f32_bf16 v20, v78, v6
v_dot2c_f32_bf16 v21, v78, v7
v_dot2c_f32_bf16 v22, v79, v6
v_dot2c_f32_bf16 v23, v79, v7
v_dot2c_f32_bf16 v16, v112, v6
v_dot2c_f32_bf16 v17, v112, v7
v_dot2c_f32_bf16 v18, v113, v6
v_dot2c_f32_bf16 v19, v113, v7
v_dot2c_f32_bf16 v20, v114, v6
v_dot2c_f32_bf16 v21, v114, v7
v_dot2c_f32_bf16 v22, v115, v6
v_dot2c_f32_bf16 v23, v115, v7
v_dot2c_f32_bf16 v16, v116, v6
v_dot2c_f32_bf16 v17, v116, v7
v_dot2c_f32_bf16 v18, v117, v6
v_dot2c_f32_bf16 v19, v117, v7
v_dot2c_f32_bf16 v20, v118, v6
v_dot2c_f32_bf16 v21, v118, v7
v_dot2c_f32_bf16 v22, v119, v6
v_dot2c_f32_bf16 v23, v119, v7
v_dot2c_f32_bf16 v16, v120, v6
v_dot2c_f32_bf16 v17, v120, v7
v_dot2c_f32_bf16 v18, v121, v6
v_dot2c_f32_bf16 v19, v121, v7
v_dot2c_f32_bf16 v20, v122, v6
v_dot2c_f32_bf16 v21, v122, v7
v_dot2c_f32_bf16 v22, v123, v6
v_dot2c_f32_bf16 v23, v123, v7
v_dot2c_f32_bf16 v16, v124, v6
v_dot2c_f32_bf16 v17, v124, v7
v_dot2c_f32_bf16 v18, v125, v6
v_dot2c_f32_bf16 v19, v125, v7
v_dot2c_f32_bf16 v20, v126, v6
v_dot2c_f32_bf16 v21, v126, v7
v_dot2c_f32_bf16 v22, v127, v6
v_dot2c_f32_bf16 v23, v127, v7
v_dot2c_f32_bf16 v16, v128, v6
v_dot2c_f32_bf16 v17, v128, v7
v_dot2c_f32_bf16 v18, v129, v6
v_dot2c_f32_bf16 v19, v129, v7
v_dot2c_f32_bf16 v20, v130, v6
v_dot2c_f32_bf16 v21, v130, v7
v_dot2c_f32_bf16 v22, v131, v6
v_dot2c_f32_bf16 v23, v131, v7
v_dot2c_f32_bf16 v16, v132, v6
v_dot2c_f32_bf16 v17, v132, v7
v_dot2c_f32_bf16 v18, v133, v6
v_dot2c_f32_bf16 v19, v133, v7
v_dot2c_f32_bf16 v20, v134, v6
v_dot2c_f32_bf16 v21, v134, v7
v_dot2c_f32_bf16 v22, v135, v6
v_dot2c_f32_bf16 v23, v135, v7
v_dot2c_f32_bf16 v16, v136, v6
v_dot2c_f32_bf16 v17, v136, v7
v_dot2c_f32_bf16 v18, v137, v6
v_dot2c_f32_bf16 v19, v137, v7
v_dot2c_f32_bf16 v20, v138, v6
v_dot2c_f32_bf16 v21, v138, v7
v_dot2c_f32_bf16 v22, v139, v6
v_dot2c_f32_bf16 v23, v139, v7
v_dot2c_f32_bf16 v16, v140, v6
v_dot2c_f32_bf16 v17, v140, v7
v_dot2c_f32_bf16 v18, v141, v6
v_dot2c_f32_bf16 v19, v141, v7
v_dot2c_f32_bf16 v20, v142, v6
v_dot2c_f32_bf16 v21, v142, v7
v_dot2c_f32_bf16 v22, v143, v6
v_dot2c_f32_bf16 v23, v143, v7
v_cvt_pk_bf16_f32 v244, v16, v17
v_cvt_pk_bf16_f32 v245, v18, v19
v_cvt_pk_bf16_f32 v246, v20, v21
v_cvt_pk_bf16_f32 v247, v22, v23
buffer_store_dwordx2 v[244:245], v9, s[44:47], 0 offen
buffer_store_dwordx2 v[246:247], v9, s[44:47], 0 offen offset:32
s_lshl_b32 s3, s53, 7
s_add_u32 s3, s3, 41943040
s_cmp_eq_u32 s54, 0
s_cselect_b32 s3, s3, 0x40000000
buffer_store_dword v10, v3, s[28:31], s3 offen sc1
L_main_end:
s_endpgm
.section .rodata,"a"
.p2align 6
.amdhsa_kernel parallel_sum__sliding_local_dilated__swiglu_ffn__prompt_kernel
  .amdhsa_next_free_vgpr 512
  .amdhsa_next_free_sgpr 102
  .amdhsa_accum_offset 256
  .amdhsa_group_segment_fixed_size 0
  .amdhsa_kernarg_size 80
  .amdhsa_user_sgpr_count 2
  .amdhsa_user_sgpr_kernarg_segment_ptr 1
  .amdhsa_system_sgpr_workgroup_id_x 1
.end_amdhsa_kernel
```
